```python
import torch

def _softmax(x, axis=-1):
    return torch.softmax(x, dim=axis)

def _gelu(x):
    return torch.nn.functional.gelu(x, approximate='tanh')

def _silu(x):
    return torch.nn.functional.silu(x)

def _sigmoid(x):
    return torch.sigmoid(x)

def _layernorm(x, axis=-1, eps=1e-05):
    m = x.mean(dim=axis, keepdim=True)
    v = x.var(dim=axis, keepdim=True, unbiased=False)
    return (x - m) / torch.sqrt(v + eps)

def _scatter_add(tgt, idx, src, axis=0):
    return tgt.clone().index_add_(axis, idx, src)

def _segment_sum(src, seg, n):
    out = torch.zeros((n,) + src.shape[1:], dtype=src.dtype)
    return out.index_add_(0, seg, src)

def _pad(x, pw):
    flat = tuple((v for pair in reversed(pw) for v in pair))
    return torch.nn.functional.pad(x, flat)
kernel_name = 'adaLN_cond__ssm_conv_h3__glu_gated_reglu__prompt'

def setup_inputs():

    _w = lambda a: (lambda t: t.to(torch.bfloat16) if t.is_floating_point() else t)(torch.as_tensor(a))

    def _A_setup():
        B, S, D = (1, 2048, 512)
        ks = 4
        return {'q': _w((lambda *s: torch.randn(*s, dtype=torch.bfloat16) * 0.05)(B, S, D)), 'k': _w((lambda *s: torch.randn(*s, dtype=torch.bfloat16) * 0.8)(B, S, D)), 'v': _w((lambda *s: torch.randn(*s, dtype=torch.bfloat16) * 0.8)(B, S, D)), 'shift_k': _w((lambda *s: torch.randn(*s, dtype=torch.bfloat16) * 0.8)(D, ks) * 0.5), 'ssm_k': _w((lambda *s: torch.randn(*s, dtype=torch.bfloat16) * 0.8)(D, S) * (1.0 / S ** 0.5)), 'ssm_D': _w((lambda *s: torch.randn(*s, dtype=torch.bfloat16) * 0.8)(D))}
    _A_in = _A_setup()

    def _B_setup():
        B, S, D, F = (1, 2048, 512, 1792)
        return {'x': _w((lambda *s: torch.randn(*s, dtype=torch.bfloat16) * 0.05)(B, S, D)), 'W_gate': _w((lambda *s: torch.randn(*s, dtype=torch.bfloat16) * 0.8)(D, F) * (2.0 / D) ** 0.5), 'W_up': _w((lambda *s: torch.randn(*s, dtype=torch.bfloat16) * 0.8)(D, F) * (2.0 / D) ** 0.5), 'W_down': _w((lambda *s: torch.randn(*s, dtype=torch.bfloat16) * 0.8)(F, D) * (1.0 / F) ** 0.5)}
    _B_in = _B_setup()
    return {'A_q': _A_in['q'], 'A_k': _A_in['k'], 'A_v': _A_in['v'], 'A_shift_k': _A_in['shift_k'], 'A_ssm_k': _A_in['ssm_k'], 'A_ssm_D': _A_in['ssm_D'], 'B_x': _B_in['x'], 'B_W_gate': _B_in['W_gate'], 'B_W_up': _B_in['W_up'], 'B_W_down': _B_in['W_down'], 'c': _w((lambda *s: torch.randn(*s, dtype=torch.bfloat16) * 0.2)(1, 512) * 8.0), 'w_mod': _w((lambda *s: torch.randn(*s, dtype=torch.bfloat16) * 0.2)(512, 6 * 512) * 512 ** (-0.5) * 8.0)}

def reference(A_q, A_k, A_v, A_shift_k, A_ssm_k, A_ssm_D, B_x, B_W_gate, B_W_up, B_W_down, c, w_mod):

    def _A_ref(q, k, v, shift_k, ssm_k, ssm_D):
        B, S, D = q.shape
        ks = shift_k.shape[-1]
        k_pad = _pad(k, ((0, 0), (ks - 1, 0), (0, 0)))
        k_shift = torch.zeros_like(k)
        for t in range(ks):
            k_shift = k_shift + k_pad[:, t:t + S, :] * shift_k[:, ks - 1 - t][None, None, :]
        kv = k_shift * v
        L = 2 * S
        kv_pad = _pad(kv, ((0, 0), (0, S), (0, 0)))
        kf_pad = _pad(ssm_k, ((0, 0), (0, S)))
        kv_f = (lambda x, axes=(-2, -1): torch.fft.rfft2(x.float(), dim=axes))(kv_pad[:, None, :, :], axes=(1, 2))
        kf_f = (lambda x, axes=(-2, -1): torch.fft.rfft2(x.float(), dim=axes))(kf_pad[:, None, :], axes=(1, 2))
        kf_f = (lambda x, *d: x.permute(*d))(kf_f, 1, 2, 0)
        y_f = kv_f * kf_f[None, :, :, :]
        y = (lambda x, s, axes=(-2, -1): torch.fft.irfft2(x, s=s, dim=axes).to(torch.bfloat16))(y_f, (1, L), axes=(1, 2))[:, 0, :S, :]
        y = y + kv * ssm_D[None, None, :]
        return q * y

    def _B_ref(x, W_gate, W_up, W_down):
        gate = torch.einsum('bsd,df->bsf', x, W_gate)
        up = torch.einsum('bsd,df->bsf', x, W_up)
        gate = gate * (lambda x, dt: x.to(dt))(gate > 0, gate.dtype)
        h = gate * up
        return torch.einsum('bsf,fd->bsd', h, W_down)
    x = A_q
    mod = (_silu(c) @ w_mod).reshape(c.shape[0], 6, 1, -1)
    sa, ca, ga, sb, cb, gb = (mod[:, 0].clone(), mod[:, 1].clone(), mod[:, 2].clone(), mod[:, 3].clone(), mod[:, 4].clone(), mod[:, 5].clone())
    h = _layernorm(x, axis=-1) * (1 + ca) + sa
    x = x + ga * _A_ref(h, A_k, A_v, A_shift_k, A_ssm_k, A_ssm_D)
    h = _layernorm(x, axis=-1) * (1 + cb) + sb
    x = x + gb * _B_ref(h, B_W_gate, B_W_up, B_W_down)
    return x
```

```asm
; @launch kernel=mega_kernel grid=(256,1,1) block=(256,1,1) lds=163840
.amdgcn_target "amdgcn-amd-amdhsa--gfx950"
.text
.globl mega_kernel
.p2align 8
.type mega_kernel,@function
mega_kernel:
    s_cmp_ge_u32 s2, 256
    s_cbranch_scc1 Lm_done
    s_load_dwordx8 s[56:63], s[0:1], 0
    s_load_dwordx2 s[10:11], s[0:1], 112
    s_load_dwordx4 s[4:7], s[0:1], 32
    s_memrealtime s[68:69]
    s_load_dwordx4 s[72:75], s[0:1], 88
    s_load_dwordx4 s[64:67], s[0:1], 72
    s_load_dwordx4 s[12:15], s[0:1], 56
    s_getpc_b64 s[38:39]
Lm_pc:
    s_lshr_b32 s43, s2, 3
    v_lshrrev_b32 v2, 6, v0
    v_and_b32 v222, 3, v0
    v_lshl_add_u32 v222, v2, 2, v222
    s_lshl_b32 s40, s43, 4
    v_add_u32 v222, s40, v222
    v_lshlrev_b32 v222, 7, v222
    v_min_u32 v222, Lm_fast_end-Lm_pc-4, v222
    s_mov_b64 exec, 15
    global_load_dword v223, v222, s[38:39]
    s_mov_b64 exec, -1
    s_and_b32 s42, s2, 7
    v_readfirstlane_b32 s44, v2
    v_and_b32 v1, 31, v0
    v_lshrrev_b32 v2, 5, v0
    s_lshl_b32 s47, s43, 16
    s_lshl_b32 s48, s42, 7
    s_add_u32 s47, s47, s48
    v_lshlrev_b32 v4, 13, v2
    v_lshl_add_u32 v4, v1, 2, v4
    v_add_u32 v4, s47, v4
    v_add_u32 v5, 0x1000, v4
    v_subrev_u32 v6, 3072, v4
    s_lshl_b32 s48, s42, 9
    v_lshlrev_b32 v9, 4, v1
    v_add_u32 v9, s48, v9
    s_mov_b32 s34, 0x200000
    s_mov_b32 s35, 0x00020000
    s_waitcnt lgkmcnt(0)
    s_mov_b32 s32, s58
    s_and_b32 s33, s59, 0xffff
    global_load_dwordx4 v[30:33], v9, s[62:63]
    buffer_load_dword v10, v6, s[32:35], 0 offen offset:0
    buffer_load_dword v11, v6, s[32:35], 0 offen offset:1024
    buffer_load_dword v12, v6, s[32:35], 0 offen offset:2048
    buffer_load_dword v13, v4, s[32:35], 0 offen offset:0
    buffer_load_dword v14, v4, s[32:35], 0 offen offset:1024
    buffer_load_dword v15, v4, s[32:35], 0 offen offset:2048
    buffer_load_dword v16, v4, s[32:35], 0 offen offset:3072
    buffer_load_dword v17, v5, s[32:35], 0 offen offset:0
    buffer_load_dword v18, v5, s[32:35], 0 offen offset:1024
    buffer_load_dword v19, v5, s[32:35], 0 offen offset:2048
    buffer_load_dword v20, v5, s[32:35], 0 offen offset:3072
    global_load_dword v21, v4, s[60:61] offset:0
    global_load_dword v22, v4, s[60:61] offset:1024
    global_load_dword v23, v4, s[60:61] offset:2048
    global_load_dword v24, v4, s[60:61] offset:3072
    global_load_dword v25, v5, s[60:61] offset:0
    global_load_dword v26, v5, s[60:61] offset:1024
    global_load_dword v27, v5, s[60:61] offset:2048
    global_load_dword v28, v5, s[60:61] offset:3072
    s_mov_b32 s16, s10
    s_and_b32 s17, s11, 0xffff
    s_mov_b32 s18, 0x3000000
    s_mov_b32 s19, 0x00020000
    s_mov_b32 s40, 0xffff0000
    v_and_b32 v3, 63, v0
    s_lshl_b32 s41, s42, 5
    s_add_u32 s41, s41, s43
    s_lshr_b32 s46, s41, 4
    s_and_b32 s45, s43, 15
    s_getreg_b32 s37, hwreg(HW_REG_XCC_ID, 0, 4)
    v_mov_b32 v219, 0
    s_cmp_lg_u32 s44, 0
    s_cbranch_scc1 Lm_noe0
    s_and_b32 s55, s68, 0xffffffe0
    s_or_b32 s55, s55, s37
    s_or_b32 s55, s55, 16
    v_mov_b32 v216, s55
    v_mov_b32 v217, s69
    s_lshl_b32 s50, s41, 3
    s_add_u32 s50, s50, 7143424
    s_mov_b64 exec, 1
    buffer_store_dwordx2 v[216:217], v219, s[16:19], s50 offen sc1
    s_mov_b64 exec, -1
Lm_noe0:
    v_lshlrev_b32 v7, 4, v0
    s_lshl_b32 s52, s41, 13
    s_add_u32 s53, s52, 4096
    s_lshl_b32 s54, s41, 2
    s_add_u32 s20, s4, s52
    s_addc_u32 s21, s5, 0
    s_and_b32 s21, s21, 0xffff
    s_mov_b32 s22, 0x1000
    s_mov_b32 s23, 0x00020000
    s_add_u32 s24, s4, s53
    s_addc_u32 s25, s5, 0
    s_and_b32 s25, s25, 0xffff
    s_mov_b32 s26, 0x1000
    s_mov_b32 s27, 0x00020000
    buffer_load_dwordx4 v[132:135], v7, s[20:23], 0 offen
    buffer_load_dwordx4 v[136:139], v7, s[20:23], 0 offen offset:4
    buffer_load_dword v140, v7, s[20:23], 0 offen offset:20
    buffer_load_dwordx4 v[142:145], v7, s[24:27], 0 offen
    buffer_load_dwordx4 v[146:149], v7, s[24:27], 0 offen offset:4
    buffer_load_dword v150, v7, s[24:27], 0 offen offset:20
    s_load_dword s47, s[6:7], s54
    v_lshrrev_b32 v220, 3, v3
    v_mul_u32_u24 v220, 4480, v220
    v_and_b32 v221, 7, v3
    v_lshl_add_u32 v220, v221, 4, v220
    s_lshl_b32 s50, s42, 6
    s_lshl_b32 s51, s44, 4
    s_add_u32 s50, s50, s51
    s_mul_i32 s50, s50, 4480
    s_lshl_b32 s51, s43, 7
    s_sub_u32 s38, s50, s51
    s_add_u32 s38, s38, 22024064
    s_add_u32 s50, s38, 35840
    v_mul_u32_u24 v222, 4480, v3
    s_mov_b64 exec, 0xffff
    buffer_load_dword v223, v222, s[16:19], s38 offen
    s_mov_b64 exec, -1
    v_lshrrev_b32 v237, 3, v3
    v_mul_u32_u24 v237, 3584, v237
    v_lshl_add_u32 v237, v221, 7, v237
    s_lshl_b32 s52, s43, 1
    s_and_b32 s53, s44, 1
    s_add_u32 s52, s52, s53
    s_mul_i32 s52, s52, 28672
    v_add_u32 v237, s52, v237
    s_cmp_ge_u32 s44, 2
    s_cselect_b32 s12, s14, s12
    s_cselect_b32 s13, s15, s13
    v_add_u32 v36, 0, v3
    v_min_u32 v36, 95, v36
    v_mul_u32_u24 v37, 2731, v36
    v_lshrrev_b32 v37, 16, v37
    v_mul_u32_u24 v38, 24, v37
    v_sub_u32 v36, v36, v38
    v_mul_u32_u24 v38, 10923, v36
    v_lshrrev_b32 v38, 16, v38
    v_mul_u32_u24 v240, 3488, v38
    v_lshl_add_u32 v240, v36, 4, v240
    v_mul_u32_u24 v38, 96, v37
    v_add_u32 v240, v240, v38
    v_mul_u32_u24 v242, 98304, v37
    v_lshl_add_u32 v242, v36, 4, v242
    v_add_u32 v36, 64, v3
    v_min_u32 v36, 95, v36
    v_mul_u32_u24 v37, 2731, v36
    v_lshrrev_b32 v37, 16, v37
    v_mul_u32_u24 v38, 24, v37
    v_sub_u32 v36, v36, v38
    v_mul_u32_u24 v38, 10923, v36
    v_lshrrev_b32 v38, 16, v38
    v_mul_u32_u24 v241, 3488, v38
    v_lshl_add_u32 v241, v36, 4, v241
    v_mul_u32_u24 v38, 96, v37
    v_add_u32 v241, v241, v38
    v_mul_u32_u24 v243, 98304, v37
    v_lshl_add_u32 v243, v36, 4, v243
    s_lshl_b32 s52, s41, 1
    s_add_u32 s52, s52, s53
    s_mul_i32 s52, s52, 3584
    v_lshlrev_b32 v244, 7, v3
    v_add_u32 v244, s52, v244
    s_lshr_b32 s52, s41, 1
    s_and_b32 s51, s41, 1
    s_lshl_b32 s51, s51, 1
    s_add_u32 s51, s51, s53
    s_mul_i32 s53, s52, 14336
    s_mul_i32 s55, s51, 384
    s_add_u32 s53, s53, s55
    s_add_u32 s53, s53, 2048
    v_add_u32 v240, s53, v240
    v_add_u32 v241, s53, v241
    s_mul_i32 s52, s52, 384
    s_mul_i32 s51, s51, 393216
    s_add_u32 s52, s52, s51
    s_lshr_b32 s51, s44, 1
    s_mul_i32 s51, s51, 49152
    s_add_u32 s52, s52, s51
    s_add_u32 s52, s52, 9437184
    v_add_u32 v242, s52, v242
    v_add_u32 v243, s52, v243
    s_mov_b32 s8, s74
    s_mov_b32 s9, s75
    s_sub_u32 s68, s68, 800
    s_subb_u32 s69, s69, 0
    v_lshlrev_b32 v218, 3, v3
    s_lshl_b32 s52, s42, 8
    v_add_u32 v218, s52, v218
    v_cmp_gt_u32 vcc, 32, v3
    v_and_b32 v184, 7, v1
    v_cndmask_b32 v218, 0, v218, vcc
    v_xor_b32 v184, v184, v2
    v_xor_b32 v184, 7, v184
    v_lshlrev_b32 v185, 8, v1
    v_lshl_add_u32 v184, v184, 4, v185
    v_add_u32 v184, 49152, v184
    v_lshrrev_b32 v186, 4, v3
    v_xor_b32 v186, v186, v221
    v_lshrrev_b32 v187, 3, v3
    v_lshlrev_b32 v187, 7, v187
    v_lshl_add_u32 v186, v186, 4, v187
    s_lshl_b32 s52, s44, 11
    s_add_u32 s52, s52, 49152
    v_add_u32 v186, s52, v186
    v_xor_b32 v187, 64, v186
    s_mov_b32 s54, 7143424
    s_mov_b32 s52, 0x05040100
    s_mov_b32 s53, 0x07060302
    v_mov_b32 v156, 0
    v_mov_b32 v157, 0
    v_mov_b32 v158, 0
    v_mov_b32 v159, 0
    v_cmp_gt_u32 vcc, 60, v0
    v_subrev_u32 v8, 60, v0
    v_mov_b32 v34, 161696
    v_mov_b32 v35, 154112
    v_cndmask_b32 v8, v8, v0, vcc
    v_cndmask_b32 v35, v34, v35, vcc
    v_lshrrev_b32 v34, 2, v8
    v_and_b32 v36, 3, v8
    v_mul_u32_u24 v34, 96, v34
    v_lshl_add_u32 v35, v36, 4, v35
    v_add_u32 v35, v35, v34
    v_cmp_gt_u32 vcc, 120, v0
    s_and_saveexec_b64 s[58:59], vcc
    s_cbranch_execz Lm_z1
    ds_write_b128 v35, v[156:159]
Lm_z1:
    s_mov_b64 exec, s[58:59]
    v_lshrrev_b32 v34, 3, v3
    v_lshlrev_b32 v196, 10, v221
    v_lshl_add_u32 v196, v34, 4, v196
    s_lshl_b32 s58, s41, 13
    s_lshl_b32 s59, s44, 8
    s_add_u32 s58, s58, s59
    v_add_u32 v196, s58, v196
    s_min_u32 s58, s2, 223
    s_lshr_b32 s49, s58, 1
    s_and_b32 s58, s58, 1
    s_mul_i32 s59, s49, 9363
    s_lshr_b32 s59, s59, 16
    s_mul_i32 s51, s59, 7
    s_sub_u32 s51, s49, s51
    s_lshl_b32 s100, s59, 2
    s_mul_i32 s59, s59, 3
    s_add_u32 s59, s59, 60
    s_cmp_lt_u32 s51, 4
    s_cselect_b32 s59, s100, s59
    s_add_u32 s59, s59, s51
    s_lshl_b32 s59, s59, 14
    s_lshl_b32 s51, s58, 12
    s_add_u32 s59, s59, s51
    v_lshrrev_b32 v198, 5, v3
    v_lshlrev_b32 v198, 12, v198
    v_lshl_add_u32 v198, v34, 10, v198
    v_lshl_add_u32 v198, v221, 4, v198
    s_lshl_b32 s51, s44, 7
    s_add_u32 s59, s59, s51
    v_add_u32 v198, s59, v198
    v_add_u32 v199, 512, v198
    s_lshl_b32 s49, s49, 11
    s_lshl_b32 s58, s58, 9
    s_add_u32 s49, s49, s58
    s_mul_i32 s58, s44, 229376
    s_add_u32 s49, s49, s58
    s_add_u32 s49, s49, 19922944
    s_add_u32 s100, s49, 917504
    v_min_u32 v35, 5, v221
    v_mul_u32_u24 v34, 6144, v34
    v_lshl_add_u32 v197, v35, 7, v34
    s_lshl_b32 s58, s43, 2
    s_add_u32 s58, s58, s44
    s_mul_i32 s58, s58, 24576
    s_mul_i32 s59, s42, 768
    s_add_u32 s58, s58, s59
    v_add_u32 v197, s58, v197
    s_waitcnt vmcnt(26)
    v_lshlrev_b32 v80, 16, v30
    v_lshlrev_b32 v81, 16, v32
    v_and_b32 v82, s40, v30
    v_and_b32 v83, s40, v32
    v_lshlrev_b32 v84, 16, v31
    v_lshlrev_b32 v85, 16, v33
    v_and_b32 v86, s40, v31
    v_and_b32 v87, s40, v33
    s_waitcnt vmcnt(15)
    buffer_load_dwordx2 v[216:217], v218, s[16:19], s54 offen sc1
    s_mov_b32 exec_hi, 0
    global_load_dword v223, v197, s[72:73]
    s_mov_b32 exec_hi, -1
    s_mov_b64 exec, 0xffff
    global_load_dword v223, v244, s[12:13]
    s_mov_b64 exec, -1
    global_load_dwordx4 a[0:3], v240, s[12:13]
    s_mov_b32 exec_hi, 0
    global_load_dwordx4 a[4:7], v241, s[12:13]
    s_mov_b32 exec_hi, -1
    global_load_dwordx4 a[8:11], v198, s[64:65]
    global_load_dwordx4 a[12:15], v199, s[64:65]
    v_lshlrev_b32 v40, 16, v10
    v_and_b32 v41, s40, v10
    v_lshlrev_b32 v42, 16, v11
    v_and_b32 v43, s40, v11
    v_lshlrev_b32 v44, 16, v12
    v_and_b32 v45, s40, v12
    v_lshlrev_b32 v46, 16, v13
    v_and_b32 v47, s40, v13
    v_lshlrev_b32 v48, 16, v14
    v_and_b32 v49, s40, v14
    v_lshlrev_b32 v50, 16, v15
    v_and_b32 v51, s40, v15
    v_lshlrev_b32 v52, 16, v16
    v_and_b32 v53, s40, v16
    v_lshlrev_b32 v54, 16, v17
    v_and_b32 v55, s40, v17
    v_lshlrev_b32 v56, 16, v18
    v_and_b32 v57, s40, v18
    v_lshlrev_b32 v58, 16, v19
    v_and_b32 v59, s40, v19
    v_lshlrev_b32 v60, 16, v20
    v_and_b32 v61, s40, v20
    v_pk_mul_f32 v[90:91], v[40:41], v[86:87]
    v_pk_mul_f32 v[94:95], v[42:43], v[86:87]
    v_pk_mul_f32 v[98:99], v[44:45], v[86:87]
    v_pk_mul_f32 v[102:103], v[46:47], v[86:87]
    v_pk_mul_f32 v[106:107], v[48:49], v[86:87]
    v_pk_mul_f32 v[110:111], v[50:51], v[86:87]
    v_pk_mul_f32 v[114:115], v[52:53], v[86:87]
    v_pk_mul_f32 v[118:119], v[54:55], v[86:87]
    v_pk_mul_f32 v[92:93], v[42:43], v[84:85]
    v_pk_mul_f32 v[96:97], v[44:45], v[84:85]
    v_pk_mul_f32 v[100:101], v[46:47], v[84:85]
    v_pk_mul_f32 v[104:105], v[48:49], v[84:85]
    v_pk_mul_f32 v[108:109], v[50:51], v[84:85]
    v_pk_mul_f32 v[112:113], v[52:53], v[84:85]
    v_pk_mul_f32 v[116:117], v[54:55], v[84:85]
    v_pk_mul_f32 v[120:121], v[56:57], v[84:85]
    v_cvt_pk_bf16_f32 v90, 0, v90
    v_cvt_pk_bf16_f32 v94, 0, v94
    v_cvt_pk_bf16_f32 v98, 0, v98
    v_cvt_pk_bf16_f32 v102, 0, v102
    v_cvt_pk_bf16_f32 v106, 0, v106
    v_cvt_pk_bf16_f32 v110, 0, v110
    v_cvt_pk_bf16_f32 v114, 0, v114
    v_cvt_pk_bf16_f32 v118, 0, v118
    v_cvt_pk_bf16_f32 v91, 0, v91
    v_cvt_pk_bf16_f32 v95, 0, v95
    v_cvt_pk_bf16_f32 v99, 0, v99
    v_cvt_pk_bf16_f32 v103, 0, v103
    v_cvt_pk_bf16_f32 v107, 0, v107
    v_cvt_pk_bf16_f32 v111, 0, v111
    v_cvt_pk_bf16_f32 v115, 0, v115
    v_cvt_pk_bf16_f32 v119, 0, v119
    v_cvt_pk_bf16_f32 v92, 0, v92
    v_cvt_pk_bf16_f32 v96, 0, v96
    v_cvt_pk_bf16_f32 v100, 0, v100
    v_cvt_pk_bf16_f32 v104, 0, v104
    v_cvt_pk_bf16_f32 v108, 0, v108
    v_cvt_pk_bf16_f32 v112, 0, v112
    v_cvt_pk_bf16_f32 v116, 0, v116
    v_cvt_pk_bf16_f32 v120, 0, v120
    v_cvt_pk_bf16_f32 v93, 0, v93
    v_cvt_pk_bf16_f32 v97, 0, v97
    v_cvt_pk_bf16_f32 v101, 0, v101
    v_cvt_pk_bf16_f32 v105, 0, v105
    v_cvt_pk_bf16_f32 v109, 0, v109
    v_cvt_pk_bf16_f32 v113, 0, v113
    v_cvt_pk_bf16_f32 v117, 0, v117
    v_cvt_pk_bf16_f32 v121, 0, v121
    v_pk_add_f32 v[90:91], v[90:91], v[92:93]
    v_pk_add_f32 v[94:95], v[94:95], v[96:97]
    v_pk_add_f32 v[98:99], v[98:99], v[100:101]
    v_pk_add_f32 v[102:103], v[102:103], v[104:105]
    v_pk_add_f32 v[106:107], v[106:107], v[108:109]
    v_pk_add_f32 v[110:111], v[110:111], v[112:113]
    v_pk_add_f32 v[114:115], v[114:115], v[116:117]
    v_pk_add_f32 v[118:119], v[118:119], v[120:121]
    v_pk_mul_f32 v[92:93], v[44:45], v[82:83]
    v_pk_mul_f32 v[96:97], v[46:47], v[82:83]
    v_pk_mul_f32 v[100:101], v[48:49], v[82:83]
    v_pk_mul_f32 v[104:105], v[50:51], v[82:83]
    v_pk_mul_f32 v[108:109], v[52:53], v[82:83]
    v_pk_mul_f32 v[112:113], v[54:55], v[82:83]
    v_pk_mul_f32 v[116:117], v[56:57], v[82:83]
    v_pk_mul_f32 v[120:121], v[58:59], v[82:83]
    v_cvt_pk_bf16_f32 v90, 0, v90
    v_cvt_pk_bf16_f32 v94, 0, v94
    v_cvt_pk_bf16_f32 v98, 0, v98
    v_cvt_pk_bf16_f32 v102, 0, v102
    v_cvt_pk_bf16_f32 v106, 0, v106
    v_cvt_pk_bf16_f32 v110, 0, v110
    v_cvt_pk_bf16_f32 v114, 0, v114
    v_cvt_pk_bf16_f32 v118, 0, v118
    v_cvt_pk_bf16_f32 v91, 0, v91
    v_cvt_pk_bf16_f32 v95, 0, v95
    v_cvt_pk_bf16_f32 v99, 0, v99
    v_cvt_pk_bf16_f32 v103, 0, v103
    v_cvt_pk_bf16_f32 v107, 0, v107
    v_cvt_pk_bf16_f32 v111, 0, v111
    v_cvt_pk_bf16_f32 v115, 0, v115
    v_cvt_pk_bf16_f32 v119, 0, v119
    v_cvt_pk_bf16_f32 v92, 0, v92
    v_cvt_pk_bf16_f32 v96, 0, v96
    v_cvt_pk_bf16_f32 v100, 0, v100
    v_cvt_pk_bf16_f32 v104, 0, v104
    v_cvt_pk_bf16_f32 v108, 0, v108
    v_cvt_pk_bf16_f32 v112, 0, v112
    v_cvt_pk_bf16_f32 v116, 0, v116
    v_cvt_pk_bf16_f32 v120, 0, v120
    v_cvt_pk_bf16_f32 v93, 0, v93
    v_cvt_pk_bf16_f32 v97, 0, v97
    v_cvt_pk_bf16_f32 v101, 0, v101
    v_cvt_pk_bf16_f32 v105, 0, v105
    v_cvt_pk_bf16_f32 v109, 0, v109
    v_cvt_pk_bf16_f32 v113, 0, v113
    v_cvt_pk_bf16_f32 v117, 0, v117
    v_cvt_pk_bf16_f32 v121, 0, v121
    v_pk_add_f32 v[90:91], v[90:91], v[92:93]
    v_pk_add_f32 v[94:95], v[94:95], v[96:97]
    v_pk_add_f32 v[98:99], v[98:99], v[100:101]
    v_pk_add_f32 v[102:103], v[102:103], v[104:105]
    v_pk_add_f32 v[106:107], v[106:107], v[108:109]
    v_pk_add_f32 v[110:111], v[110:111], v[112:113]
    v_pk_add_f32 v[114:115], v[114:115], v[116:117]
    v_pk_add_f32 v[118:119], v[118:119], v[120:121]
    v_pk_mul_f32 v[92:93], v[46:47], v[80:81]
    v_pk_mul_f32 v[96:97], v[48:49], v[80:81]
    v_pk_mul_f32 v[100:101], v[50:51], v[80:81]
    v_pk_mul_f32 v[104:105], v[52:53], v[80:81]
    v_pk_mul_f32 v[108:109], v[54:55], v[80:81]
    v_pk_mul_f32 v[112:113], v[56:57], v[80:81]
    v_pk_mul_f32 v[116:117], v[58:59], v[80:81]
    v_pk_mul_f32 v[120:121], v[60:61], v[80:81]
    v_cvt_pk_bf16_f32 v90, 0, v90
    v_cvt_pk_bf16_f32 v94, 0, v94
    v_cvt_pk_bf16_f32 v98, 0, v98
    v_cvt_pk_bf16_f32 v102, 0, v102
    v_cvt_pk_bf16_f32 v106, 0, v106
    v_cvt_pk_bf16_f32 v110, 0, v110
    v_cvt_pk_bf16_f32 v114, 0, v114
    v_cvt_pk_bf16_f32 v118, 0, v118
    v_cvt_pk_bf16_f32 v91, 0, v91
    v_cvt_pk_bf16_f32 v95, 0, v95
    v_cvt_pk_bf16_f32 v99, 0, v99
    v_cvt_pk_bf16_f32 v103, 0, v103
    v_cvt_pk_bf16_f32 v107, 0, v107
    v_cvt_pk_bf16_f32 v111, 0, v111
    v_cvt_pk_bf16_f32 v115, 0, v115
    v_cvt_pk_bf16_f32 v119, 0, v119
    v_cvt_pk_bf16_f32 v92, 0, v92
    v_cvt_pk_bf16_f32 v96, 0, v96
    v_cvt_pk_bf16_f32 v100, 0, v100
    v_cvt_pk_bf16_f32 v104, 0, v104
    v_cvt_pk_bf16_f32 v108, 0, v108
    v_cvt_pk_bf16_f32 v112, 0, v112
    v_cvt_pk_bf16_f32 v116, 0, v116
    v_cvt_pk_bf16_f32 v120, 0, v120
    v_cvt_pk_bf16_f32 v93, 0, v93
    v_cvt_pk_bf16_f32 v97, 0, v97
    v_cvt_pk_bf16_f32 v101, 0, v101
    v_cvt_pk_bf16_f32 v105, 0, v105
    v_cvt_pk_bf16_f32 v109, 0, v109
    v_cvt_pk_bf16_f32 v113, 0, v113
    v_cvt_pk_bf16_f32 v117, 0, v117
    v_cvt_pk_bf16_f32 v121, 0, v121
    v_pk_add_f32 v[90:91], v[90:91], v[92:93]
    v_pk_add_f32 v[94:95], v[94:95], v[96:97]
    v_pk_add_f32 v[98:99], v[98:99], v[100:101]
    v_pk_add_f32 v[102:103], v[102:103], v[104:105]
    v_pk_add_f32 v[106:107], v[106:107], v[108:109]
    v_pk_add_f32 v[110:111], v[110:111], v[112:113]
    v_pk_add_f32 v[114:115], v[114:115], v[116:117]
    v_pk_add_f32 v[118:119], v[118:119], v[120:121]
    v_cvt_pk_bf16_f32 v90, 0, v90
    v_cvt_pk_bf16_f32 v94, 0, v94
    v_cvt_pk_bf16_f32 v98, 0, v98
    v_cvt_pk_bf16_f32 v102, 0, v102
    v_cvt_pk_bf16_f32 v106, 0, v106
    v_cvt_pk_bf16_f32 v110, 0, v110
    v_cvt_pk_bf16_f32 v114, 0, v114
    v_cvt_pk_bf16_f32 v118, 0, v118
    v_cvt_pk_bf16_f32 v91, 0, v91
    v_cvt_pk_bf16_f32 v95, 0, v95
    v_cvt_pk_bf16_f32 v99, 0, v99
    v_cvt_pk_bf16_f32 v103, 0, v103
    v_cvt_pk_bf16_f32 v107, 0, v107
    v_cvt_pk_bf16_f32 v111, 0, v111
    v_cvt_pk_bf16_f32 v115, 0, v115
    v_cvt_pk_bf16_f32 v119, 0, v119
    s_waitcnt vmcnt(14)
    v_lshlrev_b32 v62, 16, v21
    v_and_b32 v63, s40, v21
    v_lshlrev_b32 v64, 16, v22
    v_and_b32 v65, s40, v22
    v_lshlrev_b32 v66, 16, v23
    v_and_b32 v67, s40, v23
    v_lshlrev_b32 v68, 16, v24
    v_and_b32 v69, s40, v24
    v_lshlrev_b32 v70, 16, v25
    v_and_b32 v71, s40, v25
    v_lshlrev_b32 v72, 16, v26
    v_and_b32 v73, s40, v26
    v_lshlrev_b32 v74, 16, v27
    v_and_b32 v75, s40, v27
    v_lshlrev_b32 v76, 16, v28
    v_and_b32 v77, s40, v28
    v_pk_mul_f32 v[62:63], v[90:91], v[62:63]
    v_pk_mul_f32 v[64:65], v[94:95], v[64:65]
    v_pk_mul_f32 v[66:67], v[98:99], v[66:67]
    v_pk_mul_f32 v[68:69], v[102:103], v[68:69]
    v_pk_mul_f32 v[70:71], v[106:107], v[70:71]
    v_pk_mul_f32 v[72:73], v[110:111], v[72:73]
    v_pk_mul_f32 v[74:75], v[114:115], v[74:75]
    v_pk_mul_f32 v[76:77], v[118:119], v[76:77]
    v_cvt_pk_bf16_f32 v10, v76, v74
    v_cvt_pk_bf16_f32 v14, v77, v75
    v_cvt_pk_bf16_f32 v11, v72, v70
    v_cvt_pk_bf16_f32 v15, v73, v71
    v_cvt_pk_bf16_f32 v12, v68, v66
    v_cvt_pk_bf16_f32 v16, v69, v67
    v_cvt_pk_bf16_f32 v13, v64, v62
    v_cvt_pk_bf16_f32 v17, v65, v63
    ds_write_b128 v184, v[10:13]
    ds_write_b128 v184, v[14:17] offset:128
    s_waitcnt vmcnt(6)
    v_subrev_co_u32 v40, vcc, s68, v216
    v_mov_b32 v41, s69
    v_subb_co_u32 v41, vcc, v217, v41, vcc
    v_lshrrev_b32 v40, 24, v40
    v_or_b32 v40, v40, v41
    v_cmp_ne_u32 vcc, 0, v40
    s_cbranch_vccnz Lm_e0slow
Lm_e0back:
    v_readlane_b32 s36, v216, 32
    v_and_b32 v40, 15, v216
    v_cmp_ne_u32 vcc, s37, v40
    s_waitcnt lgkmcnt(0)
    s_barrier
    ds_read_b128 v[10:13], v186
    ds_read_b128 v[14:17], v187 offset:1024
    s_cmp_lg_u32 vcc_lo, 0
    s_cbranch_scc1 Lm_G
    v_mov_b32 v193, s36
    s_lshl_b32 s37, s42, 9
    s_add_u32 s37, s37, 7077888
    s_lshl_b32 s39, s43, 4
    s_lshl_b32 s60, s44, 2
    s_add_u32 s39, s39, s60
    s_add_u32 s39, s39, s37
    v_lshlrev_b32 v189, 3, v3
    s_waitcnt lgkmcnt(1)
    buffer_store_dwordx4 v[10:13], v220, s[16:19], s38 offen
    s_waitcnt lgkmcnt(0)
    buffer_store_dwordx4 v[14:17], v220, s[16:19], s50 offen
    v_lshlrev_b32 v1, 4, v0
    s_lshr_b32 s50, s44, 1
    s_and_b32 s51, s44, 1
    v_and_b32 v60, 15, v3
    v_lshrrev_b32 v61, 4, v3
    v_add_u32 v4, 114752, v1
    v_alignbit_b32 v32, v133, v132, 16
    v_alignbit_b32 v33, v134, v133, 16
    v_alignbit_b32 v34, v135, v134, 16
    v_alignbit_b32 v35, v139, v135, 16
    v_alignbit_b32 v36, v137, v136, 16
    v_alignbit_b32 v37, v138, v137, 16
    v_alignbit_b32 v38, v139, v138, 16
    v_alignbit_b32 v39, v140, v139, 16
    ds_write_b128 v4, v[132:135]
    ds_write_b128 v4, v[136:139] offset:8320
    ds_write_b128 v4, v[32:35] offset:4160
    ds_write_b128 v4, v[36:39] offset:12480
    v_readfirstlane_b32 s54, v132
    v_readfirstlane_b32 s55, v133
    s_waitcnt vmcnt(0)
    s_mov_b64 exec, 1
    buffer_store_dword v193, v219, s[16:19], s39 offen
    s_mov_b64 exec, -1
    v_alignbit_b32 v40, v143, v142, 16
    v_alignbit_b32 v41, v144, v143, 16
    v_alignbit_b32 v42, v145, v144, 16
    v_alignbit_b32 v43, v149, v145, 16
    v_alignbit_b32 v44, v147, v146, 16
    v_alignbit_b32 v45, v148, v147, 16
    v_alignbit_b32 v46, v149, v148, 16
    v_alignbit_b32 v47, v150, v149, 16
    ds_write_b128 v4, v[142:145] offset:16640
    ds_write_b128 v4, v[146:149] offset:24960
    ds_write_b128 v4, v[40:43] offset:20800
    ds_write_b128 v4, v[44:47] offset:29120
    v_readfirstlane_b32 s58, v142
    v_readfirstlane_b32 s59, v143
    buffer_load_dwordx2 v[48:49], v189, s[16:19], s37 offen sc1
    s_cmp_lg_u32 s44, 0
    s_cbranch_scc1 LL_nohead
    v_bfe_u32 v32, v3, 4, 1
    v_bfe_u32 v33, v3, 2, 2
    v_and_b32 v34, 3, v3
    v_mul_u32_u24 v35, 16640, v32
    v_mul_u32_u24 v36, 4160, v33
    v_lshl_add_u32 v35, v34, 4, v35
    v_add_u32 v35, v35, v36
    v_add_u32 v35, 114688, v35
    v_cmp_eq_u32 vcc, 1, v32
    v_mov_b32 v36, s54
    v_mov_b32 v37, s55
    v_mov_b32 v38, s58
    v_mov_b32 v39, s59
    v_cndmask_b32 v36, v36, v38, vcc
    v_cndmask_b32 v37, v37, v39, vcc
    v_lshlrev_b32 v38, 4, v33
    v_sub_u32 v38, 64, v38
    v_lshlrev_b64 v[36:37], v38, v[36:37]
    v_cmp_eq_u32 vcc, 3, v34
    v_cmp_ne_u32 s[54:55], 0, v33
    s_and_b64 vcc, vcc, s[54:55]
    v_cndmask_b32 v158, 0, v36, vcc
    v_cndmask_b32 v159, 0, v37, vcc
    ds_write_b128 v35, v[156:159]
LL_nohead:
    s_mul_i32 s54, s41, 8960
    s_add_u32 s55, s54, 22024576
    s_add_u32 s54, s54, 22020096
    v_lshrrev_b32 v26, 1, v0
    v_lshlrev_b32 v24, 3, v26
    s_cmp_lt_u32 s43, 24
    s_cselect_b32 s58, 24576, 0
    v_mul_u32_u24 v25, s58, v26
    v_and_b32 v26, 1, v0
    v_lshlrev_b32 v26, 4, v26
    s_min_u32 s60, s43, 23
    s_mul_i32 s58, s42, 24
    s_add_u32 s58, s58, s60
    s_lshl_b32 s58, s58, 5
    v_add3_u32 v25, s58, v25, v26
    v_add_u32 v26, 6144, v25
    v_add_u32 v28, 12288, v25
    v_add_u32 v29, 18432, v25
    v_and_b32 v7, 7, v3
    v_lshrrev_b32 v6, 3, v3
    v_lshlrev_b32 v6, 9, v6
    v_lshl_add_u32 v233, v7, 4, v6
    s_lshl_b32 s60, s44, 13
    v_add_u32 v6, s60, v6
    v_lshl_add_u32 v232, v7, 2, v6
    s_mul_i32 s60, s44, 8960
    v_add_u32 v233, s60, v233
    v_lshrrev_b32 v6, 5, v3
    v_and_b32 v27, 31, v3
    v_lshlrev_b32 v27, 4, v27
    v_lshl_add_u32 v27, v6, 10, v27
    v_lshrrev_b32 v6, 3, v0
    v_and_b32 v7, 7, v0
    v_lshlrev_b32 v231, 15, v6
    v_lshl_add_u32 v231, v7, 4, v231
    s_lshl_b32 s58, s41, 7
    v_add_u32 v231, s58, v231
    v_mul_u32_u24 v230, 80, v6
    v_lshl_add_u32 v230, v7, 3, v230
    v_add_u32 v230, 49152, v230
    v_mul_u32_u24 v6, 96, v6
    v_lshl_add_u32 v6, v7, 3, v6
    v_sub_u32 v188, 151000, v6
    v_mov_b32 v40, -1
    v_mov_b32 v41, -1
    v_mov_b32 v42, -1
    v_mov_b32 v43, -1
    s_mov_b32 s94, 4194304
    s_mov_b32 s95, 5242880
    s_lshr_b32 s58, s41, 2
    s_lshl_b32 s96, s58, 15
    s_and_b32 s60, s41, 3
    s_lshl_b32 s61, s60, 5
    s_add_u32 s98, s96, s61
    s_add_u32 s98, s98, 4194304
    s_lshl_b32 s61, s60, 7
    s_mul_i32 s96, s58, 35840
    s_add_u32 s96, s96, s61
    s_add_u32 s96, s96, 22020096
    s_lshl_b32 s58, s58, 7
    s_lshl_b32 s60, s60, 4
    s_add_u32 s58, s58, s60
    s_lshl_b32 s60, s44, 2
    s_add_u32 s58, s58, s60
    s_add_u32 s99, s58, 7094272
    v_lshrrev_b32 v5, 2, v0
    v_and_b32 v6, 3, v0
    v_mul_u32_u24 v5, 96, v5
    v_lshl_add_u32 v5, v6, 4, v5
    v_add_u32 v5, 114688, v5
    s_waitcnt vmcnt(0)
    v_xor_b32 v48, s36, v48
    v_xor_b32 v49, s36, v49
    v_or_b32 v48, v48, v49
    v_cmp_ne_u32 vcc, 0, v48
    s_cbranch_vccnz LL_slow0
LL_back0:
    buffer_load_dwordx4 v[48:51], v1, s[16:19], s54 offen
    buffer_load_dwordx4 v[52:55], v1, s[16:19], s55 offen
    v_lshrrev_b32 v4, 3, v3
    v_bfe_u32 v7, v3, 1, 2
    v_bfe_u32 v6, v3, 4, 1
    s_lshl_b32 s54, s50, 1
    v_or_b32 v6, s54, v6
    v_xor_b32 v7, v7, v6
    v_mul_u32_u24 v4, 3584, v4
    v_lshl_add_u32 v4, v7, 5, v4
    v_and_b32 v7, 1, v3
    v_lshl_add_u32 v4, v7, 4, v4
    s_lshl_b32 s54, s45, 7
    v_add_u32 v224, s54, v4
    v_add_u32 v225, 27648, v224
    v_add_u32 v226, 55296, v224
    v_add_u32 v227, 82944, v224
    s_lshl_b32 s48, s50, 16
    s_lshl_b32 s54, s51, 12
    s_add_u32 s48, s48, s54
    s_mul_i32 s38, s51, 114688
    s_lshl_b32 s39, s51, 5
    s_mov_b32 s62, 0x0f0f0f0f
    s_mov_b32 s63, 0x0f0f0f0f
    s_and_b32 s54, s46, 1
    s_lshl_b32 s55, s54, 13
    s_mul_i32 s54, s54, 229376
    s_add_u32 s32, s48, s55
    s_sub_u32 s33, s48, s55
    s_add_u32 s34, s38, s54
    s_sub_u32 s35, s38, s54
    s_mul_i32 s55, s55, 3
    s_mul_i32 s54, s54, 3
    s_add_u32 s4, s48, s55
    s_sub_u32 s5, s48, s55
    s_add_u32 s6, s38, s54
    s_sub_u32 s7, s38, s54
    v_add_u32 v62, 1, v60
    v_and_b32 v63, 3, v62
    v_and_b32 v62, 28, v62
    v_mul_u32_u24 v63, 4160, v63
    v_lshl_add_u32 v63, v62, 1, v63
    v_lshl_add_u32 v63, v61, 4, v63
    s_mul_i32 s54, s50, 16640
    s_add_u32 s54, s54, s39
    s_add_u32 s54, s54, 114688
    v_add_u32 v63, s54, v63
    v_sub_u32 v62, 15, v60
    v_mul_u32_u24 v62, 96, v62
    s_mul_i32 s54, s50, 7584
    s_add_u32 s54, s54, 147968
    v_add_u32 v62, s54, v62
    v_lshl_add_u32 v62, v61, 4, v62
    s_mov_b32 s28, s12
    s_and_b32 s29, s13, 0xffff
    s_mov_b32 s30, 0x1c0000
    s_mov_b32 s31, 0x00020000
    s_mul_i32 s54, s45, 98304
    s_mul_i32 s55, s50, 49152
    s_add_u32 s54, s54, s55
    s_mul_i32 s55, s51, 6144
    s_add_u32 s54, s54, s55
    s_add_u32 s54, s54, 9437184
    s_and_b32 s55, s46, 1
    s_mul_i32 s55, s55, 3072
    v_lshlrev_b32 v6, 4, v3
    v_add_u32 v6, s54, v6
    v_add_u32 v238, s55, v6
    v_subrev_u32 v239, s55, v6
    v_add_u32 v239, 3072, v239
    s_waitcnt vmcnt(0)
    ds_write_b128 v5, v[48:51] offset:33280
    ds_write_b128 v5, v[52:55] offset:40864
    v_mov_b32 v128, 0
    v_mov_b32 v129, 0
    v_mov_b32 v130, 0
    v_mov_b32 v131, 0
    v_mov_b32 v132, 0
    v_mov_b32 v133, 0
    v_mov_b32 v134, 0
    v_mov_b32 v135, 0
    v_mov_b32 v136, 0
    v_mov_b32 v137, 0
    v_mov_b32 v138, 0
    v_mov_b32 v139, 0
    v_mov_b32 v140, 0
    v_mov_b32 v141, 0
    v_mov_b32 v142, 0
    v_mov_b32 v143, 0
    s_and_b32 s75, s47, s40
    s_lshl_b32 s74, s47, 16
    s_waitcnt lgkmcnt(0)
    s_barrier
    ds_read_b64 v[48:49], v188 offset:0
    ds_read_b64 v[50:51], v188 offset:3072
    ds_read_b64 v[52:53], v188 offset:7584
    ds_read_b64 v[54:55], v188 offset:10656
    ds_read_b64 v[64:65], v63 offset:0
    ds_read_b64 v[66:67], v63 offset:8
    ds_read_b128 v[80:83], v62 offset:4608
    ds_read_b128 v[84:87], v62 offset:3072
    ds_read_b64 v[68:69], v63 offset:1024
    ds_read_b64 v[70:71], v63 offset:1032
    ds_read_b128 v[88:91], v62 offset:1536
    ds_read_b64 v[72:73], v63 offset:2048
    ds_read_b64 v[74:75], v63 offset:2056
    ds_read_b128 v[92:95], v62 offset:0
    ds_read_b64 v[76:77], v63 offset:3072
    s_waitcnt lgkmcnt(11)
    ds_read_b64 v[78:79], v63 offset:3080
    global_load_dwordx2 v[168:169], v24, s[66:67]
    global_load_dwordx4 v[144:147], v25, s[72:73]
    global_load_dwordx4 v[148:151], v26, s[72:73]
    global_load_dwordx4 v[152:155], v28, s[72:73]
    global_load_dwordx4 v[156:159], v29, s[72:73]
    buffer_store_dwordx4 v[40:43], v231, s[16:19], s94 offen sc1
    buffer_store_dwordx4 v[40:43], v231, s[16:19], s95 offen sc1
    s_waitcnt lgkmcnt(9)
    v_mfma_f32_16x16x32_bf16 v[128:131], v[64:67], v[80:83], v[128:131]
    ds_read_b64 v[96:97], v63 offset:64
    ds_read_b64 v[98:99], v63 offset:72
    v_lshrrev_b32 v228, 4, v3
    s_waitcnt lgkmcnt(10)
    v_mfma_f32_16x16x32_bf16 v[132:135], v[64:67], v[84:87], v[132:135]
    ds_read_b128 v[112:115], v62 offset:4704
    v_and_b32 v190, 1, v3
    v_lshl_add_u32 v228, v190, 2, v228
    s_waitcnt lgkmcnt(9)
    v_mfma_f32_16x16x32_bf16 v[132:135], v[68:71], v[80:83], v[132:135]
    ds_read_b128 v[116:119], v62 offset:3168
    v_lshlrev_b32 v228, 3, v228
    s_lshl_b32 s58, s44, 6
    s_waitcnt lgkmcnt(9)
    v_mfma_f32_16x16x32_bf16 v[136:139], v[64:67], v[88:91], v[136:139]
    ds_read_b64 v[100:101], v63 offset:1088
    ds_read_b64 v[102:103], v63 offset:1096
    v_mfma_f32_16x16x32_bf16 v[136:139], v[68:71], v[84:87], v[136:139]
    ds_read_b128 v[120:123], v62 offset:1632
    s_add_u32 s58, s58, 163136
    v_add_u32 v228, s58, v228
    s_waitcnt lgkmcnt(10)
    v_mfma_f32_16x16x32_bf16 v[136:139], v[72:75], v[80:83], v[136:139]
    ds_read_b64 v[104:105], v63 offset:2112
    v_and_b32 v190, 7, v3
    v_lshlrev_b32 v190, 3, v190
    s_waitcnt lgkmcnt(10)
    v_mfma_f32_16x16x32_bf16 v[140:143], v[64:67], v[92:95], v[140:143]
    ds_read_b64 v[106:107], v63 offset:2120
    v_add_u32 v191, 163136, v190
    s_mul_i32 s61, s42, 24
    v_mfma_f32_16x16x32_bf16 v[140:143], v[68:71], v[88:91], v[140:143]
    ds_read_b128 v[124:127], v62 offset:96
    s_add_u32 s61, s61, s43
    s_lshl_b32 s61, s61, 6
    v_mfma_f32_16x16x32_bf16 v[140:143], v[72:75], v[84:87], v[140:143]
    ds_read_b64 v[108:109], v63 offset:3136
    s_lshl_b32 s58, s42, 3
    s_add_u32 s58, s58, s43
    s_waitcnt lgkmcnt(11)
    v_mfma_f32_16x16x32_bf16 v[140:143], v[76:79], v[80:83], v[140:143]
    ds_read_b64 v[110:111], v63 offset:3144
    s_waitcnt lgkmcnt(9)
    v_mfma_f32_16x16x32_bf16 v[128:131], v[96:99], v[112:115], v[128:131]
    ds_read_b64 v[64:65], v63 offset:128
    ds_read_b64 v[66:67], v63 offset:136
    s_lshl_b32 s58, s58, 3
    s_waitcnt lgkmcnt(10)
    v_mfma_f32_16x16x32_bf16 v[132:135], v[96:99], v[116:119], v[132:135]
    ds_read_b128 v[80:83], v62 offset:4800
    s_add_u32 s58, s58, 12096
    s_cmp_lt_u32 s43, 24
    s_cselect_b32 s61, s61, s58
    s_cselect_b32 s58, 1, 0
    s_waitcnt lgkmcnt(9)
    v_mfma_f32_16x16x32_bf16 v[132:135], v[100:103], v[112:115], v[132:135]
    ds_read_b128 v[84:87], v62 offset:3264
    v_mul_u32_u24 v190, s58, v190
    s_add_u32 s61, s61, 6356992
    s_waitcnt lgkmcnt(9)
    v_mfma_f32_16x16x32_bf16 v[136:139], v[96:99], v[120:123], v[136:139]
    ds_read_b64 v[68:69], v63 offset:1152
    ds_read_b64 v[70:71], v63 offset:1160
    s_mov_b32 s55, 0xbfb8aa3b
    v_mfma_f32_16x16x32_bf16 v[136:139], v[100:103], v[116:119], v[136:139]
    ds_read_b128 v[88:91], v62 offset:1728
    v_lshlrev_b32 v15, 16, v48
    v_and_b32 v14, s40, v48
    s_waitcnt lgkmcnt(10)
    v_mfma_f32_16x16x32_bf16 v[136:139], v[104:107], v[112:115], v[136:139]
    ds_read_b64 v[72:73], v63 offset:2176
    global_load_dwordx4 v[160:163], v196, s[56:57]
    global_load_dwordx4 v[164:167], v196, s[56:57] offset:128
    s_waitcnt lgkmcnt(10)
    v_mfma_f32_16x16x32_bf16 v[140:143], v[96:99], v[124:127], v[140:143]
    ds_read_b64 v[74:75], v63 offset:2184
    v_lshlrev_b32 v13, 16, v49
    v_and_b32 v12, s40, v49
    v_mfma_f32_16x16x32_bf16 v[140:143], v[100:103], v[120:123], v[140:143]
    ds_read_b128 v[92:95], v62 offset:192
    v_lshlrev_b32 v11, 16, v50
    v_and_b32 v10, s40, v50
    v_mfma_f32_16x16x32_bf16 v[140:143], v[104:107], v[116:119], v[140:143]
    ds_read_b64 v[76:77], v63 offset:3200
    v_lshlrev_b32 v9, 16, v51
    v_and_b32 v8, s40, v51
    s_waitcnt lgkmcnt(11)
    v_mfma_f32_16x16x32_bf16 v[140:143], v[108:111], v[112:115], v[140:143]
    ds_read_b64 v[78:79], v63 offset:3208
    v_lshlrev_b32 v23, 16, v52
    v_and_b32 v22, s40, v52
    s_waitcnt lgkmcnt(9)
    v_mfma_f32_16x16x32_bf16 v[128:131], v[64:67], v[80:83], v[128:131]
    ds_read_b64 v[96:97], v63 offset:192
    ds_read_b64 v[98:99], v63 offset:200
    v_lshlrev_b32 v21, 16, v53
    s_waitcnt lgkmcnt(10)
    v_mfma_f32_16x16x32_bf16 v[132:135], v[64:67], v[84:87], v[132:135]
    ds_read_b128 v[112:115], v62 offset:4896
    v_and_b32 v20, s40, v53
    v_lshlrev_b32 v19, 16, v54
    s_waitcnt lgkmcnt(9)
    v_mfma_f32_16x16x32_bf16 v[132:135], v[68:71], v[80:83], v[132:135]
    ds_read_b128 v[116:119], v62 offset:3360
    v_and_b32 v18, s40, v54
    v_lshlrev_b32 v17, 16, v55
    s_waitcnt lgkmcnt(9)
    v_mfma_f32_16x16x32_bf16 v[136:139], v[64:67], v[88:91], v[136:139]
    ds_read_b64 v[100:101], v63 offset:1216
    ds_read_b64 v[102:103], v63 offset:1224
    v_and_b32 v16, s40, v55
    v_mfma_f32_16x16x32_bf16 v[136:139], v[68:71], v[84:87], v[136:139]
    ds_read_b128 v[120:123], v62 offset:1824
    v_mul_f32 v8, s74, v8
    v_mul_f32 v9, s74, v9
    s_waitcnt lgkmcnt(10)
    v_mfma_f32_16x16x32_bf16 v[136:139], v[72:75], v[80:83], v[136:139]
    ds_read_b64 v[104:105], v63 offset:2240
    v_mul_f32 v10, s74, v10
    v_mul_f32 v11, s74, v11
    s_waitcnt lgkmcnt(10)
    v_mfma_f32_16x16x32_bf16 v[140:143], v[64:67], v[92:95], v[140:143]
    ds_read_b64 v[106:107], v63 offset:2248
    v_mul_f32 v12, s74, v12
    v_mul_f32 v13, s74, v13
    v_mfma_f32_16x16x32_bf16 v[140:143], v[68:71], v[88:91], v[140:143]
    ds_read_b128 v[124:127], v62 offset:288
    v_mul_f32 v14, s74, v14
    v_mul_f32 v15, s74, v15
    v_mfma_f32_16x16x32_bf16 v[140:143], v[72:75], v[84:87], v[140:143]
    ds_read_b64 v[108:109], v63 offset:3264
    v_mul_f32 v16, s75, v16
    v_mul_f32 v17, s75, v17
    s_waitcnt lgkmcnt(11)
    v_mfma_f32_16x16x32_bf16 v[140:143], v[76:79], v[80:83], v[140:143]
    ds_read_b64 v[110:111], v63 offset:3272
    s_waitcnt vmcnt(4)
    s_mov_b32 s66, 0x3f803f80
    s_waitcnt lgkmcnt(9)
    v_mfma_f32_16x16x32_bf16 v[128:131], v[96:99], v[112:115], v[128:131]
    ds_read_b64 v[64:65], v63 offset:256
    ds_read_b64 v[66:67], v63 offset:264
    v_lshlrev_b32 v170, 16, v168
    s_waitcnt lgkmcnt(10)
    v_mfma_f32_16x16x32_bf16 v[132:135], v[96:99], v[116:119], v[132:135]
    ds_read_b128 v[80:83], v62 offset:4992
    v_and_b32 v171, s40, v168
    v_lshlrev_b32 v172, 16, v169
    s_waitcnt lgkmcnt(9)
    v_mfma_f32_16x16x32_bf16 v[132:135], v[100:103], v[112:115], v[132:135]
    ds_read_b128 v[84:87], v62 offset:3456
    v_and_b32 v173, s40, v169
    v_mul_f32 v174, s55, v170
    s_waitcnt lgkmcnt(9)
    v_mfma_f32_16x16x32_bf16 v[136:139], v[96:99], v[120:123], v[136:139]
    ds_read_b64 v[68:69], v63 offset:1280
    ds_read_b64 v[70:71], v63 offset:1288
    v_mul_f32 v175, s55, v171
    v_mfma_f32_16x16x32_bf16 v[136:139], v[100:103], v[116:119], v[136:139]
    ds_read_b128 v[88:91], v62 offset:1920
    v_mul_f32 v176, s55, v172
    v_mul_f32 v177, s55, v173
    s_waitcnt lgkmcnt(10)
    v_mfma_f32_16x16x32_bf16 v[136:139], v[104:107], v[112:115], v[136:139]
    ds_read_b64 v[72:73], v63 offset:2304
    v_exp_f32 v174, v174
    v_exp_f32 v175, v175
    s_waitcnt lgkmcnt(10)
    v_mfma_f32_16x16x32_bf16 v[140:143], v[96:99], v[124:127], v[140:143]
    ds_read_b64 v[74:75], v63 offset:2312
    v_exp_f32 v176, v176
    v_exp_f32 v177, v177
    v_mfma_f32_16x16x32_bf16 v[140:143], v[100:103], v[120:123], v[140:143]
    ds_read_b128 v[92:95], v62 offset:384
    v_perm_b32 v178, v148, v144, s52
    v_perm_b32 v179, v148, v144, s53
    v_mfma_f32_16x16x32_bf16 v[140:143], v[104:107], v[116:119], v[140:143]
    ds_read_b64 v[76:77], v63 offset:3328
    v_add_f32 v174, 1.0, v174
    v_add_f32 v175, 1.0, v175
    s_waitcnt lgkmcnt(11)
    v_mfma_f32_16x16x32_bf16 v[140:143], v[108:111], v[112:115], v[140:143]
    ds_read_b64 v[78:79], v63 offset:3336
    v_add_f32 v176, 1.0, v176
    v_add_f32 v177, 1.0, v177
    s_waitcnt lgkmcnt(9)
    v_mfma_f32_16x16x32_bf16 v[128:131], v[64:67], v[80:83], v[128:131]
    ds_read_b64 v[96:97], v63 offset:320
    ds_read_b64 v[98:99], v63 offset:328
    v_rcp_f32 v174, v174
    s_waitcnt lgkmcnt(10)
    v_mfma_f32_16x16x32_bf16 v[132:135], v[64:67], v[84:87], v[132:135]
    ds_read_b128 v[112:115], v62 offset:5088
    v_rcp_f32 v175, v175
    v_rcp_f32 v176, v176
    s_waitcnt lgkmcnt(9)
    v_mfma_f32_16x16x32_bf16 v[132:135], v[68:71], v[80:83], v[132:135]
    ds_read_b128 v[116:119], v62 offset:3552
    v_rcp_f32 v177, v177
    v_perm_b32 v180, v149, v145, s52
    s_waitcnt lgkmcnt(9)
    v_mfma_f32_16x16x32_bf16 v[136:139], v[64:67], v[88:91], v[136:139]
    ds_read_b64 v[100:101], v63 offset:1344
    ds_read_b64 v[102:103], v63 offset:1352
    v_perm_b32 v181, v149, v145, s53
    v_mfma_f32_16x16x32_bf16 v[136:139], v[68:71], v[84:87], v[136:139]
    ds_read_b128 v[120:123], v62 offset:2016
    v_mul_f32 v170, v170, v174
    v_mul_f32 v171, v171, v175
    s_waitcnt lgkmcnt(10)
    v_mfma_f32_16x16x32_bf16 v[136:139], v[72:75], v[80:83], v[136:139]
    ds_read_b64 v[104:105], v63 offset:2368
    v_mul_f32 v172, v172, v176
    v_mul_f32 v173, v173, v177
    s_waitcnt lgkmcnt(10)
    v_mfma_f32_16x16x32_bf16 v[140:143], v[64:67], v[92:95], v[140:143]
    ds_read_b64 v[106:107], v63 offset:2376
    v_cvt_pk_bf16_f32 v168, v170, v171
    v_cvt_pk_bf16_f32 v169, v172, v173
    v_mfma_f32_16x16x32_bf16 v[140:143], v[68:71], v[88:91], v[140:143]
    ds_read_b128 v[124:127], v62 offset:480
    v_perm_b32 v182, v150, v146, s52
    v_perm_b32 v183, v150, v146, s53
    v_mfma_f32_16x16x32_bf16 v[140:143], v[72:75], v[84:87], v[140:143]
    ds_read_b64 v[108:109], v63 offset:3392
    v_perm_b32 v184, v151, v147, s52
    v_perm_b32 v185, v151, v147, s53
    s_waitcnt lgkmcnt(11)
    v_mfma_f32_16x16x32_bf16 v[140:143], v[76:79], v[80:83], v[140:143]
    ds_read_b64 v[110:111], v63 offset:3400
    v_perm_b32 v170, v156, v152, s52
    v_perm_b32 v171, v156, v152, s53
    s_waitcnt lgkmcnt(9)
    v_mfma_f32_16x16x32_bf16 v[128:131], v[96:99], v[112:115], v[128:131]
    ds_read_b64 v[64:65], v63 offset:384
    ds_read_b64 v[66:67], v63 offset:392
    v_perm_b32 v172, v157, v153, s52
    s_waitcnt lgkmcnt(10)
    v_mfma_f32_16x16x32_bf16 v[132:135], v[96:99], v[116:119], v[132:135]
    ds_read_b128 v[80:83], v62 offset:5184
    v_perm_b32 v173, v157, v153, s53
    v_perm_b32 v174, v158, v154, s52
    s_waitcnt lgkmcnt(9)
    v_mfma_f32_16x16x32_bf16 v[132:135], v[100:103], v[112:115], v[132:135]
    ds_read_b128 v[84:87], v62 offset:3648
    v_perm_b32 v175, v158, v154, s53
    v_perm_b32 v176, v159, v155, s52
    s_waitcnt lgkmcnt(9)
    v_mfma_f32_16x16x32_bf16 v[136:139], v[96:99], v[120:123], v[136:139]
    ds_read_b64 v[68:69], v63 offset:1408
    ds_read_b64 v[70:71], v63 offset:1416
    v_perm_b32 v177, v159, v155, s53
    v_mfma_f32_16x16x32_bf16 v[136:139], v[100:103], v[116:119], v[136:139]
    ds_read_b128 v[88:91], v62 offset:2112
    v_dot2_f32_bf16 v178, v178, v168, 0
    v_dot2_f32_bf16 v179, v179, v168, 0
    s_waitcnt lgkmcnt(10)
    v_mfma_f32_16x16x32_bf16 v[136:139], v[104:107], v[112:115], v[136:139]
    ds_read_b64 v[72:73], v63 offset:2432
    v_dot2_f32_bf16 v180, v180, v168, 0
    v_dot2_f32_bf16 v181, v181, v168, 0
    s_waitcnt lgkmcnt(10)
    v_mfma_f32_16x16x32_bf16 v[140:143], v[96:99], v[124:127], v[140:143]
    ds_read_b64 v[74:75], v63 offset:2440
    v_dot2_f32_bf16 v182, v182, v168, 0
    v_dot2_f32_bf16 v183, v183, v168, 0
    v_mfma_f32_16x16x32_bf16 v[140:143], v[100:103], v[120:123], v[140:143]
    ds_read_b128 v[92:95], v62 offset:576
    v_dot2_f32_bf16 v184, v184, v168, 0
    v_dot2_f32_bf16 v185, v185, v168, 0
    v_mfma_f32_16x16x32_bf16 v[140:143], v[104:107], v[116:119], v[140:143]
    ds_read_b64 v[76:77], v63 offset:3456
    v_dot2_f32_bf16 v178, v170, v169, v178
    v_dot2_f32_bf16 v179, v171, v169, v179
    s_waitcnt lgkmcnt(11)
    v_mfma_f32_16x16x32_bf16 v[140:143], v[108:111], v[112:115], v[140:143]
    ds_read_b64 v[78:79], v63 offset:3464
    v_dot2_f32_bf16 v180, v172, v169, v180
    v_dot2_f32_bf16 v181, v173, v169, v181
    s_waitcnt lgkmcnt(9)
    v_mfma_f32_16x16x32_bf16 v[128:131], v[64:67], v[80:83], v[128:131]
    ds_read_b64 v[96:97], v63 offset:448
    ds_read_b64 v[98:99], v63 offset:456
    v_dot2_f32_bf16 v182, v174, v169, v182
    s_waitcnt lgkmcnt(10)
    v_mfma_f32_16x16x32_bf16 v[132:135], v[64:67], v[84:87], v[132:135]
    ds_read_b128 v[112:115], v62 offset:5280
    v_dot2_f32_bf16 v183, v175, v169, v183
    v_dot2_f32_bf16 v184, v176, v169, v184
    s_waitcnt lgkmcnt(9)
    v_mfma_f32_16x16x32_bf16 v[132:135], v[68:71], v[80:83], v[132:135]
    ds_read_b128 v[116:119], v62 offset:3744
    v_dot2_f32_bf16 v185, v177, v169, v185
    s_nop 2
    s_waitcnt lgkmcnt(9)
    v_mfma_f32_16x16x32_bf16 v[136:139], v[64:67], v[88:91], v[136:139]
    ds_read_b64 v[100:101], v63 offset:1472
    ds_read_b64 v[102:103], v63 offset:1480
    v_permlane32_swap_b32 v178, v182
    v_mfma_f32_16x16x32_bf16 v[136:139], v[68:71], v[84:87], v[136:139]
    ds_read_b128 v[120:123], v62 offset:2208
    v_permlane32_swap_b32 v179, v183
    v_permlane32_swap_b32 v180, v184
    s_waitcnt lgkmcnt(10)
    v_mfma_f32_16x16x32_bf16 v[136:139], v[72:75], v[80:83], v[136:139]
    ds_read_b64 v[104:105], v63 offset:2496
    s_add_u32 m0, s4, 0
    s_add_u32 s101, s6, 0
    buffer_load_dwordx4 v224, s[28:31], s101 offen offset:0 lds
    s_waitcnt lgkmcnt(10)
    v_mfma_f32_16x16x32_bf16 v[140:143], v[64:67], v[92:95], v[140:143]
    ds_read_b64 v[106:107], v63 offset:2504
    v_permlane32_swap_b32 v181, v185
    v_add_f32 v178, v178, v182
    v_mfma_f32_16x16x32_bf16 v[140:143], v[68:71], v[88:91], v[140:143]
    ds_read_b128 v[124:127], v62 offset:672
    v_add_f32 v179, v179, v183
    v_add_f32 v180, v180, v184
    v_mfma_f32_16x16x32_bf16 v[140:143], v[72:75], v[84:87], v[140:143]
    ds_read_b64 v[108:109], v63 offset:3520
    v_add_f32 v181, v181, v185
    s_nop 1
    s_waitcnt lgkmcnt(11)
    v_mfma_f32_16x16x32_bf16 v[140:143], v[76:79], v[80:83], v[140:143]
    ds_read_b64 v[110:111], v63 offset:3528
    v_permlane16_swap_b32 v178, v180
    v_permlane16_swap_b32 v179, v181
    s_waitcnt lgkmcnt(9)
    v_mfma_f32_16x16x32_bf16 v[128:131], v[96:99], v[112:115], v[128:131]
    ds_read_b64 v[64:65], v63 offset:512
    ds_read_b64 v[66:67], v63 offset:520
    s_nop 0
    s_waitcnt lgkmcnt(10)
    v_mfma_f32_16x16x32_bf16 v[132:135], v[96:99], v[116:119], v[132:135]
    ds_read_b128 v[80:83], v62 offset:5376
    v_add_f32 v178, v178, v180
    v_add_f32 v179, v179, v181
    s_waitcnt lgkmcnt(9)
    v_mfma_f32_16x16x32_bf16 v[132:135], v[100:103], v[112:115], v[132:135]
    ds_read_b128 v[84:87], v62 offset:3840
    s_nop 0
    v_add_f32_dpp v178, v178, v178 row_shr:2 row_mask:0xf bank_mask:0xf bound_ctrl:0
    s_waitcnt lgkmcnt(9)
    v_mfma_f32_16x16x32_bf16 v[136:139], v[96:99], v[120:123], v[136:139]
    ds_read_b64 v[68:69], v63 offset:1536
    ds_read_b64 v[70:71], v63 offset:1544
    buffer_load_dwordx4 v225, s[28:31], s101 offen offset:1024 lds
    v_mfma_f32_16x16x32_bf16 v[136:139], v[100:103], v[116:119], v[136:139]
    ds_read_b128 v[88:91], v62 offset:2304
    v_add_f32_dpp v179, v179, v179 row_shr:2 row_mask:0xf bank_mask:0xf bound_ctrl:0
    s_nop 0
    s_waitcnt lgkmcnt(10)
    v_mfma_f32_16x16x32_bf16 v[136:139], v[104:107], v[112:115], v[136:139]
    ds_read_b64 v[72:73], v63 offset:2560
    v_add_f32_dpp v178, v178, v178 row_shr:4 row_mask:0xf bank_mask:0xf bound_ctrl:0
    v_add_f32_dpp v179, v179, v179 row_shr:4 row_mask:0xf bank_mask:0xf bound_ctrl:0
    s_waitcnt lgkmcnt(10)
    v_mfma_f32_16x16x32_bf16 v[140:143], v[96:99], v[124:127], v[140:143]
    ds_read_b64 v[74:75], v63 offset:2568
    s_nop 0
    v_add_f32_dpp v178, v178, v178 row_shr:8 row_mask:0xf bank_mask:0xf bound_ctrl:0
    v_mfma_f32_16x16x32_bf16 v[140:143], v[100:103], v[120:123], v[140:143]
    ds_read_b128 v[92:95], v62 offset:768
    v_add_f32_dpp v179, v179, v179 row_shr:8 row_mask:0xf bank_mask:0xf bound_ctrl:0
    v_mul_f32 v18, s75, v18
    v_mfma_f32_16x16x32_bf16 v[140:143], v[104:107], v[116:119], v[140:143]
    ds_read_b64 v[76:77], v63 offset:3584
    v_mul_f32 v19, s75, v19
    v_mul_f32 v20, s75, v20
    s_waitcnt lgkmcnt(11)
    v_mfma_f32_16x16x32_bf16 v[140:143], v[108:111], v[112:115], v[140:143]
    ds_read_b64 v[78:79], v63 offset:3592
    v_mul_f32 v21, s75, v21
    v_mul_f32 v22, s75, v22
    s_waitcnt lgkmcnt(9)
    v_mfma_f32_16x16x32_bf16 v[128:131], v[64:67], v[80:83], v[128:131]
    ds_read_b64 v[96:97], v63 offset:576
    ds_read_b64 v[98:99], v63 offset:584
    v_mul_f32 v23, s75, v23
    s_waitcnt lgkmcnt(10)
    v_mfma_f32_16x16x32_bf16 v[132:135], v[64:67], v[84:87], v[132:135]
    ds_read_b128 v[112:115], v62 offset:5472
    buffer_load_dwordx4 v226, s[28:31], s101 offen offset:2048 lds
    s_waitcnt lgkmcnt(9)
    v_mfma_f32_16x16x32_bf16 v[132:135], v[68:71], v[80:83], v[132:135]
    ds_read_b128 v[116:119], v62 offset:3936
    v_cvt_pk_bf16_f32 v8, 0, v8
    v_cvt_pk_bf16_f32 v9, 0, v9
    s_waitcnt lgkmcnt(9)
    v_mfma_f32_16x16x32_bf16 v[136:139], v[64:67], v[88:91], v[136:139]
    ds_read_b64 v[100:101], v63 offset:1600
    ds_read_b64 v[102:103], v63 offset:1608
    v_cvt_pk_bf16_f32 v10, 0, v10
    v_mfma_f32_16x16x32_bf16 v[136:139], v[68:71], v[84:87], v[136:139]
    ds_read_b128 v[120:123], v62 offset:2400
    v_cvt_pk_bf16_f32 v11, 0, v11
    v_cvt_pk_bf16_f32 v12, 0, v12
    s_waitcnt lgkmcnt(10)
    v_mfma_f32_16x16x32_bf16 v[136:139], v[72:75], v[80:83], v[136:139]
    ds_read_b64 v[104:105], v63 offset:2624
    v_cvt_pk_bf16_f32 v13, 0, v13
    v_cvt_pk_bf16_f32 v14, 0, v14
    s_waitcnt lgkmcnt(10)
    v_mfma_f32_16x16x32_bf16 v[140:143], v[64:67], v[92:95], v[140:143]
    ds_read_b64 v[106:107], v63 offset:2632
    v_cvt_pk_bf16_f32 v15, 0, v15
    v_cvt_pk_bf16_f32 v16, 0, v16
    v_mfma_f32_16x16x32_bf16 v[140:143], v[68:71], v[88:91], v[140:143]
    ds_read_b128 v[124:127], v62 offset:864
    v_cvt_pk_bf16_f32 v17, 0, v17
    v_cvt_pk_bf16_f32 v18, 0, v18
    v_mfma_f32_16x16x32_bf16 v[140:143], v[72:75], v[84:87], v[140:143]
    ds_read_b64 v[108:109], v63 offset:3648
    v_cvt_pk_bf16_f32 v19, 0, v19
    v_cvt_pk_bf16_f32 v20, 0, v20
    s_waitcnt lgkmcnt(11)
    v_mfma_f32_16x16x32_bf16 v[140:143], v[76:79], v[80:83], v[140:143]
    ds_read_b64 v[110:111], v63 offset:3656
    buffer_load_dwordx4 v227, s[28:31], s101 offen offset:3072 lds
    s_waitcnt lgkmcnt(9)
    v_mfma_f32_16x16x32_bf16 v[128:131], v[96:99], v[112:115], v[128:131]
    ds_read_b64 v[64:65], v63 offset:640
    ds_read_b64 v[66:67], v63 offset:648
    v_cvt_pk_bf16_f32 v21, 0, v21
    s_waitcnt lgkmcnt(10)
    v_mfma_f32_16x16x32_bf16 v[132:135], v[96:99], v[116:119], v[132:135]
    ds_read_b128 v[80:83], v62 offset:5568
    v_cvt_pk_bf16_f32 v22, 0, v22
    v_cvt_pk_bf16_f32 v23, 0, v23
    s_waitcnt lgkmcnt(9)
    v_mfma_f32_16x16x32_bf16 v[132:135], v[100:103], v[112:115], v[132:135]
    ds_read_b128 v[84:87], v62 offset:4032
    s_mov_b32 exec_lo, 0xc000c000
    s_mov_b32 exec_hi, 0xc000c000
    ds_write_b64 v228, v[178:179]
    s_mov_b64 exec, -1
    s_waitcnt lgkmcnt(9)
    v_mfma_f32_16x16x32_bf16 v[136:139], v[96:99], v[120:123], v[136:139]
    ds_read_b64 v[68:69], v63 offset:1664
    ds_read_b64 v[70:71], v63 offset:1672
    v_mul_u32_u24 v229, 80, v60
    v_mfma_f32_16x16x32_bf16 v[136:139], v[100:103], v[116:119], v[136:139]
    ds_read_b128 v[88:91], v62 offset:2496
    v_lshl_add_u32 v229, v61, 3, v229
    s_mul_i32 s58, s50, 5120
    s_waitcnt lgkmcnt(10)
    v_mfma_f32_16x16x32_bf16 v[136:139], v[104:107], v[112:115], v[136:139]
    ds_read_b64 v[72:73], v63 offset:2688
    s_add_u32 s58, s58, s39
    s_add_u32 s58, s58, 49152
    s_waitcnt lgkmcnt(10)
    v_mfma_f32_16x16x32_bf16 v[140:143], v[96:99], v[124:127], v[140:143]
    ds_read_b64 v[74:75], v63 offset:2696
    v_add_u32 v229, s58, v229
    v_lshlrev_b32 v250, 2, v3
    v_mfma_f32_16x16x32_bf16 v[140:143], v[100:103], v[120:123], v[140:143]
    ds_read_b128 v[92:95], v62 offset:960
    s_add_u32 m0, s4, 8192
    s_add_u32 s101, s6, 229376
    buffer_load_dwordx4 v224, s[28:31], s101 offen offset:0 lds
    v_mfma_f32_16x16x32_bf16 v[140:143], v[104:107], v[116:119], v[140:143]
    ds_read_b64 v[76:77], v63 offset:3712
    s_lshr_b32 s58, s43, 3
    s_add_u32 s58, s58, s43
    s_waitcnt lgkmcnt(11)
    v_mfma_f32_16x16x32_bf16 v[140:143], v[108:111], v[112:115], v[140:143]
    ds_read_b64 v[78:79], v63 offset:3720
    s_and_b32 s58, s58, 3
    s_mul_i32 s20, s58, 14336
    s_waitcnt lgkmcnt(9)
    v_mfma_f32_16x16x32_bf16 v[128:131], v[64:67], v[80:83], v[128:131]
    ds_read_b64 v[96:97], v63 offset:704
    ds_read_b64 v[98:99], v63 offset:712
    s_add_u32 s59, s58, 1
    s_waitcnt lgkmcnt(10)
    v_mfma_f32_16x16x32_bf16 v[132:135], v[64:67], v[84:87], v[132:135]
    ds_read_b128 v[112:115], v62 offset:5664
    s_and_b32 s59, s59, 3
    s_mul_i32 s21, s59, 14336
    s_waitcnt lgkmcnt(9)
    v_mfma_f32_16x16x32_bf16 v[132:135], v[68:71], v[80:83], v[132:135]
    ds_read_b128 v[116:119], v62 offset:4128
    s_waitcnt vmcnt(7)
    s_barrier
    ds_read2_b64 v[168:171], v191 offset1:8
    ds_read2_b64 v[172:175], v191 offset0:16 offset1:24
    s_waitcnt lgkmcnt(9)
    v_mfma_f32_16x16x32_bf16 v[136:139], v[64:67], v[88:91], v[136:139]
    ds_read_b64 v[100:101], v63 offset:1728
    ds_read_b64 v[102:103], v63 offset:1736
    s_xor_b32 s59, s58, 2
    v_mfma_f32_16x16x32_bf16 v[136:139], v[68:71], v[84:87], v[136:139]
    ds_read_b128 v[120:123], v62 offset:2592
    s_mul_i32 s22, s59, 14336
    s_add_u32 s59, s58, 3
    s_waitcnt lgkmcnt(10)
    v_mfma_f32_16x16x32_bf16 v[136:139], v[72:75], v[80:83], v[136:139]
    ds_read_b64 v[104:105], v63 offset:2752
    buffer_load_dwordx4 v225, s[28:31], s101 offen offset:1024 lds
    s_waitcnt lgkmcnt(10)
    v_mfma_f32_16x16x32_bf16 v[140:143], v[64:67], v[92:95], v[140:143]
    ds_read_b64 v[106:107], v63 offset:2760
    s_and_b32 s59, s59, 3
    s_mul_i32 s23, s59, 14336
    v_mfma_f32_16x16x32_bf16 v[140:143], v[68:71], v[88:91], v[140:143]
    ds_read_b128 v[124:127], v62 offset:1056
    s_lshr_b32 s24, s20, 1
    s_lshr_b32 s25, s21, 1
    v_mfma_f32_16x16x32_bf16 v[140:143], v[72:75], v[84:87], v[140:143]
    ds_read_b64 v[108:109], v63 offset:3776
    s_lshr_b32 s26, s22, 1
    s_lshr_b32 s27, s23, 1
    s_waitcnt lgkmcnt(11)
    v_mfma_f32_16x16x32_bf16 v[140:143], v[76:79], v[80:83], v[140:143]
    ds_read_b64 v[110:111], v63 offset:3784
    s_lshl_b32 s47, s46, 2
    s_add_u32 s47, s47, s44
    s_waitcnt lgkmcnt(9)
    v_mfma_f32_16x16x32_bf16 v[128:131], v[96:99], v[112:115], v[128:131]
    ds_read_b64 v[64:65], v63 offset:768
    ds_read_b64 v[66:67], v63 offset:776
    s_mul_i32 s58, s47, 112
    s_waitcnt lgkmcnt(10)
    v_mfma_f32_16x16x32_bf16 v[132:135], v[96:99], v[116:119], v[132:135]
    ds_read_b128 v[80:83], v62 offset:5760
    s_mul_i32 s59, s45, 7
    s_add_u32 s58, s58, s59
    s_waitcnt lgkmcnt(9)
    v_mfma_f32_16x16x32_bf16 v[132:135], v[100:103], v[112:115], v[132:135]
    ds_read_b128 v[84:87], v62 offset:4224
    s_cmp_lg_u32 s44, 3
    s_cbranch_scc1 LL_nomod
    v_pk_add_f32 v[168:169], v[168:169], v[170:171]
    v_pk_add_f32 v[172:173], v[172:173], v[174:175]
    v_pk_add_f32 v[168:169], v[168:169], v[172:173]
    v_cvt_pk_bf16_f32 v192, v168, v169
    s_mov_b64 exec, 0xff
    buffer_store_dwordx2 v[192:193], v190, s[16:19], s61 offen sc1
    s_mov_b64 exec, -1
LL_nomod:
    s_waitcnt lgkmcnt(9)
    v_mfma_f32_16x16x32_bf16 v[136:139], v[96:99], v[120:123], v[136:139]
    ds_read_b64 v[68:69], v63 offset:1792
    ds_read_b64 v[70:71], v63 offset:1800
    buffer_load_dwordx4 v226, s[28:31], s101 offen offset:2048 lds
    v_mfma_f32_16x16x32_bf16 v[136:139], v[100:103], v[116:119], v[136:139]
    ds_read_b128 v[88:91], v62 offset:2688
    s_lshl_b32 s58, s58, 10
    s_add_u32 s97, s58, 11534336
    s_waitcnt lgkmcnt(10)
    v_mfma_f32_16x16x32_bf16 v[136:139], v[104:107], v[112:115], v[136:139]
    ds_read_b64 v[72:73], v63 offset:2816
    v_min_u32 v251, -1, v3
    v_lshlrev_b32 v251, 7, v251
    s_waitcnt lgkmcnt(10)
    v_mfma_f32_16x16x32_bf16 v[140:143], v[96:99], v[124:127], v[140:143]
    ds_read_b64 v[74:75], v63 offset:2824
    s_add_u32 s58, s97, 0
    v_add_u32 v251, s58, v251
    v_mfma_f32_16x16x32_bf16 v[140:143], v[100:103], v[120:123], v[140:143]
    ds_read_b128 v[92:95], v62 offset:1152
    s_and_b32 s58, s45, 7
    s_mul_i32 s58, s58, 229376
    v_mfma_f32_16x16x32_bf16 v[140:143], v[104:107], v[116:119], v[140:143]
    ds_read_b64 v[76:77], v63 offset:3840
    s_mul_i32 s59, s44, 57344
    s_add_u32 s58, s58, s59
    s_waitcnt lgkmcnt(11)
    v_mfma_f32_16x16x32_bf16 v[140:143], v[108:111], v[112:115], v[140:143]
    ds_read_b64 v[78:79], v63 offset:3848
    s_add_u32 s58, s58, 19922944
    v_lshlrev_b32 v248, 4, v3
    s_waitcnt lgkmcnt(9)
    v_mfma_f32_16x16x32_bf16 v[128:131], v[64:67], v[80:83], v[128:131]
    ds_read_b64 v[96:97], v63 offset:832
    ds_read_b64 v[98:99], v63 offset:840
    v_add_u32 v248, s58, v248
    s_waitcnt lgkmcnt(10)
    v_mfma_f32_16x16x32_bf16 v[132:135], v[64:67], v[84:87], v[132:135]
    ds_read_b128 v[112:115], v62 offset:5856
    buffer_load_dwordx4 v227, s[28:31], s101 offen offset:3072 lds
    s_waitcnt lgkmcnt(9)
    v_mfma_f32_16x16x32_bf16 v[132:135], v[68:71], v[80:83], v[132:135]
    ds_read_b128 v[116:119], v62 offset:4320
    s_lshl_b32 s67, s47, 7
    s_add_u32 s67, s67, 7094272
    s_waitcnt lgkmcnt(9)
    v_mfma_f32_16x16x32_bf16 v[136:139], v[64:67], v[88:91], v[136:139]
    ds_read_b64 v[100:101], v63 offset:1856
    ds_read_b64 v[102:103], v63 offset:1864
    s_lshr_b32 s72, s41, 3
    v_mfma_f32_16x16x32_bf16 v[136:139], v[68:71], v[84:87], v[136:139]
    ds_read_b128 v[120:123], v62 offset:2784
    s_mul_i32 s58, s72, 224
    s_mul_i32 s59, s44, 28
    s_waitcnt lgkmcnt(10)
    v_mfma_f32_16x16x32_bf16 v[136:139], v[72:75], v[80:83], v[136:139]
    ds_read_b64 v[104:105], v63 offset:2880
    s_add_u32 s58, s58, s59
    s_lshl_b32 s58, s58, 10
    s_waitcnt lgkmcnt(10)
    v_mfma_f32_16x16x32_bf16 v[140:143], v[64:67], v[92:95], v[140:143]
    ds_read_b64 v[106:107], v63 offset:2888
    s_add_u32 s73, s58, 11534336
    s_lshl_b32 s74, s46, 12
    v_mfma_f32_16x16x32_bf16 v[140:143], v[68:71], v[88:91], v[140:143]
    ds_read_b128 v[124:127], v62 offset:1248
    s_add_u32 s74, s74, 7208960
    s_and_b32 s58, s72, 1
    v_mfma_f32_16x16x32_bf16 v[140:143], v[72:75], v[84:87], v[140:143]
    ds_read_b64 v[108:109], v63 offset:3904
    s_lshl_b32 s58, s58, 2
    s_add_u32 s58, s58, s44
    s_waitcnt lgkmcnt(11)
    v_mfma_f32_16x16x32_bf16 v[140:143], v[76:79], v[80:83], v[140:143]
    ds_read_b64 v[110:111], v63 offset:3912
    s_add_u32 m0, s4, 16384
    s_add_u32 s101, s6, 458752
    buffer_load_dwordx4 v224, s[28:31], s101 offen offset:0 lds
    s_waitcnt lgkmcnt(9)
    v_mfma_f32_16x16x32_bf16 v[128:131], v[96:99], v[112:115], v[128:131]
    ds_read_b64 v[64:65], v63 offset:896
    ds_read_b64 v[66:67], v63 offset:904
    s_lshl_b32 s58, s58, 7
    s_waitcnt lgkmcnt(10)
    v_mfma_f32_16x16x32_bf16 v[132:135], v[96:99], v[116:119], v[132:135]
    ds_read_b128 v[80:83], v62 offset:5952
    s_add_u32 s75, s74, s58
    s_lshl_b32 s58, s50, 2
    s_waitcnt lgkmcnt(9)
    v_mfma_f32_16x16x32_bf16 v[132:135], v[100:103], v[112:115], v[132:135]
    ds_read_b128 v[84:87], v62 offset:4416
    s_lshr_b32 s59, s45, 2
    s_add_u32 s58, s58, s59
    s_waitcnt lgkmcnt(9)
    v_mfma_f32_16x16x32_bf16 v[136:139], v[96:99], v[120:123], v[136:139]
    ds_read_b64 v[68:69], v63 offset:1920
    ds_read_b64 v[70:71], v63 offset:1928
    s_lshl_b32 s58, s58, 7
    v_mfma_f32_16x16x32_bf16 v[136:139], v[100:103], v[116:119], v[136:139]
    ds_read_b128 v[88:91], v62 offset:2880
    s_add_u32 s74, s74, s58
    s_and_b32 s58, s45, 3
    s_waitcnt lgkmcnt(10)
    v_mfma_f32_16x16x32_bf16 v[136:139], v[104:107], v[112:115], v[136:139]
    ds_read_b64 v[72:73], v63 offset:2944
    s_lshl_b32 s58, s58, 3
    s_add_u32 s74, s74, s58
    s_waitcnt lgkmcnt(10)
    v_mfma_f32_16x16x32_bf16 v[140:143], v[96:99], v[124:127], v[140:143]
    ds_read_b64 v[74:75], v63 offset:2952
    s_lshl_b32 s58, s51, 2
    s_add_u32 s74, s74, s58
    v_mfma_f32_16x16x32_bf16 v[140:143], v[100:103], v[120:123], v[140:143]
    ds_read_b128 v[92:95], v62 offset:1344
    buffer_load_dwordx4 v225, s[28:31], s101 offen offset:1024 lds
    v_mfma_f32_16x16x32_bf16 v[140:143], v[104:107], v[116:119], v[140:143]
    ds_read_b64 v[76:77], v63 offset:3968
    v_lshlrev_b32 v246, 10, v3
    s_mov_b32 s68, 0x3b000000
    s_waitcnt lgkmcnt(11)
    v_mfma_f32_16x16x32_bf16 v[140:143], v[108:111], v[112:115], v[140:143]
    ds_read_b64 v[78:79], v63 offset:3976
    s_mov_b32 s69, 0x3727c5ac
    s_waitcnt lgkmcnt(9)
    v_mfma_f32_16x16x32_bf16 v[128:131], v[64:67], v[80:83], v[128:131]
    ds_read_b64 v[96:97], v63 offset:960
    ds_read_b64 v[98:99], v63 offset:968
    s_waitcnt lgkmcnt(10)
    v_mfma_f32_16x16x32_bf16 v[132:135], v[64:67], v[84:87], v[132:135]
    ds_read_b128 v[112:115], v62 offset:6048
    s_waitcnt lgkmcnt(9)
    v_mfma_f32_16x16x32_bf16 v[132:135], v[68:71], v[80:83], v[132:135]
    ds_read_b128 v[116:119], v62 offset:4512
    s_waitcnt lgkmcnt(9)
    v_mfma_f32_16x16x32_bf16 v[136:139], v[64:67], v[88:91], v[136:139]
    ds_read_b64 v[100:101], v63 offset:1984
    ds_read_b64 v[102:103], v63 offset:1992
    v_mfma_f32_16x16x32_bf16 v[136:139], v[68:71], v[84:87], v[136:139]
    ds_read_b128 v[120:123], v62 offset:2976
    s_waitcnt lgkmcnt(10)
    v_mfma_f32_16x16x32_bf16 v[136:139], v[72:75], v[80:83], v[136:139]
    ds_read_b64 v[104:105], v63 offset:3008
    buffer_load_dwordx4 v226, s[28:31], s101 offen offset:2048 lds
    s_waitcnt lgkmcnt(10)
    v_mfma_f32_16x16x32_bf16 v[140:143], v[64:67], v[92:95], v[140:143]
    ds_read_b64 v[106:107], v63 offset:3016
    v_mfma_f32_16x16x32_bf16 v[140:143], v[68:71], v[88:91], v[140:143]
    ds_read_b128 v[124:127], v62 offset:1440
    v_mfma_f32_16x16x32_bf16 v[140:143], v[72:75], v[84:87], v[140:143]
    ds_read_b64 v[108:109], v63 offset:4032
    s_waitcnt lgkmcnt(11)
    v_mfma_f32_16x16x32_bf16 v[140:143], v[76:79], v[80:83], v[140:143]
    ds_read_b64 v[110:111], v63 offset:4040
    s_waitcnt lgkmcnt(9)
    v_mfma_f32_16x16x32_bf16 v[128:131], v[96:99], v[112:115], v[128:131]
    s_waitcnt lgkmcnt(8)
    v_mfma_f32_16x16x32_bf16 v[132:135], v[96:99], v[116:119], v[132:135]
    s_waitcnt lgkmcnt(6)
    v_mfma_f32_16x16x32_bf16 v[132:135], v[100:103], v[112:115], v[132:135]
    s_waitcnt lgkmcnt(5)
    v_mfma_f32_16x16x32_bf16 v[136:139], v[96:99], v[120:123], v[136:139]
    v_mfma_f32_16x16x32_bf16 v[136:139], v[100:103], v[116:119], v[136:139]
    s_waitcnt lgkmcnt(3)
    v_mfma_f32_16x16x32_bf16 v[136:139], v[104:107], v[112:115], v[136:139]
    s_waitcnt lgkmcnt(2)
    v_mfma_f32_16x16x32_bf16 v[140:143], v[96:99], v[124:127], v[140:143]
    v_mfma_f32_16x16x32_bf16 v[140:143], v[100:103], v[120:123], v[140:143]
    v_mfma_f32_16x16x32_bf16 v[140:143], v[104:107], v[116:119], v[140:143]
    s_waitcnt lgkmcnt(0)
    v_mfma_f32_16x16x32_bf16 v[140:143], v[108:111], v[112:115], v[140:143]
    s_nop 7
    v_cvt_pk_bf16_f32 v64, v128, v129
    v_cvt_pk_bf16_f32 v65, v130, v131
    v_cvt_pk_bf16_f32 v66, v132, v133
    v_cvt_pk_bf16_f32 v67, v134, v135
    v_cvt_pk_bf16_f32 v68, v136, v137
    v_cvt_pk_bf16_f32 v69, v138, v139
    v_cvt_pk_bf16_f32 v70, v140, v141
    v_cvt_pk_bf16_f32 v71, v142, v143
    ds_write_b64 v229, v[64:65] offset:0
    ds_write_b64 v229, v[66:67] offset:1280
    ds_write_b64 v229, v[68:69] offset:2560
    ds_write_b64 v229, v[70:71] offset:3840
    s_waitcnt lgkmcnt(0)
    s_barrier
    ds_read_b64 v[64:65], v230
    ds_read_b64 v[66:67], v230 offset:2560
    ds_read_b64 v[68:69], v230 offset:5120
    ds_read_b64 v[70:71], v230 offset:7680
    s_waitcnt lgkmcnt(0)
    v_lshlrev_b32 v72, 16, v64
    v_and_b32 v73, s40, v64
    v_lshlrev_b32 v74, 16, v65
    v_and_b32 v75, s40, v65
    v_lshlrev_b32 v76, 16, v66
    v_and_b32 v77, s40, v66
    v_lshlrev_b32 v78, 16, v67
    v_and_b32 v79, s40, v67
    v_lshlrev_b32 v80, 16, v68
    v_and_b32 v81, s40, v68
    v_lshlrev_b32 v82, 16, v69
    v_and_b32 v83, s40, v69
    v_lshlrev_b32 v84, 16, v70
    v_and_b32 v85, s40, v70
    v_lshlrev_b32 v86, 16, v71
    v_and_b32 v87, s40, v71
    v_pk_add_f32 v[72:73], v[72:73], v[8:9]
    v_pk_add_f32 v[74:75], v[74:75], v[10:11]
    v_pk_add_f32 v[76:77], v[76:77], v[12:13]
    v_pk_add_f32 v[78:79], v[78:79], v[14:15]
    v_pk_add_f32 v[80:81], v[80:81], v[16:17]
    v_pk_add_f32 v[82:83], v[82:83], v[18:19]
    v_pk_add_f32 v[84:85], v[84:85], v[20:21]
    v_pk_add_f32 v[86:87], v[86:87], v[22:23]
    v_cvt_pk_bf16_f32 v64, v72, v80
    v_cvt_pk_bf16_f32 v65, v73, v81
    v_cvt_pk_bf16_f32 v66, v74, v82
    v_cvt_pk_bf16_f32 v67, v75, v83
    v_cvt_pk_bf16_f32 v68, v76, v84
    v_cvt_pk_bf16_f32 v69, v77, v85
    v_cvt_pk_bf16_f32 v70, v78, v86
    v_cvt_pk_bf16_f32 v71, v79, v87
    buffer_store_dwordx4 v[64:67], v231, s[16:19], s94 offen sc1
    buffer_store_dwordx4 v[68:71], v231, s[16:19], s95 offen sc1
    v_lshlrev_b32 v24, 3, v0
    s_mov_b32 s54, 6356992
    s_mov_b32 s55, 6361088
    s_mov_b32 s56, 6365184
    v_add_u32 v189, 0x1000, v189
    buffer_load_dwordx2 v[144:145], v24, s[16:19], s54 offen offset:0 sc1
    buffer_load_dwordx2 v[146:147], v24, s[16:19], s54 offen offset:2048 sc1
    buffer_load_dwordx2 v[148:149], v24, s[16:19], s55 offen offset:0 sc1
    buffer_load_dwordx2 v[150:151], v24, s[16:19], s55 offen offset:2048 sc1
    buffer_load_dwordx2 v[152:153], v24, s[16:19], s56 offen offset:0 sc1
    buffer_load_dwordx2 v[154:155], v24, s[16:19], s56 offen offset:2048 sc1
    buffer_load_dwordx2 v[156:157], v189, s[16:19], s56 offen sc1
    v_bfe_u32 v204, v3, 2, 2
    v_lshrrev_b32 v205, 4, v3
    v_lshlrev_b32 v204, 7, v204
    v_lshl_add_u32 v204, v205, 5, v204
    v_and_b32 v205, 3, v3
    v_lshl_add_u32 v204, v205, 3, v204
    s_lshl_b32 s60, s44, 11
    s_add_u32 s60, s60, 147456
    v_add_u32 v204, s60, v204
    v_lshlrev_b32 v205, 4, v3
    v_add_u32 v206, s60, v205
    ds_write_b128 v206, a[8:11]
    ds_write_b128 v206, a[12:15] offset:1024
    ds_read_b64_tr_b16 v[200:201], v204 offset:0
    ds_read_b64_tr_b16 v[202:203], v204 offset:512
    ds_read_b64_tr_b16 v[208:209], v204 offset:1024
    ds_read_b64_tr_b16 v[210:211], v204 offset:1536
    buffer_store_dwordx4 a[0:3], v242, s[16:19], 0 offen sc1
    s_mov_b32 exec_hi, 0
    buffer_store_dwordx4 a[4:7], v243, s[16:19], 0 offen sc1
    s_mov_b64 exec, -1
    s_waitcnt lgkmcnt(0)
    buffer_store_dwordx4 v[200:203], v27, s[16:19], s49 offen sc1
    buffer_store_dwordx4 v[208:211], v27, s[16:19], s100 offen sc1
    v_and_b32 v7, 7, v3
    v_lshrrev_b32 v6, 5, v3
    v_lshlrev_b32 v7, 2, v7
    v_add_u32 v235, 143360, v7
    v_lshl_add_u32 v234, v6, 5, v235
    s_lshl_b32 s58, s44, 6
    v_add_u32 v234, s58, v234
    s_mov_b32 s64, 0xff
    s_mov_b32 s65, 0xff
    buffer_load_dwordx4 v227, s[28:31], s101 offen offset:3072 lds
    s_waitcnt vmcnt(25)
    v_dot2_f32_bf16 v96, v160, s66, 0
    v_dot2_f32_bf16 v98, v160, v160, 0
    v_dot2_f32_bf16 v97, v164, s66, 0
    v_dot2_f32_bf16 v99, v164, v164, 0
    v_dot2_f32_bf16 v96, v161, s66, v96
    v_dot2_f32_bf16 v98, v161, v161, v98
    v_dot2_f32_bf16 v97, v165, s66, v97
    v_dot2_f32_bf16 v99, v165, v165, v99
    v_dot2_f32_bf16 v96, v162, s66, v96
    v_dot2_f32_bf16 v98, v162, v162, v98
    v_dot2_f32_bf16 v97, v166, s66, v97
    v_dot2_f32_bf16 v99, v166, v166, v99
    v_dot2_f32_bf16 v96, v163, s66, v96
    v_dot2_f32_bf16 v98, v163, v163, v98
    v_dot2_f32_bf16 v97, v167, s66, v97
    v_dot2_f32_bf16 v99, v167, v167, v99
    s_nop 2
    v_add_f32 v96, v96, v97
    v_add_f32 v98, v98, v99
    s_nop 1
    v_permlane32_swap_b32 v96, v98
    s_nop 0
    v_add_f32 v96, v96, v98
    v_mov_b32 v97, v96
    s_nop 1
    v_permlane16_swap_b32 v96, v97
    s_nop 0
    v_add_f32 v96, v96, v97
    s_nop 1
    v_add_f32_dpp v96, v96, v96 row_ror:8 row_mask:0xf bank_mask:0xf
    s_mov_b64 exec, s[64:65]
    ds_write_b32 v234, v96 offset:0
    s_mov_b64 exec, -1
    v_lshlrev_b32 v64, 16, v160
    v_and_b32 v65, s40, v160
    v_lshlrev_b32 v66, 16, v161
    v_and_b32 v67, s40, v161
    v_lshlrev_b32 v68, 16, v162
    v_and_b32 v69, s40, v162
    v_lshlrev_b32 v70, 16, v163
    v_and_b32 v71, s40, v163
    s_add_u32 m0, s5, 24576
    s_add_u32 s101, s7, 688128
    buffer_load_dwordx4 v224, s[28:31], s101 offen offset:0 lds
    v_lshlrev_b32 v72, 16, v164
    v_and_b32 v73, s40, v164
    v_lshlrev_b32 v74, 16, v165
    v_and_b32 v75, s40, v165
    v_lshlrev_b32 v76, 16, v166
    v_and_b32 v77, s40, v166
    v_lshlrev_b32 v78, 16, v167
    v_and_b32 v79, s40, v167
    buffer_load_dwordx4 v225, s[28:31], s101 offen offset:1024 lds
    v_add_u32 v25, 131072, v24
    v_lshrrev_b32 v26, 3, v3
    v_lshlrev_b32 v26, 5, v26
    s_lshl_b32 s58, s44, 9
    s_add_u32 s58, s58, 131072
    v_add_u32 v26, s58, v26
    s_waitcnt vmcnt(7)
    v_xor_b32 v145, s36, v145
    v_xor_b32 v147, s36, v147
    v_xor_b32 v149, s36, v149
    v_xor_b32 v151, s36, v151
    v_xor_b32 v153, s36, v153
    v_xor_b32 v155, s36, v155
    v_xor_b32 v157, s36, v157
    v_or3_b32 v145, v145, v147, v149
    v_or3_b32 v145, v145, v151, v153
    v_or3_b32 v145, v145, v155, v157
    v_cmp_ne_u32 vcc, 0, v145
    s_cbranch_vccnz LL_slow1
LL_back1:
    v_and_b32 v145, s40, v144
    v_lshlrev_b32 v144, 16, v144
    v_and_b32 v147, s40, v146
    v_lshlrev_b32 v146, 16, v146
    v_and_b32 v149, s40, v148
    v_lshlrev_b32 v148, 16, v148
    v_and_b32 v151, s40, v150
    v_lshlrev_b32 v150, 16, v150
    buffer_load_dwordx4 v226, s[28:31], s101 offen offset:2048 lds
    v_and_b32 v153, s40, v152
    v_lshlrev_b32 v152, 16, v152
    v_and_b32 v155, s40, v154
    v_lshlrev_b32 v154, 16, v154
    v_pk_add_f32 v[146:147], v[146:147], 1.0 op_sel_hi:[1,0]
    v_pk_add_f32 v[152:153], v[152:153], 1.0 op_sel_hi:[1,0]
    v_cvt_pk_bf16_f32 v146, 0, v146
    v_cvt_pk_bf16_f32 v147, 0, v147
    buffer_load_dwordx4 v227, s[28:31], s101 offen offset:3072 lds
    v_cvt_pk_bf16_f32 v152, 0, v152
    v_cvt_pk_bf16_f32 v153, 0, v153
    ds_write_b64 v25, v[144:145] offset:0
    ds_write_b64 v25, v[146:147] offset:2048
    ds_write_b64 v25, v[148:149] offset:4096
    ds_write_b64 v25, v[150:151] offset:6144
    ds_write_b64 v25, v[152:153] offset:8192
    ds_write_b64 v25, v[154:155] offset:10240
    s_waitcnt vmcnt(5)
    s_waitcnt lgkmcnt(0)
    s_barrier
    s_mov_b32 s61, 7110656
    v_lshlrev_b32 v205, 6, v0
    s_cmp_lg_u32 s44, 0
    s_cbranch_scc1 LL_not2
    s_lshl_b32 s60, s41, 6
    s_add_u32 s60, s60, s61
    v_mov_b32 v206, s36
    s_mov_b64 exec, 1
    buffer_store_dword v206, off, s[16:19], s60 sc1
    s_mov_b64 exec, -1
LL_not2:
    ds_read2_b32 v[96:97], v235 offset0:0 offset1:8
    ds_read2_b32 v[98:99], v235 offset0:16 offset1:24
    ds_read2_b32 v[100:101], v235 offset0:32 offset1:40
    ds_read2_b32 v[102:103], v235 offset0:48 offset1:56
    s_waitcnt lgkmcnt(0)
    v_pk_add_f32 v[96:97], v[96:97], v[98:99]
    v_pk_add_f32 v[100:101], v[100:101], v[102:103]
    v_pk_add_f32 v[96:97], v[96:97], v[100:101]
    v_mul_f32 v96, s68, v96
    v_mul_f32 v97, s68, v97
    v_fma_f32 v97, -v96, v96, v97
    v_max_f32 v97, 0, v97
    v_cvt_pk_bf16_f32 v97, 0, v97
    v_add_f32 v97, s69, v97
    v_cvt_pk_bf16_f32 v97, 0, v97
    v_sqrt_f32 v97, v97
    v_cvt_pk_bf16_f32 v96, 0, v96
    v_cvt_pk_bf16_f32 v97, 0, v97
    v_rcp_f32 v97, v97
    s_nop 0
    v_pk_add_f32 v[80:81], v[64:65], v[96:97] op_sel:[0,0] op_sel_hi:[1,0] neg_lo:[0,1] neg_hi:[0,1]
    v_pk_add_f32 v[82:83], v[66:67], v[96:97] op_sel:[0,0] op_sel_hi:[1,0] neg_lo:[0,1] neg_hi:[0,1]
    v_pk_add_f32 v[84:85], v[68:69], v[96:97] op_sel:[0,0] op_sel_hi:[1,0] neg_lo:[0,1] neg_hi:[0,1]
    v_pk_add_f32 v[86:87], v[70:71], v[96:97] op_sel:[0,0] op_sel_hi:[1,0] neg_lo:[0,1] neg_hi:[0,1]
    v_pk_add_f32 v[88:89], v[72:73], v[96:97] op_sel:[0,0] op_sel_hi:[1,0] neg_lo:[0,1] neg_hi:[0,1]
    v_pk_add_f32 v[90:91], v[74:75], v[96:97] op_sel:[0,0] op_sel_hi:[1,0] neg_lo:[0,1] neg_hi:[0,1]
    s_add_u32 m0, s5, 32768
    s_add_u32 s101, s7, 917504
    buffer_load_dwordx4 v224, s[28:31], s101 offen offset:0 lds
    v_pk_add_f32 v[92:93], v[76:77], v[96:97] op_sel:[0,0] op_sel_hi:[1,0] neg_lo:[0,1] neg_hi:[0,1]
    v_pk_add_f32 v[94:95], v[78:79], v[96:97] op_sel:[0,0] op_sel_hi:[1,0] neg_lo:[0,1] neg_hi:[0,1]
    v_cvt_pk_bf16_f32 v80, 0, v80
    v_cvt_pk_bf16_f32 v81, 0, v81
    v_cvt_pk_bf16_f32 v82, 0, v82
    v_cvt_pk_bf16_f32 v83, 0, v83
    buffer_load_dwordx4 v225, s[28:31], s101 offen offset:1024 lds
    v_cvt_pk_bf16_f32 v84, 0, v84
    v_cvt_pk_bf16_f32 v85, 0, v85
    v_cvt_pk_bf16_f32 v86, 0, v86
    v_cvt_pk_bf16_f32 v87, 0, v87
    v_cvt_pk_bf16_f32 v88, 0, v88
    v_cvt_pk_bf16_f32 v89, 0, v89
    buffer_load_dwordx4 v226, s[28:31], s101 offen offset:2048 lds
    v_cvt_pk_bf16_f32 v90, 0, v90
    v_cvt_pk_bf16_f32 v91, 0, v91
    v_cvt_pk_bf16_f32 v92, 0, v92
    v_cvt_pk_bf16_f32 v93, 0, v93
    v_cvt_pk_bf16_f32 v94, 0, v94
    v_cvt_pk_bf16_f32 v95, 0, v95
    buffer_load_dwordx4 v227, s[28:31], s101 offen offset:3072 lds
    v_pk_mul_f32 v[80:81], v[80:81], v[96:97] op_sel:[0,1] op_sel_hi:[1,1]
    v_pk_mul_f32 v[82:83], v[82:83], v[96:97] op_sel:[0,1] op_sel_hi:[1,1]
    v_pk_mul_f32 v[84:85], v[84:85], v[96:97] op_sel:[0,1] op_sel_hi:[1,1]
    v_pk_mul_f32 v[86:87], v[86:87], v[96:97] op_sel:[0,1] op_sel_hi:[1,1]
    v_pk_mul_f32 v[88:89], v[88:89], v[96:97] op_sel:[0,1] op_sel_hi:[1,1]
    v_pk_mul_f32 v[90:91], v[90:91], v[96:97] op_sel:[0,1] op_sel_hi:[1,1]
    s_add_u32 m0, s5, 40960
    s_add_u32 s101, s7, 1146880
    buffer_load_dwordx4 v224, s[28:31], s101 offen offset:0 lds
    v_pk_mul_f32 v[92:93], v[92:93], v[96:97] op_sel:[0,1] op_sel_hi:[1,1]
    v_pk_mul_f32 v[94:95], v[94:95], v[96:97] op_sel:[0,1] op_sel_hi:[1,1]
    v_cvt_pk_bf16_f32 v80, 0, v80
    v_cvt_pk_bf16_f32 v81, 0, v81
    v_cvt_pk_bf16_f32 v82, 0, v82
    v_cvt_pk_bf16_f32 v83, 0, v83
    buffer_load_dwordx4 v225, s[28:31], s101 offen offset:1024 lds
    v_cvt_pk_bf16_f32 v84, 0, v84
    v_cvt_pk_bf16_f32 v85, 0, v85
    v_cvt_pk_bf16_f32 v86, 0, v86
    v_cvt_pk_bf16_f32 v87, 0, v87
    v_cvt_pk_bf16_f32 v88, 0, v88
    v_cvt_pk_bf16_f32 v89, 0, v89
    buffer_load_dwordx4 v226, s[28:31], s101 offen offset:2048 lds
    v_cvt_pk_bf16_f32 v90, 0, v90
    v_cvt_pk_bf16_f32 v91, 0, v91
    v_cvt_pk_bf16_f32 v92, 0, v92
    v_cvt_pk_bf16_f32 v93, 0, v93
    v_cvt_pk_bf16_f32 v94, 0, v94
    v_cvt_pk_bf16_f32 v95, 0, v95
    buffer_load_dwordx4 v227, s[28:31], s101 offen offset:3072 lds
    ds_read_b128 v[112:115], v26 offset:2048
    ds_read_b128 v[116:119], v26 offset:2064
    ds_read_b128 v[120:123], v26 offset:2304
    ds_read_b128 v[124:127], v26 offset:2320
    ds_read_b128 v[128:131], v26 offset:0
    ds_read_b128 v[132:135], v26 offset:16
    ds_read_b128 v[136:139], v26 offset:256
    ds_read_b128 v[140:143], v26 offset:272
    ds_read_b128 v[144:147], v26 offset:4096
    ds_read_b128 v[148:151], v26 offset:4112
    ds_read_b128 v[152:155], v26 offset:4352
    ds_read_b128 v[156:159], v26 offset:4368
    s_add_u32 s58, s98, 4096
    buffer_load_dword v208, v232, s[16:19], s98 offen offset:0 sc1
    buffer_load_dword v209, v232, s[16:19], s98 offen offset:128 sc1
    buffer_load_dword v210, v232, s[16:19], s98 offen offset:256 sc1
    buffer_load_dword v211, v232, s[16:19], s98 offen offset:384 sc1
    buffer_load_dword v212, v232, s[16:19], s58 offen offset:0 sc1
    buffer_load_dword v213, v232, s[16:19], s58 offen offset:128 sc1
    buffer_load_dword v214, v232, s[16:19], s58 offen offset:256 sc1
    buffer_load_dword v215, v232, s[16:19], s58 offen offset:384 sc1
    s_waitcnt lgkmcnt(8)
    v_pk_mul_f32 v[80:81], v[80:81], v[112:113]
    v_pk_mul_f32 v[82:83], v[82:83], v[114:115]
    v_pk_mul_f32 v[84:85], v[84:85], v[116:117]
    v_pk_mul_f32 v[86:87], v[86:87], v[118:119]
    v_pk_mul_f32 v[88:89], v[88:89], v[120:121]
    v_pk_mul_f32 v[90:91], v[90:91], v[122:123]
    v_pk_mul_f32 v[92:93], v[92:93], v[124:125]
    v_pk_mul_f32 v[94:95], v[94:95], v[126:127]
    v_cvt_pk_bf16_f32 v80, 0, v80
    v_cvt_pk_bf16_f32 v81, 0, v81
    s_add_u32 m0, s32, 49152
    s_add_u32 s101, s34, 1376256
    buffer_load_dwordx4 v224, s[28:31], s101 offen offset:0 lds
    v_cvt_pk_bf16_f32 v82, 0, v82
    v_cvt_pk_bf16_f32 v83, 0, v83
    v_cvt_pk_bf16_f32 v84, 0, v84
    v_cvt_pk_bf16_f32 v85, 0, v85
    v_cvt_pk_bf16_f32 v86, 0, v86
    v_cvt_pk_bf16_f32 v87, 0, v87
    v_cvt_pk_bf16_f32 v88, 0, v88
    v_cvt_pk_bf16_f32 v89, 0, v89
    v_cvt_pk_bf16_f32 v90, 0, v90
    v_cvt_pk_bf16_f32 v91, 0, v91
    buffer_load_dwordx4 v225, s[28:31], s101 offen offset:1024 lds
    v_cvt_pk_bf16_f32 v92, 0, v92
    v_cvt_pk_bf16_f32 v93, 0, v93
    v_cvt_pk_bf16_f32 v94, 0, v94
    v_cvt_pk_bf16_f32 v95, 0, v95
    s_waitcnt lgkmcnt(4)
    ds_read_b128 v[168:171], v26 offset:8192
    ds_read_b128 v[172:175], v26 offset:8208
    ds_read_b128 v[176:179], v26 offset:8448
    ds_read_b128 v[180:183], v26 offset:8464
    v_mov_b32 v216, s36
    ds_read_b128 v[184:187], v26 offset:6144
    ds_read_b128 v[188:191], v26 offset:6160
    ds_read_b128 v[192:195], v26 offset:6400
    ds_read_b128 v[196:199], v26 offset:6416
    v_pk_add_f32 v[80:81], v[80:81], v[128:129]
    v_pk_add_f32 v[82:83], v[82:83], v[130:131]
    v_pk_add_f32 v[84:85], v[84:85], v[132:133]
    v_pk_add_f32 v[86:87], v[86:87], v[134:135]
    v_pk_add_f32 v[88:89], v[88:89], v[136:137]
    buffer_load_dwordx4 v226, s[28:31], s101 offen offset:2048 lds
    v_pk_add_f32 v[90:91], v[90:91], v[138:139]
    v_pk_add_f32 v[92:93], v[92:93], v[140:141]
    v_pk_add_f32 v[94:95], v[94:95], v[142:143]
    v_cvt_pk_bf16_f32 v80, 0, v80
    v_cvt_pk_bf16_f32 v81, 0, v81
    v_cvt_pk_bf16_f32 v82, 0, v82
    v_cvt_pk_bf16_f32 v83, 0, v83
    v_cvt_pk_bf16_f32 v84, 0, v84
    v_cvt_pk_bf16_f32 v85, 0, v85
    v_cvt_pk_bf16_f32 v86, 0, v86
    buffer_load_dwordx4 v227, s[28:31], s101 offen offset:3072 lds
    v_cvt_pk_bf16_f32 v87, 0, v87
    v_cvt_pk_bf16_f32 v88, 0, v88
    v_cvt_pk_bf16_f32 v89, 0, v89
    v_cvt_pk_bf16_f32 v90, 0, v90
    v_cvt_pk_bf16_f32 v91, 0, v91
    v_cvt_pk_bf16_f32 v92, 0, v92
    v_cvt_pk_bf16_f32 v93, 0, v93
    v_cvt_pk_bf16_f32 v94, 0, v94
    v_cvt_pk_bf16_f32 v95, 0, v95
    v_lshlrev_b32 v10, 4, v3
    s_mul_i32 s54, s47, 35840
    s_add_u32 s54, s54, 22020096
    v_add_u32 v1, s54, v10
    v_add_u32 v10, s97, v10
    v_mov_b32 v11, v248
    v_lshrrev_b32 v13, 5, v3
    v_bfe_u32 v14, v3, 4, 1
    v_bfe_u32 v15, v3, 2, 2
    v_and_b32 v12, 3, v3
    v_lshl_add_u32 v13, v13, 3, v15
    v_lshlrev_b32 v2, 7, v13
    v_lshl_add_u32 v2, v14, 16, v2
    v_lshl_add_u32 v2, v12, 3, v2
    v_mul_u32_u24 v6, 96, v13
    v_lshl_add_u32 v6, v12, 3, v6
    v_mul_u32_u24 v12, 65664, v14
    v_add_u32 v6, v6, v12
    v_lshrrev_b32 v15, 1, v15
    v_lshl_or_b32 v15, v14, 1, v15
    v_lshlrev_b32 v15, 5, v15
    v_xor_b32 v5, 0x60, v15
    v_xor_b32 v4, 0x40, v15
    v_xor_b32 v12, 0x20, v15
    v_add_u32 v5, v5, v2
    v_add_u32 v4, v4, v2
    v_add_u32 v247, v12, v2
    v_add_u32 v2, v15, v2

    s_add_u32 m0, s33, 57344
    s_add_u32 s101, s35, 1605632
    buffer_load_dwordx4 v224, s[28:31], s101 offen offset:0 lds
    s_mul_i32 s52, s50, 65664
    s_mul_i32 s54, s51, 6144
    s_add_u32 s52, s52, s54
    v_lshlrev_b32 v7, 4, v3
    v_add_u32 v7, s52, v7
    s_and_b32 s54, s46, 1
    s_mul_i32 s54, s54, 3072
    v_subrev_u32 v8, s54, v7
    v_add_u32 v7, s54, v7
    v_mov_b32 v13, s36
    v_and_b32 v12, 3, v3
    v_lshlrev_b32 v12, 3, v12
    v_and_b32 v9, 4, v3
    v_lshl_add_u32 v12, v9, 7, v12
    s_mov_b32 s56, 4096
    v_mov_b32 v3, v247
    s_add_u32 s55, s96, 4480
    s_waitcnt lgkmcnt(0)
    buffer_load_dwordx4 v225, s[28:31], s101 offen offset:1024 lds
    buffer_load_dwordx4 v226, s[28:31], s101 offen offset:2048 lds
    buffer_load_dwordx4 v227, s[28:31], s101 offen offset:3072 lds
    s_waitcnt vmcnt(8)
    v_max3_u32 v217, v208, v209, v210
    v_max3_u32 v217, v217, v211, v212
    v_max3_u32 v217, v217, v213, v214
    v_max_u32 v217, v217, v215
    v_cmp_eq_u32 vcc, -1, v217
    s_cbranch_vccnz LL_slow2
LL_back2:
    buffer_load_dword v200, v205, s[16:19], s61 offen sc1
    v_lshlrev_b32 v112, 16, v208
    v_and_b32 v113, s40, v208
    v_lshlrev_b32 v114, 16, v209
    v_and_b32 v115, s40, v209
    v_lshlrev_b32 v116, 16, v210
    v_and_b32 v117, s40, v210
    v_lshlrev_b32 v118, 16, v211
    v_and_b32 v119, s40, v211
    v_lshlrev_b32 v120, 16, v212
    v_and_b32 v121, s40, v212
    v_lshlrev_b32 v122, 16, v213
    v_and_b32 v123, s40, v213
    v_lshlrev_b32 v124, 16, v214
    v_and_b32 v125, s40, v214
    v_lshlrev_b32 v126, 16, v215
    v_and_b32 v127, s40, v215
    v_pk_mul_f32 v[112:113], v[112:113], v[80:81]
    v_pk_mul_f32 v[114:115], v[114:115], v[82:83]
    v_pk_mul_f32 v[116:117], v[116:117], v[84:85]
    v_pk_mul_f32 v[118:119], v[118:119], v[86:87]
    v_pk_mul_f32 v[120:121], v[120:121], v[88:89]
    v_pk_mul_f32 v[122:123], v[122:123], v[90:91]
    v_pk_mul_f32 v[124:125], v[124:125], v[92:93]
    v_pk_mul_f32 v[126:127], v[126:127], v[94:95]
    v_cvt_pk_bf16_f32 v112, 0, v112
    v_cvt_pk_bf16_f32 v113, 0, v113
    v_cvt_pk_bf16_f32 v114, 0, v114
    v_cvt_pk_bf16_f32 v115, 0, v115
    v_cvt_pk_bf16_f32 v116, 0, v116
    v_cvt_pk_bf16_f32 v117, 0, v117
    v_cvt_pk_bf16_f32 v118, 0, v118
    v_cvt_pk_bf16_f32 v119, 0, v119
    v_cvt_pk_bf16_f32 v120, 0, v120
    v_cvt_pk_bf16_f32 v121, 0, v121
    v_cvt_pk_bf16_f32 v122, 0, v122
    v_cvt_pk_bf16_f32 v123, 0, v123
    v_cvt_pk_bf16_f32 v124, 0, v124
    v_cvt_pk_bf16_f32 v125, 0, v125
    v_cvt_pk_bf16_f32 v126, 0, v126
    v_cvt_pk_bf16_f32 v127, 0, v127
    v_pk_mul_f32 v[112:113], v[112:113], v[144:145]
    v_pk_mul_f32 v[114:115], v[114:115], v[146:147]
    v_pk_mul_f32 v[116:117], v[116:117], v[148:149]
    v_pk_mul_f32 v[118:119], v[118:119], v[150:151]
    v_pk_mul_f32 v[120:121], v[120:121], v[152:153]
    v_pk_mul_f32 v[122:123], v[122:123], v[154:155]
    v_pk_mul_f32 v[124:125], v[124:125], v[156:157]
    v_pk_mul_f32 v[126:127], v[126:127], v[158:159]
    v_cvt_pk_bf16_f32 v112, 0, v112
    v_cvt_pk_bf16_f32 v113, 0, v113
    v_cvt_pk_bf16_f32 v114, 0, v114
    v_cvt_pk_bf16_f32 v115, 0, v115
    v_cvt_pk_bf16_f32 v116, 0, v116
    v_cvt_pk_bf16_f32 v117, 0, v117
    v_cvt_pk_bf16_f32 v118, 0, v118
    v_cvt_pk_bf16_f32 v119, 0, v119
    v_cvt_pk_bf16_f32 v120, 0, v120
    v_cvt_pk_bf16_f32 v121, 0, v121
    v_cvt_pk_bf16_f32 v122, 0, v122
    v_cvt_pk_bf16_f32 v123, 0, v123
    v_cvt_pk_bf16_f32 v124, 0, v124
    v_cvt_pk_bf16_f32 v125, 0, v125
    v_cvt_pk_bf16_f32 v126, 0, v126
    v_cvt_pk_bf16_f32 v127, 0, v127
    v_pk_add_f32 v[112:113], v[112:113], v[64:65]
    v_pk_add_f32 v[114:115], v[114:115], v[66:67]
    v_pk_add_f32 v[116:117], v[116:117], v[68:69]
    v_pk_add_f32 v[118:119], v[118:119], v[70:71]
    v_pk_add_f32 v[120:121], v[120:121], v[72:73]
    v_pk_add_f32 v[122:123], v[122:123], v[74:75]
    v_pk_add_f32 v[124:125], v[124:125], v[76:77]
    v_pk_add_f32 v[126:127], v[126:127], v[78:79]
    v_cvt_pk_bf16_f32 v208, v112, v113
    v_cvt_pk_bf16_f32 v209, v114, v115
    v_cvt_pk_bf16_f32 v210, v116, v117
    v_cvt_pk_bf16_f32 v211, v118, v119
    v_cvt_pk_bf16_f32 v212, v120, v121
    v_cvt_pk_bf16_f32 v213, v122, v123
    v_cvt_pk_bf16_f32 v214, v124, v125
    v_cvt_pk_bf16_f32 v215, v126, v127
    v_dot2_f32_bf16 v96, v208, s66, 0
    v_dot2_f32_bf16 v98, v208, v208, 0
    v_dot2_f32_bf16 v97, v212, s66, 0
    v_dot2_f32_bf16 v99, v212, v212, 0
    v_dot2_f32_bf16 v96, v209, s66, v96
    v_dot2_f32_bf16 v98, v209, v209, v98
    v_dot2_f32_bf16 v97, v213, s66, v97
    v_dot2_f32_bf16 v99, v213, v213, v99
    v_dot2_f32_bf16 v96, v210, s66, v96
    v_dot2_f32_bf16 v98, v210, v210, v98
    v_dot2_f32_bf16 v97, v214, s66, v97
    v_dot2_f32_bf16 v99, v214, v214, v99
    v_dot2_f32_bf16 v96, v211, s66, v96
    v_dot2_f32_bf16 v98, v211, v211, v98
    v_dot2_f32_bf16 v97, v215, s66, v97
    v_dot2_f32_bf16 v99, v215, v215, v99
    s_nop 2
    v_add_f32 v96, v96, v97
    v_add_f32 v98, v98, v99
    s_nop 1
    v_permlane32_swap_b32 v96, v98
    s_nop 0
    v_add_f32 v96, v96, v98
    v_mov_b32 v97, v96
    s_nop 1
    v_permlane16_swap_b32 v96, v97
    s_nop 0
    v_add_f32 v96, v96, v97
    s_nop 1
    v_add_f32_dpp v96, v96, v96 row_ror:8 row_mask:0xf bank_mask:0xf
    s_mov_b64 exec, s[64:65]
    ds_write_b32 v234, v96 offset:256
    s_mov_b64 exec, -1
    s_waitcnt vmcnt(0)
    v_cmp_ne_u32 vcc, s36, v200
    s_cbranch_vccnz LL_slow3
LL_back3:
    s_waitcnt lgkmcnt(0)
    s_barrier
    ds_read2_b32 v[96:97], v235 offset0:64 offset1:72
    ds_read2_b32 v[98:99], v235 offset0:80 offset1:88
    ds_read2_b32 v[100:101], v235 offset0:96 offset1:104
    ds_read2_b32 v[102:103], v235 offset0:112 offset1:120
    v_lshlrev_b32 v112, 16, v208
    v_and_b32 v113, s40, v208
    v_lshlrev_b32 v114, 16, v209
    v_and_b32 v115, s40, v209
    v_lshlrev_b32 v116, 16, v210
    v_and_b32 v117, s40, v210
    v_lshlrev_b32 v118, 16, v211
    v_and_b32 v119, s40, v211
    v_lshlrev_b32 v120, 16, v212
    v_and_b32 v121, s40, v212
    v_lshlrev_b32 v122, 16, v213
    v_and_b32 v123, s40, v213
    v_lshlrev_b32 v124, 16, v214
    v_and_b32 v125, s40, v214
    v_lshlrev_b32 v126, 16, v215
    v_and_b32 v127, s40, v215
    s_waitcnt lgkmcnt(0)
    v_pk_add_f32 v[96:97], v[96:97], v[98:99]
    v_pk_add_f32 v[100:101], v[100:101], v[102:103]
    v_pk_add_f32 v[96:97], v[96:97], v[100:101]
    v_mul_f32 v96, s68, v96
    v_mul_f32 v97, s68, v97
    v_fma_f32 v97, -v96, v96, v97
    v_max_f32 v97, 0, v97
    v_cvt_pk_bf16_f32 v97, 0, v97
    v_add_f32 v97, s69, v97
    v_cvt_pk_bf16_f32 v97, 0, v97
    v_sqrt_f32 v97, v97
    v_cvt_pk_bf16_f32 v96, 0, v96
    v_cvt_pk_bf16_f32 v97, 0, v97
    v_rcp_f32 v97, v97
    s_nop 0
    v_mul_f32 v96, -v96, v97
    v_pk_fma_f32 v[112:113], v[112:113], v[96:97], v[96:97] op_sel:[0,1,0] op_sel_hi:[1,1,0]
    v_pk_fma_f32 v[114:115], v[114:115], v[96:97], v[96:97] op_sel:[0,1,0] op_sel_hi:[1,1,0]
    v_pk_fma_f32 v[116:117], v[116:117], v[96:97], v[96:97] op_sel:[0,1,0] op_sel_hi:[1,1,0]
    v_pk_fma_f32 v[118:119], v[118:119], v[96:97], v[96:97] op_sel:[0,1,0] op_sel_hi:[1,1,0]
    v_pk_fma_f32 v[120:121], v[120:121], v[96:97], v[96:97] op_sel:[0,1,0] op_sel_hi:[1,1,0]
    v_pk_fma_f32 v[122:123], v[122:123], v[96:97], v[96:97] op_sel:[0,1,0] op_sel_hi:[1,1,0]
    v_pk_fma_f32 v[124:125], v[124:125], v[96:97], v[96:97] op_sel:[0,1,0] op_sel_hi:[1,1,0]
    v_pk_fma_f32 v[126:127], v[126:127], v[96:97], v[96:97] op_sel:[0,1,0] op_sel_hi:[1,1,0]
    v_pk_fma_f32 v[112:113], v[112:113], v[168:169], v[184:185]
    v_pk_fma_f32 v[114:115], v[114:115], v[170:171], v[186:187]
    v_pk_fma_f32 v[116:117], v[116:117], v[172:173], v[188:189]
    v_pk_fma_f32 v[118:119], v[118:119], v[174:175], v[190:191]
    v_pk_fma_f32 v[120:121], v[120:121], v[176:177], v[192:193]
    v_pk_fma_f32 v[122:123], v[122:123], v[178:179], v[194:195]
    v_pk_fma_f32 v[124:125], v[124:125], v[180:181], v[196:197]
    v_pk_fma_f32 v[126:127], v[126:127], v[182:183], v[198:199]
    v_cvt_pk_bf16_f32 v128, v112, v113
    v_cvt_pk_bf16_f32 v129, v114, v115
    v_cvt_pk_bf16_f32 v130, v116, v117
    v_cvt_pk_bf16_f32 v131, v118, v119
    v_cvt_pk_bf16_f32 v132, v120, v121
    v_cvt_pk_bf16_f32 v133, v122, v123
    v_cvt_pk_bf16_f32 v134, v124, v125
    v_cvt_pk_bf16_f32 v135, v126, v127
    buffer_store_dwordx4 v[128:131], v233, s[16:19], s96 offen
    buffer_store_dwordx4 v[132:135], v233, s[16:19], s55 offen
    ds_read_b64_tr_b16 a[0:1], v2 offset:0
    ds_read_b64_tr_b16 a[2:3], v2 offset:512
    ds_read_b64_tr_b16 a[4:5], v3 offset:0
    ds_read_b64_tr_b16 a[6:7], v3 offset:512
    ds_read_b64_tr_b16 a[8:9], v4 offset:0
    ds_read_b64_tr_b16 a[10:11], v4 offset:512
    ds_read_b64_tr_b16 a[12:13], v5 offset:0
    ds_read_b64_tr_b16 a[14:15], v5 offset:512
    ds_read_b64_tr_b16 a[16:17], v2 offset:2048
    ds_read_b64_tr_b16 a[18:19], v2 offset:2560
    ds_read_b64_tr_b16 a[20:21], v3 offset:2048
    ds_read_b64_tr_b16 a[22:23], v3 offset:2560
    ds_read_b64_tr_b16 a[24:25], v4 offset:2048
    ds_read_b64_tr_b16 a[26:27], v4 offset:2560
    ds_read_b64_tr_b16 a[28:29], v5 offset:2048
    s_waitcnt lgkmcnt(11)
    ds_read_b64_tr_b16 a[30:31], v5 offset:2560
    ds_read_b64_tr_b16 a[32:33], v2 offset:4096
    ds_read_b64_tr_b16 a[34:35], v2 offset:4608
    ds_read_b64_tr_b16 a[36:37], v3 offset:4096
    s_waitcnt lgkmcnt(11)
    ds_read_b64_tr_b16 a[38:39], v3 offset:4608
    ds_read_b64_tr_b16 a[40:41], v4 offset:4096
    ds_read_b64_tr_b16 a[42:43], v4 offset:4608
    ds_read_b64_tr_b16 a[44:45], v5 offset:4096
    s_waitcnt lgkmcnt(11)
    ds_read_b64_tr_b16 a[46:47], v5 offset:4608
    s_waitcnt vmcnt(0)
    s_mov_b64 exec, 1
    buffer_store_dword v216, v219, s[16:19], s99 offen
    s_mov_b64 exec, -1
    s_mov_b64 exec, 65535
    buffer_load_dword v14, v250, s[16:19], s67 offen sc1
    s_mov_b64 exec, -1
    ds_read_b64_tr_b16 a[48:49], v2 offset:6144
    ds_read_b64_tr_b16 a[50:51], v2 offset:6656
    ds_read_b64_tr_b16 a[52:53], v3 offset:6144
    s_waitcnt lgkmcnt(11)
    ds_read_b64_tr_b16 a[54:55], v3 offset:6656
    ds_read_b64_tr_b16 a[56:57], v4 offset:6144
    ds_read_b64_tr_b16 a[58:59], v4 offset:6656
    ds_read_b64_tr_b16 a[60:61], v5 offset:6144
    s_waitcnt lgkmcnt(11)
    ds_read_b64_tr_b16 a[62:63], v5 offset:6656
    ds_read_b64_tr_b16 a[64:65], v2 offset:8192
    ds_read_b64_tr_b16 a[66:67], v2 offset:8704
    ds_read_b64_tr_b16 a[68:69], v3 offset:8192
    s_waitcnt lgkmcnt(11)
    ds_read_b64_tr_b16 a[70:71], v3 offset:8704
    ds_read_b64_tr_b16 a[72:73], v4 offset:8192
    ds_read_b64_tr_b16 a[74:75], v4 offset:8704
    ds_read_b64_tr_b16 a[76:77], v5 offset:8192
    s_waitcnt lgkmcnt(11)
    ds_read_b64_tr_b16 a[78:79], v5 offset:8704
    ds_read_b64_tr_b16 a[80:81], v2 offset:10240
    ds_read_b64_tr_b16 a[82:83], v2 offset:10752
    ds_read_b64_tr_b16 a[84:85], v3 offset:10240
    s_waitcnt lgkmcnt(11)
    ds_read_b64_tr_b16 a[86:87], v3 offset:10752
    ds_read_b64_tr_b16 a[88:89], v4 offset:10240
    ds_read_b64_tr_b16 a[90:91], v4 offset:10752
    ds_read_b64_tr_b16 a[92:93], v5 offset:10240
    s_waitcnt lgkmcnt(11)
    ds_read_b64_tr_b16 a[94:95], v5 offset:10752
    ds_read_b64_tr_b16 a[96:97], v2 offset:12288
    ds_read_b64_tr_b16 a[98:99], v2 offset:12800
    ds_read_b64_tr_b16 a[100:101], v3 offset:12288
    s_waitcnt lgkmcnt(11)
    ds_read_b64_tr_b16 a[102:103], v3 offset:12800
    ds_read_b64_tr_b16 a[104:105], v4 offset:12288
    ds_read_b64_tr_b16 a[106:107], v4 offset:12800
    ds_read_b64_tr_b16 a[108:109], v5 offset:12288
    s_waitcnt lgkmcnt(11)
    ds_read_b64_tr_b16 a[110:111], v5 offset:12800
    s_mov_b64 exec, 65535
    s_waitcnt vmcnt(0)
    v_cmp_ne_u32 vcc, s36, v14
    s_cbranch_vccnz LL_slow4
LL_back4:
    s_mov_b64 exec, -1
    s_mov_b32 s60, 0
    buffer_load_dwordx4 v[16:19], v1, s[16:19], s60 offen offset:0
    buffer_load_dwordx4 v[20:23], v1, s[16:19], s60 offen offset:1024
    buffer_load_dwordx4 v[24:27], v1, s[16:19], s60 offen offset:2048
    buffer_load_dwordx4 v[28:31], v1, s[16:19], s60 offen offset:3072
    s_mov_b32 s60, 4480
    buffer_load_dwordx4 v[32:35], v1, s[16:19], s60 offen offset:0
    ds_read_b64_tr_b16 a[112:113], v2 offset:14336
    ds_read_b64_tr_b16 a[114:115], v2 offset:14848
    ds_read_b64_tr_b16 a[116:117], v3 offset:14336
    s_waitcnt lgkmcnt(11)
    ds_read_b64_tr_b16 a[118:119], v3 offset:14848
    ds_read_b64_tr_b16 a[120:121], v4 offset:14336
    ds_read_b64_tr_b16 a[122:123], v4 offset:14848
    ds_read_b64_tr_b16 a[124:125], v5 offset:14336
    s_waitcnt lgkmcnt(11)
    ds_read_b64_tr_b16 a[126:127], v5 offset:14848
    ds_read_b64_tr_b16 a[128:129], v2 offset:16384
    ds_read_b64_tr_b16 a[130:131], v2 offset:16896
    ds_read_b64_tr_b16 a[132:133], v3 offset:16384
    s_waitcnt lgkmcnt(11)
    ds_read_b64_tr_b16 a[134:135], v3 offset:16896
    ds_read_b64_tr_b16 a[136:137], v4 offset:16384
    ds_read_b64_tr_b16 a[138:139], v4 offset:16896
    ds_read_b64_tr_b16 a[140:141], v5 offset:16384
    s_waitcnt lgkmcnt(11)
    ds_read_b64_tr_b16 a[142:143], v5 offset:16896
    ds_read_b64_tr_b16 a[144:145], v2 offset:18432
    ds_read_b64_tr_b16 a[146:147], v2 offset:18944
    ds_read_b64_tr_b16 a[148:149], v3 offset:18432
    s_waitcnt lgkmcnt(11)
    ds_read_b64_tr_b16 a[150:151], v3 offset:18944
    ds_read_b64_tr_b16 a[152:153], v4 offset:18432
    ds_read_b64_tr_b16 a[154:155], v4 offset:18944
    ds_read_b64_tr_b16 a[156:157], v5 offset:18432
    s_waitcnt lgkmcnt(11)
    ds_read_b64_tr_b16 a[158:159], v5 offset:18944
    s_waitcnt vmcnt(4)
    v_mfma_f32_32x32x16_bf16 v[144:159], a[0:3], v[16:19], 0
    buffer_load_dwordx4 v[36:39], v1, s[16:19], s60 offen offset:1024
    v_mfma_f32_32x32x16_bf16 v[160:175], a[4:7], v[16:19], 0
    buffer_load_dwordx4 v[40:43], v1, s[16:19], s60 offen offset:2048
    v_mfma_f32_32x32x16_bf16 v[176:191], a[8:11], v[16:19], 0
    ds_read_b64_tr_b16 a[0:1], v2 offset:20480
    ds_read_b64_tr_b16 a[2:3], v2 offset:20992
    buffer_load_dwordx4 v[44:47], v1, s[16:19], s60 offen offset:3072
    v_mfma_f32_32x32x16_bf16 v[192:207], a[12:15], v[16:19], 0
    ds_read_b64_tr_b16 a[4:5], v3 offset:20480
    s_waitcnt lgkmcnt(11)
    ds_read_b64_tr_b16 a[6:7], v3 offset:20992
    s_mov_b32 s60, 8960
    buffer_load_dwordx4 v[48:51], v1, s[16:19], s60 offen offset:0
    s_waitcnt vmcnt(7)
    v_mfma_f32_32x32x16_bf16 v[144:159], a[16:19], v[20:23], v[144:159]
    ds_read_b64_tr_b16 a[8:9], v4 offset:20480
    ds_read_b64_tr_b16 a[10:11], v4 offset:20992
    buffer_load_dwordx4 v[52:55], v1, s[16:19], s60 offen offset:1024
    v_mfma_f32_32x32x16_bf16 v[160:175], a[20:23], v[20:23], v[160:175]
    ds_read_b64_tr_b16 a[12:13], v5 offset:20480
    s_waitcnt lgkmcnt(11)
    ds_read_b64_tr_b16 a[14:15], v5 offset:20992
    buffer_load_dwordx4 v[56:59], v1, s[16:19], s60 offen offset:2048
    v_mfma_f32_32x32x16_bf16 v[176:191], a[24:27], v[20:23], v[176:191]
    ds_read_b64_tr_b16 a[16:17], v2 offset:22528
    ds_read_b64_tr_b16 a[18:19], v2 offset:23040
    buffer_load_dwordx4 v[60:63], v1, s[16:19], s60 offen offset:3072
    v_mfma_f32_32x32x16_bf16 v[192:207], a[28:31], v[20:23], v[192:207]
    ds_read_b64_tr_b16 a[20:21], v3 offset:22528
    s_waitcnt lgkmcnt(11)
    ds_read_b64_tr_b16 a[22:23], v3 offset:23040
    s_mov_b32 s60, 13440
    buffer_load_dwordx4 v[64:67], v1, s[16:19], s60 offen offset:0
    s_waitcnt vmcnt(10)
    v_mfma_f32_32x32x16_bf16 v[144:159], a[32:35], v[24:27], v[144:159]
    ds_read_b64_tr_b16 a[24:25], v4 offset:22528
    ds_read_b64_tr_b16 a[26:27], v4 offset:23040
    buffer_load_dwordx4 v[68:71], v1, s[16:19], s60 offen offset:1024
    v_mfma_f32_32x32x16_bf16 v[160:175], a[36:39], v[24:27], v[160:175]
    ds_read_b64_tr_b16 a[28:29], v5 offset:22528
    s_waitcnt lgkmcnt(11)
    ds_read_b64_tr_b16 a[30:31], v5 offset:23040
    buffer_load_dwordx4 v[72:75], v1, s[16:19], s60 offen offset:2048
    v_mfma_f32_32x32x16_bf16 v[176:191], a[40:43], v[24:27], v[176:191]
    ds_read_b64_tr_b16 a[32:33], v2 offset:24576
    ds_read_b64_tr_b16 a[34:35], v2 offset:25088
    s_mov_b32 s57, 0
    buffer_load_dwordx4 a[160:163], v238, s[16:19], s57 offen offset:0
    v_mfma_f32_32x32x16_bf16 v[192:207], a[44:47], v[24:27], v[192:207]
    ds_read_b64_tr_b16 a[36:37], v3 offset:24576
    s_waitcnt lgkmcnt(11)
    ds_read_b64_tr_b16 a[38:39], v3 offset:25088
    buffer_load_dwordx4 v[76:79], v1, s[16:19], s60 offen offset:3072
    s_waitcnt vmcnt(13)
    v_mfma_f32_32x32x16_bf16 v[144:159], a[48:51], v[28:31], v[144:159]
    ds_read_b64_tr_b16 a[40:41], v4 offset:24576
    ds_read_b64_tr_b16 a[42:43], v4 offset:25088
    buffer_load_dwordx4 a[164:167], v238, s[16:19], s57 offen offset:1024
    v_mfma_f32_32x32x16_bf16 v[160:175], a[52:55], v[28:31], v[160:175]
    ds_read_b64_tr_b16 a[44:45], v5 offset:24576
    s_waitcnt lgkmcnt(11)
    ds_read_b64_tr_b16 a[46:47], v5 offset:25088
    v_mfma_f32_32x32x16_bf16 v[176:191], a[56:59], v[28:31], v[176:191]
    ds_read_b64_tr_b16 a[48:49], v2 offset:26624
    ds_read_b64_tr_b16 a[50:51], v2 offset:27136
    buffer_load_dwordx4 a[168:171], v238, s[16:19], s57 offen offset:2048
    v_mfma_f32_32x32x16_bf16 v[192:207], a[60:63], v[28:31], v[192:207]
    ds_read_b64_tr_b16 a[52:53], v3 offset:26624
    s_waitcnt lgkmcnt(11)
    ds_read_b64_tr_b16 a[54:55], v3 offset:27136
    s_mov_b32 s60, 17920
    buffer_load_dwordx4 v[80:83], v1, s[16:19], s60 offen offset:0
    s_waitcnt vmcnt(15)
    v_mfma_f32_32x32x16_bf16 v[144:159], a[64:67], v[32:35], v[144:159]
    ds_read_b64_tr_b16 a[56:57], v4 offset:26624
    ds_read_b64_tr_b16 a[58:59], v4 offset:27136
    buffer_load_dwordx4 v[84:87], v1, s[16:19], s60 offen offset:1024
    v_mfma_f32_32x32x16_bf16 v[160:175], a[68:71], v[32:35], v[160:175]
    ds_read_b64_tr_b16 a[60:61], v5 offset:26624
    s_waitcnt lgkmcnt(11)
    ds_read_b64_tr_b16 a[62:63], v5 offset:27136
    s_mov_b32 s57, 12288
    buffer_load_dwordx4 a[184:187], v238, s[16:19], s57 offen offset:0
    v_mfma_f32_32x32x16_bf16 v[176:191], a[72:75], v[32:35], v[176:191]
    ds_read_b64_tr_b16 a[64:65], v2 offset:28672
    ds_read_b64_tr_b16 a[66:67], v2 offset:29184
    buffer_load_dwordx4 v[88:91], v1, s[16:19], s60 offen offset:2048
    v_mfma_f32_32x32x16_bf16 v[192:207], a[76:79], v[32:35], v[192:207]
    ds_read_b64_tr_b16 a[68:69], v3 offset:28672
    s_waitcnt lgkmcnt(11)
    ds_read_b64_tr_b16 a[70:71], v3 offset:29184
    s_waitcnt vmcnt(17)
    v_mfma_f32_32x32x16_bf16 v[144:159], a[80:83], v[36:39], v[144:159]
    ds_read_b64_tr_b16 a[72:73], v4 offset:28672
    ds_read_b64_tr_b16 a[74:75], v4 offset:29184
    buffer_load_dwordx4 a[188:191], v238, s[16:19], s57 offen offset:1024
    v_mfma_f32_32x32x16_bf16 v[160:175], a[84:87], v[36:39], v[160:175]
    ds_read_b64_tr_b16 a[76:77], v5 offset:28672
    s_waitcnt lgkmcnt(11)
    ds_read_b64_tr_b16 a[78:79], v5 offset:29184
    buffer_load_dwordx4 v[92:95], v1, s[16:19], s60 offen offset:3072
    v_mfma_f32_32x32x16_bf16 v[176:191], a[88:91], v[36:39], v[176:191]
    ds_read_b64_tr_b16 a[80:81], v2 offset:30720
    ds_read_b64_tr_b16 a[82:83], v2 offset:31232
    s_mov_b32 s60, 22400
    buffer_load_dwordx4 v[96:99], v1, s[16:19], s60 offen offset:0
    v_mfma_f32_32x32x16_bf16 v[192:207], a[92:95], v[36:39], v[192:207]
    ds_read_b64_tr_b16 a[84:85], v3 offset:30720
    s_waitcnt lgkmcnt(11)
    ds_read_b64_tr_b16 a[86:87], v3 offset:31232
    buffer_load_dwordx4 a[192:195], v238, s[16:19], s57 offen offset:2048
    s_waitcnt vmcnt(20)
    v_mfma_f32_32x32x16_bf16 v[144:159], a[96:99], v[40:43], v[144:159]
    ds_read_b64_tr_b16 a[88:89], v4 offset:30720
    ds_read_b64_tr_b16 a[90:91], v4 offset:31232
    buffer_load_dwordx4 v[100:103], v1, s[16:19], s60 offen offset:1024
    v_mfma_f32_32x32x16_bf16 v[160:175], a[100:103], v[40:43], v[160:175]
    ds_read_b64_tr_b16 a[92:93], v5 offset:30720
    s_waitcnt lgkmcnt(11)
    ds_read_b64_tr_b16 a[94:95], v5 offset:31232
    v_mfma_f32_32x32x16_bf16 v[176:191], a[104:107], v[40:43], v[176:191]
    ds_read_b64_tr_b16 a[96:97], v2 offset:32768
    ds_read_b64_tr_b16 a[98:99], v2 offset:33280
    s_mov_b32 s57, 0
    buffer_load_dwordx4 a[172:175], v239, s[16:19], s57 offen offset:0
    v_mfma_f32_32x32x16_bf16 v[192:207], a[108:111], v[40:43], v[192:207]
    ds_read_b64_tr_b16 a[100:101], v3 offset:32768
    s_waitcnt lgkmcnt(11)
    ds_read_b64_tr_b16 a[102:103], v3 offset:33280
    buffer_load_dwordx4 v[104:107], v1, s[16:19], s60 offen offset:2048
    s_waitcnt vmcnt(22)
    v_mfma_f32_32x32x16_bf16 v[144:159], a[112:115], v[44:47], v[144:159]
    ds_read_b64_tr_b16 a[104:105], v2 offset:34816
    ds_read_b64_tr_b16 a[106:107], v2 offset:35328
    buffer_load_dwordx4 v[108:111], v1, s[16:19], s60 offen offset:3072
    v_mfma_f32_32x32x16_bf16 v[160:175], a[116:119], v[44:47], v[160:175]
    ds_read_b64_tr_b16 a[108:109], v3 offset:34816
    s_waitcnt lgkmcnt(11)
    ds_read_b64_tr_b16 a[110:111], v3 offset:35328
    buffer_load_dwordx4 a[176:179], v239, s[16:19], s57 offen offset:1024
    v_mfma_f32_32x32x16_bf16 v[176:191], a[120:123], v[44:47], v[176:191]
    ds_read_b64_tr_b16 a[112:113], v2 offset:36864
    ds_read_b64_tr_b16 a[114:115], v2 offset:37376
    s_mov_b32 s60, 26880
    buffer_load_dwordx4 v[112:115], v1, s[16:19], s60 offen offset:0
    v_mfma_f32_32x32x16_bf16 v[192:207], a[124:127], v[44:47], v[192:207]
    ds_read_b64_tr_b16 a[116:117], v3 offset:36864
    s_waitcnt lgkmcnt(11)
    ds_read_b64_tr_b16 a[118:119], v3 offset:37376
    s_waitcnt vmcnt(24)
    v_mfma_f32_32x32x16_bf16 v[144:159], a[128:131], v[48:51], v[144:159]
    ds_read_b64_tr_b16 a[120:121], v2 offset:38912
    ds_read_b64_tr_b16 a[122:123], v2 offset:39424
    buffer_load_dwordx4 a[180:183], v239, s[16:19], s57 offen offset:2048
    v_mfma_f32_32x32x16_bf16 v[160:175], a[132:135], v[48:51], v[160:175]
    ds_read_b64_tr_b16 a[124:125], v3 offset:38912
    s_waitcnt lgkmcnt(11)
    ds_read_b64_tr_b16 a[126:127], v3 offset:39424
    buffer_load_dwordx4 v[116:119], v1, s[16:19], s60 offen offset:1024
    v_mfma_f32_32x32x16_bf16 v[176:191], a[136:139], v[48:51], v[176:191]
    ds_read_b64_tr_b16 a[128:129], v2 offset:40960
    ds_read_b64_tr_b16 a[130:131], v2 offset:41472
    buffer_load_dwordx4 v[120:123], v1, s[16:19], s60 offen offset:2048
    v_mfma_f32_32x32x16_bf16 v[192:207], a[140:143], v[48:51], v[192:207]
    ds_read_b64_tr_b16 a[132:133], v3 offset:40960
    s_waitcnt lgkmcnt(11)
    ds_read_b64_tr_b16 a[134:135], v3 offset:41472
    s_waitcnt vmcnt(26)
    v_mfma_f32_32x32x16_bf16 v[144:159], a[144:147], v[52:55], v[144:159]
    ds_read_b64_tr_b16 a[136:137], v2 offset:43008
    ds_read_b64_tr_b16 a[138:139], v2 offset:43520
    s_mov_b32 s57, 12288
    buffer_load_dwordx4 a[196:199], v239, s[16:19], s57 offen offset:0
    v_mfma_f32_32x32x16_bf16 v[160:175], a[148:151], v[52:55], v[160:175]
    ds_read_b64_tr_b16 a[140:141], v3 offset:43008
    s_waitcnt lgkmcnt(11)
    ds_read_b64_tr_b16 a[142:143], v3 offset:43520
    buffer_load_dwordx4 v[124:127], v1, s[16:19], s60 offen offset:3072
    v_mfma_f32_32x32x16_bf16 v[176:191], a[152:155], v[52:55], v[176:191]
    ds_read_b64_tr_b16 a[144:145], v2 offset:45056
    ds_read_b64_tr_b16 a[146:147], v2 offset:45568
    s_mov_b32 s60, 31360
    buffer_load_dwordx4 v[128:131], v1, s[16:19], s60 offen offset:0
    v_mfma_f32_32x32x16_bf16 v[192:207], a[156:159], v[52:55], v[192:207]
    ds_read_b64_tr_b16 a[148:149], v3 offset:45056
    s_waitcnt lgkmcnt(11)
    ds_read_b64_tr_b16 a[150:151], v3 offset:45568
    buffer_load_dwordx4 a[200:203], v239, s[16:19], s57 offen offset:1024
    s_waitcnt vmcnt(29)
    v_mfma_f32_32x32x16_bf16 v[144:159], a[0:3], v[56:59], v[144:159]
    ds_read_b64_tr_b16 a[152:153], v2 offset:47104
    ds_read_b64_tr_b16 a[154:155], v2 offset:47616
    buffer_load_dwordx4 v[132:135], v1, s[16:19], s60 offen offset:1024
    v_mfma_f32_32x32x16_bf16 v[160:175], a[4:7], v[56:59], v[160:175]
    ds_read_b64_tr_b16 a[156:157], v3 offset:47104
    s_waitcnt lgkmcnt(11)
    ds_read_b64_tr_b16 a[158:159], v3 offset:47616
    v_mfma_f32_32x32x16_bf16 v[176:191], a[8:11], v[56:59], v[176:191]
    ds_read_b64_tr_b16 a[0:1], v2 offset:49152
    ds_read_b64_tr_b16 a[2:3], v2 offset:49664
    buffer_load_dwordx4 a[204:207], v239, s[16:19], s57 offen offset:2048
    v_mfma_f32_32x32x16_bf16 v[192:207], a[12:15], v[56:59], v[192:207]
    ds_read_b64_tr_b16 a[4:5], v3 offset:49152
    s_waitcnt lgkmcnt(11)
    ds_read_b64_tr_b16 a[6:7], v3 offset:49664
    buffer_load_dwordx4 v[136:139], v1, s[16:19], s60 offen offset:2048
    s_waitcnt vmcnt(31)
    v_mfma_f32_32x32x16_bf16 v[144:159], a[16:19], v[60:63], v[144:159]
    ds_read_b64_tr_b16 a[8:9], v2 offset:51200
    ds_read_b64_tr_b16 a[10:11], v2 offset:51712
    buffer_load_dwordx4 v[140:143], v1, s[16:19], s60 offen offset:3072
    v_mfma_f32_32x32x16_bf16 v[160:175], a[20:23], v[60:63], v[160:175]
    ds_read_b64_tr_b16 a[12:13], v3 offset:51200
    s_waitcnt lgkmcnt(11)
    ds_read_b64_tr_b16 a[14:15], v3 offset:51712
    v_mfma_f32_32x32x16_bf16 v[176:191], a[24:27], v[60:63], v[176:191]
    ds_read_b64_tr_b16 a[16:17], v2 offset:53248
    ds_read_b64_tr_b16 a[18:19], v2 offset:53760
    v_mfma_f32_32x32x16_bf16 v[192:207], a[28:31], v[60:63], v[192:207]
    ds_read_b64_tr_b16 a[20:21], v3 offset:53248
    s_waitcnt lgkmcnt(11)
    ds_read_b64_tr_b16 a[22:23], v3 offset:53760
    s_waitcnt vmcnt(31)
    v_mfma_f32_32x32x16_bf16 v[144:159], a[32:35], v[64:67], v[144:159]
    ds_read_b64_tr_b16 a[24:25], v2 offset:55296
    ds_read_b64_tr_b16 a[26:27], v2 offset:55808
    v_mfma_f32_32x32x16_bf16 v[160:175], a[36:39], v[64:67], v[160:175]
    ds_read_b64_tr_b16 a[28:29], v3 offset:55296
    s_waitcnt lgkmcnt(11)
    ds_read_b64_tr_b16 a[30:31], v3 offset:55808
    v_mfma_f32_32x32x16_bf16 v[176:191], a[40:43], v[64:67], v[176:191]
    ds_read_b64_tr_b16 a[32:33], v2 offset:57344
    ds_read_b64_tr_b16 a[34:35], v2 offset:57856
    v_mfma_f32_32x32x16_bf16 v[192:207], a[44:47], v[64:67], v[192:207]
    ds_read_b64_tr_b16 a[36:37], v3 offset:57344
    s_waitcnt lgkmcnt(11)
    ds_read_b64_tr_b16 a[38:39], v3 offset:57856
    s_mov_b32 s57, 24576
    buffer_load_dwordx4 a[208:211], v238, s[16:19], s57 offen offset:0
    s_waitcnt vmcnt(31)
    v_mfma_f32_32x32x16_bf16 v[144:159], a[48:51], v[68:71], v[144:159]
    ds_read_b64_tr_b16 a[40:41], v2 offset:59392
    ds_read_b64_tr_b16 a[42:43], v2 offset:59904
    v_mfma_f32_32x32x16_bf16 v[160:175], a[52:55], v[68:71], v[160:175]
    ds_read_b64_tr_b16 a[44:45], v3 offset:59392
    s_waitcnt lgkmcnt(11)
    ds_read_b64_tr_b16 a[46:47], v3 offset:59904
    v_mfma_f32_32x32x16_bf16 v[176:191], a[56:59], v[68:71], v[176:191]
    ds_read_b64_tr_b16 a[48:49], v2 offset:61440
    ds_read_b64_tr_b16 a[50:51], v2 offset:61952
    buffer_load_dwordx4 a[212:215], v238, s[16:19], s57 offen offset:1024
    v_mfma_f32_32x32x16_bf16 v[192:207], a[60:63], v[68:71], v[192:207]
    ds_read_b64_tr_b16 a[52:53], v3 offset:61440
    s_waitcnt lgkmcnt(11)
    ds_read_b64_tr_b16 a[54:55], v3 offset:61952
    s_waitcnt vmcnt(31)
    v_mfma_f32_32x32x16_bf16 v[144:159], a[64:67], v[72:75], v[144:159]
    ds_read_b64_tr_b16 a[56:57], v2 offset:63488
    ds_read_b64_tr_b16 a[58:59], v2 offset:64000
    v_mfma_f32_32x32x16_bf16 v[160:175], a[68:71], v[72:75], v[160:175]
    ds_read_b64_tr_b16 a[60:61], v3 offset:63488
    s_waitcnt lgkmcnt(11)
    ds_read_b64_tr_b16 a[62:63], v3 offset:64000
    buffer_load_dwordx4 a[216:219], v238, s[16:19], s57 offen offset:2048
    v_mfma_f32_32x32x16_bf16 v[176:191], a[72:75], v[72:75], v[176:191]
    ds_read_b64_tr_b16 a[64:65], v4 offset:32768
    ds_read_b64_tr_b16 a[66:67], v4 offset:33280
    v_mfma_f32_32x32x16_bf16 v[192:207], a[76:79], v[72:75], v[192:207]
    ds_read_b64_tr_b16 a[68:69], v5 offset:32768
    s_waitcnt lgkmcnt(11)
    ds_read_b64_tr_b16 a[70:71], v5 offset:33280
    s_mov_b32 s57, 36864
    buffer_load_dwordx4 a[232:235], v238, s[16:19], s57 offen offset:0
    s_waitcnt vmcnt(31)
    v_mfma_f32_32x32x16_bf16 v[144:159], a[80:83], v[76:79], v[144:159]
    ds_read_b64_tr_b16 a[72:73], v4 offset:34816
    ds_read_b64_tr_b16 a[74:75], v4 offset:35328
    v_mfma_f32_32x32x16_bf16 v[160:175], a[84:87], v[76:79], v[160:175]
    ds_read_b64_tr_b16 a[76:77], v5 offset:34816
    s_waitcnt lgkmcnt(11)
    ds_read_b64_tr_b16 a[78:79], v5 offset:35328
    buffer_load_dwordx4 a[236:239], v238, s[16:19], s57 offen offset:1024
    v_mfma_f32_32x32x16_bf16 v[176:191], a[88:91], v[76:79], v[176:191]
    s_barrier
    s_waitcnt vmcnt(15)
    ds_write_b128 v7, a[160:163] offset:0
    v_mfma_f32_32x32x16_bf16 v[192:207], a[92:95], v[76:79], v[192:207]
    buffer_load_dwordx4 a[240:243], v238, s[16:19], s57 offen offset:2048
    v_mfma_f32_32x32x16_bf16 v[144:159], a[96:99], v[80:83], v[144:159]
    ds_write_b128 v7, a[164:167] offset:1024
    s_add_u32 s3, s20, 0
    buffer_load_dwordx4 a[80:83], v11, s[16:19], s3 offen offset:0
    v_mfma_f32_32x32x16_bf16 v[160:175], a[100:103], v[80:83], v[160:175]
    v_mfma_f32_32x32x16_bf16 v[144:159], a[104:107], v[84:87], v[144:159]
    ds_write_b128 v7, a[168:171] offset:2048
    v_mfma_f32_32x32x16_bf16 v[160:175], a[108:111], v[84:87], v[160:175]
    s_mov_b32 s57, 24576
    buffer_load_dwordx4 a[220:223], v239, s[16:19], s57 offen offset:0
    v_mfma_f32_32x32x16_bf16 v[144:159], a[112:115], v[88:91], v[144:159]
    s_waitcnt lgkmcnt(11)
    ds_write_b128 v8, a[172:175] offset:3072
    v_mfma_f32_32x32x16_bf16 v[160:175], a[116:119], v[88:91], v[160:175]
    buffer_load_dwordx4 a[224:227], v239, s[16:19], s57 offen offset:1024
    v_mfma_f32_32x32x16_bf16 v[144:159], a[120:123], v[92:95], v[144:159]
    ds_write_b128 v8, a[176:179] offset:4096
    buffer_load_dwordx4 a[84:87], v11, s[16:19], s3 offen offset:1024
    v_mfma_f32_32x32x16_bf16 v[160:175], a[124:127], v[92:95], v[160:175]
    v_mfma_f32_32x32x16_bf16 v[144:159], a[128:131], v[96:99], v[144:159]
    ds_write_b128 v8, a[180:183] offset:5120
    v_mfma_f32_32x32x16_bf16 v[160:175], a[132:135], v[96:99], v[160:175]
    buffer_load_dwordx4 a[228:231], v239, s[16:19], s57 offen offset:2048
    v_mfma_f32_32x32x16_bf16 v[144:159], a[136:139], v[100:103], v[144:159]
    ds_read_b64_tr_b16 a[88:89], v4 offset:36864
    s_waitcnt lgkmcnt(11)
    ds_read_b64_tr_b16 a[90:91], v4 offset:37376
    v_mfma_f32_32x32x16_bf16 v[160:175], a[140:143], v[100:103], v[160:175]
    ds_read_b64_tr_b16 a[92:93], v5 offset:36864
    ds_read_b64_tr_b16 a[94:95], v5 offset:37376
    s_mov_b32 s57, 36864
    buffer_load_dwordx4 a[244:247], v239, s[16:19], s57 offen offset:0
    v_mfma_f32_32x32x16_bf16 v[144:159], a[144:147], v[104:107], v[144:159]
    ds_read_b64_tr_b16 a[96:97], v4 offset:38912
    s_waitcnt lgkmcnt(11)
    ds_read_b64_tr_b16 a[98:99], v4 offset:39424
    buffer_load_dwordx4 a[100:103], v11, s[16:19], s3 offen offset:2048
    v_mfma_f32_32x32x16_bf16 v[160:175], a[148:151], v[104:107], v[160:175]
    s_waitcnt lgkmcnt(6)
    s_barrier
    v_mfma_f32_32x32x16_bf16 v[144:159], a[152:155], v[108:111], v[144:159]
    s_waitcnt vmcnt(15)
    ds_write_b128 v7, a[184:187] offset:16384
    v_mfma_f32_32x32x16_bf16 v[160:175], a[156:159], v[108:111], v[160:175]
    buffer_load_dwordx4 a[248:251], v239, s[16:19], s57 offen offset:1024
    v_mfma_f32_32x32x16_bf16 v[144:159], a[0:3], v[112:115], v[144:159]
    ds_write_b128 v7, a[188:191] offset:17408
    v_mfma_f32_32x32x16_bf16 v[160:175], a[4:7], v[112:115], v[160:175]
    buffer_load_dwordx4 a[252:255], v239, s[16:19], s57 offen offset:2048
    v_mfma_f32_32x32x16_bf16 v[144:159], a[8:11], v[116:119], v[144:159]
    ds_write_b128 v7, a[192:195] offset:18432
    buffer_load_dwordx4 a[104:107], v11, s[16:19], s3 offen offset:3072
    v_mfma_f32_32x32x16_bf16 v[160:175], a[12:15], v[116:119], v[160:175]
    v_mfma_f32_32x32x16_bf16 v[144:159], a[16:19], v[120:123], v[144:159]
    ds_write_b128 v8, a[196:199] offset:19456
    v_mfma_f32_32x32x16_bf16 v[160:175], a[20:23], v[120:123], v[160:175]
    buffer_store_dword v208, v232, s[16:19], s98 offen offset:0
    v_mfma_f32_32x32x16_bf16 v[144:159], a[24:27], v[124:127], v[144:159]
    ds_write_b128 v8, a[200:203] offset:20480
    v_mfma_f32_32x32x16_bf16 v[160:175], a[28:31], v[124:127], v[160:175]
    buffer_store_dword v209, v232, s[16:19], s98 offen offset:128
    v_mfma_f32_32x32x16_bf16 v[144:159], a[32:35], v[128:131], v[144:159]
    ds_write_b128 v8, a[204:207] offset:21504
    s_add_u32 s3, s20, 4096
    buffer_load_dwordx4 a[108:111], v11, s[16:19], s3 offen offset:0
    v_mfma_f32_32x32x16_bf16 v[160:175], a[36:39], v[128:131], v[160:175]
    v_mfma_f32_32x32x16_bf16 v[144:159], a[40:43], v[132:135], v[144:159]
    ds_read_b64_tr_b16 a[112:113], v5 offset:38912
    ds_read_b64_tr_b16 a[114:115], v5 offset:39424
    v_mfma_f32_32x32x16_bf16 v[160:175], a[44:47], v[132:135], v[160:175]
    ds_read_b64_tr_b16 a[116:117], v4 offset:40960
    s_waitcnt lgkmcnt(11)
    ds_read_b64_tr_b16 a[118:119], v4 offset:41472
    buffer_store_dword v210, v232, s[16:19], s98 offen offset:256
    s_waitcnt vmcnt(21)
    v_mfma_f32_32x32x16_bf16 v[144:159], a[48:51], v[136:139], v[144:159]
    ds_read_b64_tr_b16 a[120:121], v5 offset:40960
    ds_read_b64_tr_b16 a[122:123], v5 offset:41472
    v_mfma_f32_32x32x16_bf16 v[160:175], a[52:55], v[136:139], v[160:175]
    ds_read_b64_tr_b16 a[124:125], v4 offset:43008
    s_waitcnt lgkmcnt(11)
    ds_read_b64_tr_b16 a[126:127], v4 offset:43520
    buffer_store_dword v211, v232, s[16:19], s98 offen offset:384
    s_waitcnt vmcnt(21)
    v_mfma_f32_32x32x16_bf16 v[144:159], a[56:59], v[140:143], v[144:159]
    ds_read_b64_tr_b16 a[128:129], v5 offset:43008
    ds_read_b64_tr_b16 a[130:131], v5 offset:43520
    buffer_load_dwordx4 a[132:135], v11, s[16:19], s3 offen offset:1024
    v_mfma_f32_32x32x16_bf16 v[160:175], a[60:63], v[140:143], v[160:175]
    ds_read_b64_tr_b16 a[136:137], v4 offset:45056
    s_waitcnt lgkmcnt(11)
    ds_read_b64_tr_b16 a[138:139], v4 offset:45568
    v_mfma_f32_32x32x16_bf16 v[176:191], a[64:67], v[80:83], v[176:191]
    ds_read_b64_tr_b16 a[140:141], v5 offset:45056
    ds_read_b64_tr_b16 a[142:143], v5 offset:45568
    v_and_b32 v2, 63, v0
    v_lshlrev_b32 v9, 7, v2
    v_add_u32 v9, s97, v9
    v_lshlrev_b32 v2, 4, v2
    v_mfma_f32_32x32x16_bf16 v[192:207], a[68:71], v[80:83], v[192:207]
    ds_read_b64_tr_b16 a[144:145], v4 offset:47104
    s_waitcnt lgkmcnt(11)
    ds_read_b64_tr_b16 a[146:147], v4 offset:47616
    v_max_f32 v144, 0, v144
    v_max_f32 v145, 0, v145
    v_max_f32 v146, 0, v146
    v_mfma_f32_32x32x16_bf16 v[176:191], a[72:75], v[84:87], v[176:191]
    ds_read_b64_tr_b16 a[160:161], v5 offset:47104
    ds_read_b64_tr_b16 a[162:163], v5 offset:47616
    v_max_f32 v147, 0, v147
    v_max_f32 v148, 0, v148
    v_max_f32 v149, 0, v149
    v_max_f32 v150, 0, v150
    v_mfma_f32_32x32x16_bf16 v[192:207], a[76:79], v[84:87], v[192:207]
    ds_read_b64_tr_b16 a[164:165], v4 offset:49152
    s_waitcnt lgkmcnt(11)
    ds_read_b64_tr_b16 a[166:167], v4 offset:49664
    v_max_f32 v151, 0, v151
    v_pk_mul_f32 v[144:145], v[144:145], v[152:153]
    v_pk_mul_f32 v[146:147], v[146:147], v[154:155]
    v_mfma_f32_32x32x16_bf16 v[176:191], a[88:91], v[88:91], v[176:191]
    ds_read_b64_tr_b16 a[168:169], v5 offset:49152
    ds_read_b64_tr_b16 a[170:171], v5 offset:49664
    v_pk_mul_f32 v[148:149], v[148:149], v[156:157]
    v_pk_mul_f32 v[150:151], v[150:151], v[158:159]
    v_cvt_pk_bf16_f32 v152, v144, v145
    v_cvt_pk_bf16_f32 v153, v146, v147
    buffer_store_dword v212, v232, s[16:19], s58 offen offset:0
    v_mfma_f32_32x32x16_bf16 v[192:207], a[92:95], v[88:91], v[192:207]
    ds_read_b64_tr_b16 a[172:173], v4 offset:51200
    s_waitcnt lgkmcnt(11)
    ds_read_b64_tr_b16 a[174:175], v4 offset:51712
    v_cvt_pk_bf16_f32 v154, v148, v149
    v_cvt_pk_bf16_f32 v155, v150, v151
    buffer_store_dwordx4 v[152:155], v10, s[16:19], 0 offen offset:0 sc1
    buffer_store_dword v213, v232, s[16:19], s58 offen offset:128
    v_mfma_f32_32x32x16_bf16 v[176:191], a[96:99], v[92:95], v[176:191]
    ds_read_b64_tr_b16 a[176:177], v5 offset:51200
    ds_read_b64_tr_b16 a[178:179], v5 offset:51712
    v_max_f32 v160, 0, v160
    v_max_f32 v161, 0, v161
    v_max_f32 v162, 0, v162
    v_max_f32 v163, 0, v163
    buffer_store_dword v214, v232, s[16:19], s58 offen offset:256
    v_mfma_f32_32x32x16_bf16 v[192:207], a[112:115], v[92:95], v[192:207]
    ds_read_b64_tr_b16 a[180:181], v4 offset:53248
    s_waitcnt lgkmcnt(11)
    ds_read_b64_tr_b16 a[182:183], v4 offset:53760
    v_max_f32 v164, 0, v164
    v_max_f32 v165, 0, v165
    v_max_f32 v166, 0, v166
    buffer_store_dword v215, v232, s[16:19], s58 offen offset:384
    v_mfma_f32_32x32x16_bf16 v[176:191], a[116:119], v[96:99], v[176:191]
    ds_read_b64_tr_b16 a[148:149], v5 offset:53248
    ds_read_b64_tr_b16 a[150:151], v5 offset:53760
    v_max_f32 v167, 0, v167
    v_pk_mul_f32 v[160:161], v[160:161], v[168:169]
    v_pk_mul_f32 v[162:163], v[162:163], v[170:171]
    v_pk_mul_f32 v[164:165], v[164:165], v[172:173]
    v_mfma_f32_32x32x16_bf16 v[192:207], a[120:123], v[96:99], v[192:207]
    s_waitcnt lgkmcnt(12)
    s_barrier
    s_waitcnt vmcnt(16)
    ds_write_b128 v7, a[208:211] offset:32768
    v_pk_mul_f32 v[166:167], v[166:167], v[174:175]
    v_cvt_pk_bf16_f32 v168, v160, v161
    v_mfma_f32_32x32x16_bf16 v[176:191], a[124:127], v[100:103], v[176:191]
    v_cvt_pk_bf16_f32 v169, v162, v163
    v_cvt_pk_bf16_f32 v170, v164, v165
    v_cvt_pk_bf16_f32 v171, v166, v167
    buffer_store_dwordx4 v[168:171], v10, s[16:19], 0 offen offset:1024 sc1
    buffer_load_dwordx4 a[152:155], v11, s[16:19], s3 offen offset:2048
    v_add_u32 v2, s73, v2
    v_mfma_f32_32x32x16_bf16 v[192:207], a[128:131], v[100:103], v[192:207]
    ds_write_b128 v7, a[212:215] offset:33792
    v_add_u32 v3, 114688, v2
    s_lshr_b32 s32, s45, 1
    s_mul_i32 s32, s32, 4480
    s_and_b32 s33, s45, 1
    s_lshl_b32 s33, s33, 11
    v_mfma_f32_32x32x16_bf16 v[176:191], a[136:139], v[104:107], v[176:191]
    s_add_u32 s32, s32, s33
    s_andn2_b32 s33, s75, 512
    s_mul_i32 s34, s24, 10
    s_lshr_b32 s34, s34, 16
    s_lshr_b32 s35, s34, 1
    s_mul_i32 s35, s35, 4480
    v_mfma_f32_32x32x16_bf16 v[192:207], a[140:143], v[104:107], v[192:207]
    ds_read_b64_tr_b16 a[156:157], v4 offset:55296
    s_waitcnt lgkmcnt(11)
    ds_read_b64_tr_b16 a[158:159], v4 offset:55808
    s_and_b32 s34, s34, 1
    s_lshl_b32 s34, s34, 11
    s_add_u32 s4, s34, s35
    v_mfma_f32_32x32x16_bf16 v[176:191], a[144:147], v[108:111], v[176:191]
    s_mul_i32 s34, s25, 10
    s_lshr_b32 s34, s34, 16
    s_lshr_b32 s35, s34, 1
    s_mul_i32 s35, s35, 4480
    s_and_b32 s34, s34, 1
    s_lshl_b32 s34, s34, 11
    v_mfma_f32_32x32x16_bf16 v[192:207], a[160:163], v[108:111], v[192:207]
    ds_read_b64_tr_b16 a[0:1], v5 offset:55296
    ds_read_b64_tr_b16 a[2:3], v5 offset:55808
    s_add_u32 s3, s21, 0
    buffer_load_dwordx4 a[4:7], v11, s[16:19], s3 offen offset:0
    s_add_u32 s5, s34, s35
    s_mul_i32 s34, s26, 10
    v_mfma_f32_32x32x16_bf16 v[176:191], a[164:167], v[112:115], v[176:191]
    ds_read_b64_tr_b16 a[8:9], v4 offset:57344
    s_waitcnt lgkmcnt(11)
    ds_read_b64_tr_b16 a[10:11], v4 offset:57856
    s_add_u32 s3, s20, 4096
    buffer_load_dwordx4 a[12:15], v11, s[16:19], s3 offen offset:3072
    s_lshr_b32 s34, s34, 16
    v_mfma_f32_32x32x16_bf16 v[192:207], a[168:171], v[112:115], v[192:207]
    ds_read_b64_tr_b16 a[16:17], v5 offset:57344
    ds_read_b64_tr_b16 a[18:19], v5 offset:57856
    s_lshr_b32 s35, s34, 1
    s_mul_i32 s35, s35, 4480
    s_and_b32 s34, s34, 1
    s_lshl_b32 s34, s34, 11
    v_mfma_f32_32x32x16_bf16 v[176:191], a[172:175], v[116:119], v[176:191]
    ds_read_b64_tr_b16 a[20:21], v4 offset:59392
    s_waitcnt lgkmcnt(11)
    ds_read_b64_tr_b16 a[22:23], v4 offset:59904
    s_add_u32 s6, s34, s35
    s_mul_i32 s34, s27, 10
    s_lshr_b32 s34, s34, 16
    v_mfma_f32_32x32x16_bf16 v[192:207], a[176:179], v[116:119], v[192:207]
    ds_read_b64_tr_b16 a[24:25], v5 offset:59392
    ds_read_b64_tr_b16 a[26:27], v5 offset:59904
    s_add_u32 s3, s22, 0
    buffer_load_dwordx4 a[28:31], v11, s[16:19], s3 offen offset:0
    s_lshr_b32 s35, s34, 1
    s_mul_i32 s35, s35, 4480
    v_mfma_f32_32x32x16_bf16 v[176:191], a[180:183], v[120:123], v[176:191]
    ds_read_b64_tr_b16 a[32:33], v4 offset:61440
    s_waitcnt lgkmcnt(11)
    ds_read_b64_tr_b16 a[34:35], v4 offset:61952
    s_and_b32 s34, s34, 1
    s_lshl_b32 s34, s34, 11
    s_add_u32 s7, s34, s35
    v_mfma_f32_32x32x16_bf16 v[192:207], a[148:151], v[120:123], v[192:207]
    ds_read_b64_tr_b16 a[36:37], v5 offset:61440
    ds_read_b64_tr_b16 a[38:39], v5 offset:61952
    s_add_u32 s3, s23, 0
    buffer_load_dwordx4 a[40:43], v11, s[16:19], s3 offen offset:0
    v_mfma_f32_32x32x16_bf16 v[176:191], a[156:159], v[124:127], v[176:191]
    ds_read_b64_tr_b16 a[44:45], v4 offset:63488
    s_waitcnt lgkmcnt(11)
    ds_read_b64_tr_b16 a[46:47], v4 offset:64000
    s_add_u32 s3, s20, 8192
    buffer_load_dwordx4 a[48:51], v11, s[16:19], s3 offen offset:0
    v_mfma_f32_32x32x16_bf16 v[192:207], a[0:3], v[124:127], v[192:207]
    ds_read_b64_tr_b16 a[52:53], v5 offset:63488
    ds_read_b64_tr_b16 a[54:55], v5 offset:64000
    v_mfma_f32_32x32x16_bf16 v[176:191], a[8:11], v[128:131], v[176:191]
    ds_read_b64_tr_b16 a[56:57], v6 offset:0
    s_waitcnt lgkmcnt(11)
    ds_read_b64_tr_b16 a[58:59], v6 offset:384
    v_mfma_f32_32x32x16_bf16 v[192:207], a[16:19], v[128:131], v[192:207]
    ds_read_b64_tr_b16 a[184:185], v6 offset:32
    ds_read_b64_tr_b16 a[186:187], v6 offset:416
    s_add_u32 s3, s21, 0
    buffer_load_dwordx4 a[188:191], v11, s[16:19], s3 offen offset:1024
    v_mfma_f32_32x32x16_bf16 v[176:191], a[20:23], v[132:135], v[176:191]
    ds_read_b64_tr_b16 a[192:193], v6 offset:1536
    s_waitcnt lgkmcnt(11)
    ds_read_b64_tr_b16 a[194:195], v6 offset:1920
    v_mfma_f32_32x32x16_bf16 v[192:207], a[24:27], v[132:135], v[192:207]
    ds_read_b64_tr_b16 a[196:197], v6 offset:1568
    ds_read_b64_tr_b16 a[198:199], v6 offset:1952
    s_add_u32 s3, s22, 0
    buffer_load_dwordx4 a[200:203], v11, s[16:19], s3 offen offset:1024
    v_mfma_f32_32x32x16_bf16 v[176:191], a[32:35], v[136:139], v[176:191]
    ds_read_b64_tr_b16 a[204:205], v6 offset:3072
    s_waitcnt lgkmcnt(11)
    ds_read_b64_tr_b16 a[206:207], v6 offset:3456
    s_add_u32 s3, s20, 8192
    buffer_load_dwordx4 a[60:63], v11, s[16:19], s3 offen offset:1024
    v_mfma_f32_32x32x16_bf16 v[192:207], a[36:39], v[136:139], v[192:207]
    ds_read_b64_tr_b16 a[64:65], v6 offset:3104
    ds_read_b64_tr_b16 a[66:67], v6 offset:3488
    v_mfma_f32_32x32x16_bf16 v[176:191], a[44:47], v[140:143], v[176:191]
    ds_read_b64_tr_b16 a[68:69], v6 offset:4608
    s_waitcnt lgkmcnt(11)
    ds_read_b64_tr_b16 a[70:71], v6 offset:4992
    v_mfma_f32_32x32x16_bf16 v[192:207], a[52:55], v[140:143], v[192:207]
    ds_read_b64_tr_b16 a[72:73], v6 offset:4640
    ds_read_b64_tr_b16 a[74:75], v6 offset:5024
    s_add_u32 s3, s23, 0
    buffer_load_dwordx4 a[76:79], v11, s[16:19], s3 offen offset:1024
    v_mfma_f32_32x32x16_bf16 v[208:223], a[56:59], v[16:19], 0
    s_mul_i32 s34, s72, 71680
    s_mul_i32 s35, s44, 8960
    s_add_u32 s34, s34, s35
    s_add_u32 s34, s34, 22020096
    v_and_b32 v4, 63, v0
    v_lshlrev_b32 v4, 4, v4
    s_waitcnt lgkmcnt(12)
    v_mfma_f32_32x32x16_bf16 v[224:239], a[184:187], v[16:19], 0
    ds_read_b64_tr_b16 a[88:89], v6 offset:6144
    ds_read_b64_tr_b16 a[90:91], v6 offset:6528
    v_max_f32 v176, 0, v176
    v_max_f32 v177, 0, v177
    v_max_f32 v178, 0, v178
    v_max_f32 v179, 0, v179
    s_waitcnt lgkmcnt(12)
    v_mfma_f32_32x32x16_bf16 v[208:223], a[192:195], v[20:23], v[208:223]
    ds_read_b64_tr_b16 a[92:93], v6 offset:6176
    ds_read_b64_tr_b16 a[94:95], v6 offset:6560
    v_max_f32 v180, 0, v180
    v_max_f32 v181, 0, v181
    v_max_f32 v182, 0, v182
    v_max_f32 v183, 0, v183
    s_waitcnt lgkmcnt(12)
    v_mfma_f32_32x32x16_bf16 v[224:239], a[196:199], v[20:23], v[224:239]
    ds_read_b64_tr_b16 a[96:97], v6 offset:7680
    ds_read_b64_tr_b16 a[98:99], v6 offset:8064
    v_pk_mul_f32 v[176:177], v[176:177], v[184:185]
    v_pk_mul_f32 v[178:179], v[178:179], v[186:187]
    v_pk_mul_f32 v[180:181], v[180:181], v[188:189]
    v_pk_mul_f32 v[182:183], v[182:183], v[190:191]
    s_waitcnt lgkmcnt(12)
    v_mfma_f32_32x32x16_bf16 v[208:223], a[204:207], v[24:27], v[208:223]
    ds_read_b64_tr_b16 a[112:113], v6 offset:7712
    ds_read_b64_tr_b16 a[114:115], v6 offset:8096
    v_cvt_pk_bf16_f32 v184, v176, v177
    v_cvt_pk_bf16_f32 v185, v178, v179
    v_cvt_pk_bf16_f32 v186, v180, v181
    v_cvt_pk_bf16_f32 v187, v182, v183
    s_waitcnt lgkmcnt(12)
    v_mfma_f32_32x32x16_bf16 v[224:239], a[64:67], v[24:27], v[224:239]
    ds_write_b128 v7, a[216:219] offset:34816
    buffer_store_dwordx4 v[184:187], v10, s[16:19], 0 offen offset:2048 sc1
    v_max_f32 v192, 0, v192
    v_max_f32 v193, 0, v193
    v_max_f32 v194, 0, v194
    v_max_f32 v195, 0, v195
    s_waitcnt lgkmcnt(11)
    v_mfma_f32_32x32x16_bf16 v[208:223], a[68:71], v[28:31], v[208:223]
    ds_read_b64_tr_b16 a[116:117], v6 offset:9216
    ds_read_b64_tr_b16 a[118:119], v6 offset:9600
    v_max_f32 v196, 0, v196
    v_max_f32 v197, 0, v197
    v_max_f32 v198, 0, v198
    v_max_f32 v199, 0, v199
    s_waitcnt lgkmcnt(11)
    v_mfma_f32_32x32x16_bf16 v[224:239], a[72:75], v[28:31], v[224:239]
    ds_write_b128 v8, a[220:223] offset:35840
    ds_read_b64_tr_b16 a[120:121], v6 offset:9248
    ds_read_b64_tr_b16 a[122:123], v6 offset:9632
    v_pk_mul_f32 v[192:193], v[192:193], v[200:201]
    v_pk_mul_f32 v[194:195], v[194:195], v[202:203]
    v_pk_mul_f32 v[196:197], v[196:197], v[204:205]
    s_waitcnt lgkmcnt(12)
    v_mfma_f32_32x32x16_bf16 v[208:223], a[88:91], v[32:35], v[208:223]
    ds_read_b64_tr_b16 a[124:125], v6 offset:10752
    ds_read_b64_tr_b16 a[126:127], v6 offset:11136
    v_pk_mul_f32 v[198:199], v[198:199], v[206:207]
    v_cvt_pk_bf16_f32 v200, v192, v193
    v_cvt_pk_bf16_f32 v201, v194, v195
    v_cvt_pk_bf16_f32 v202, v196, v197
    s_waitcnt lgkmcnt(12)
    v_mfma_f32_32x32x16_bf16 v[224:239], a[92:95], v[32:35], v[224:239]
    ds_write_b128 v8, a[224:227] offset:36864
    ds_read_b64_tr_b16 a[128:129], v6 offset:10784
    ds_read_b64_tr_b16 a[130:131], v6 offset:11168
    v_cvt_pk_bf16_f32 v203, v198, v199
    buffer_store_dwordx4 v[200:203], v10, s[16:19], 0 offen offset:3072 sc1
    s_add_u32 s3, s20, 8192
    buffer_load_dwordx4 a[136:139], v11, s[16:19], s3 offen offset:2048
    s_waitcnt lgkmcnt(13)
    v_mfma_f32_32x32x16_bf16 v[208:223], a[96:99], v[36:39], v[208:223]
    ds_read_b64_tr_b16 a[140:141], v6 offset:16384
    ds_read_b64_tr_b16 a[142:143], v6 offset:16768
    s_add_u32 s3, s21, 0
    buffer_load_dwordx4 a[144:147], v11, s[16:19], s3 offen offset:2048
    v_add_u32 v4, s34, v4
    v_add_u32 v5, 35840, v4
    s_waitcnt lgkmcnt(13)
    v_mfma_f32_32x32x16_bf16 v[224:239], a[112:115], v[36:39], v[224:239]
    ds_write_b128 v8, a[228:231] offset:37888
    ds_read_b64_tr_b16 a[160:161], v6 offset:16416
    s_waitcnt lgkmcnt(11)
    ds_read_b64_tr_b16 a[162:163], v6 offset:16800
    s_add_u32 s3, s22, 0
    buffer_load_dwordx4 a[164:167], v11, s[16:19], s3 offen offset:2048
    v_mfma_f32_32x32x16_bf16 v[208:223], a[116:119], v[40:43], v[208:223]
    ds_read_b64_tr_b16 a[168:169], v6 offset:17920
    ds_read_b64_tr_b16 a[170:171], v6 offset:18304
    s_add_u32 s3, s23, 0
    buffer_load_dwordx4 a[172:175], v11, s[16:19], s3 offen offset:2048
    s_waitcnt lgkmcnt(12)
    v_mfma_f32_32x32x16_bf16 v[224:239], a[120:123], v[40:43], v[224:239]
    ds_read_b64_tr_b16 a[176:177], v6 offset:17952
    ds_read_b64_tr_b16 a[178:179], v6 offset:18336
    s_waitcnt lgkmcnt(12)
    v_mfma_f32_32x32x16_bf16 v[208:223], a[124:127], v[44:47], v[208:223]
    ds_read_b64_tr_b16 a[180:181], v6 offset:19456
    ds_read_b64_tr_b16 a[182:183], v6 offset:19840
    s_add_u32 s3, s21, 0
    buffer_load_dwordx4 a[148:151], v11, s[16:19], s3 offen offset:3072
    s_waitcnt lgkmcnt(11)
    v_mfma_f32_32x32x16_bf16 v[224:239], a[128:131], v[44:47], v[224:239]
    ds_read_b64_tr_b16 a[156:157], v6 offset:19488
    ds_read_b64_tr_b16 a[158:159], v6 offset:19872
    s_add_u32 s3, s20, 8192
    buffer_load_dwordx4 a[0:3], v11, s[16:19], s3 offen offset:3072
    s_waitcnt lgkmcnt(11)
    v_mfma_f32_32x32x16_bf16 v[208:223], a[140:143], v[48:51], v[208:223]
    s_waitcnt lgkmcnt(10)
    s_barrier
    ds_read_b64_tr_b16 a[8:9], v6 offset:20992
    ds_read_b64_tr_b16 a[10:11], v6 offset:21376
    s_waitcnt lgkmcnt(10)
    v_mfma_f32_32x32x16_bf16 v[224:239], a[160:163], v[48:51], v[224:239]
    ds_read_b64_tr_b16 a[16:17], v6 offset:21024
    ds_read_b64_tr_b16 a[18:19], v6 offset:21408
    s_waitcnt lgkmcnt(10)
    v_mfma_f32_32x32x16_bf16 v[208:223], a[168:171], v[52:55], v[208:223]
    ds_read_b64_tr_b16 a[20:21], v6 offset:22528
    ds_read_b64_tr_b16 a[22:23], v6 offset:22912
    s_add_u32 s3, s22, 0
    buffer_load_dwordx4 a[24:27], v11, s[16:19], s3 offen offset:3072
    s_waitcnt lgkmcnt(10)
    v_mfma_f32_32x32x16_bf16 v[224:239], a[176:179], v[52:55], v[224:239]
    ds_read_b64_tr_b16 a[32:33], v6 offset:22560
    ds_read_b64_tr_b16 a[34:35], v6 offset:22944
    s_waitcnt lgkmcnt(10)
    v_mfma_f32_32x32x16_bf16 v[208:223], a[180:183], v[56:59], v[208:223]
    ds_read_b64_tr_b16 a[36:37], v6 offset:24064
    ds_read_b64_tr_b16 a[38:39], v6 offset:24448
    s_add_u32 s3, s23, 0
    buffer_load_dwordx4 a[44:47], v11, s[16:19], s3 offen offset:3072
    s_waitcnt lgkmcnt(10)
    v_mfma_f32_32x32x16_bf16 v[224:239], a[156:159], v[56:59], v[224:239]
    s_waitcnt vmcnt(33)
    ds_write_b128 v7, a[232:235] offset:49152
    ds_read_b64_tr_b16 a[52:53], v6 offset:24096
    ds_read_b64_tr_b16 a[54:55], v6 offset:24480
    s_add_u32 s3, s20, 12288
    buffer_load_dwordx4 a[56:59], v11, s[16:19], s3 offen offset:0
    s_waitcnt lgkmcnt(11)
    v_mfma_f32_32x32x16_bf16 v[208:223], a[8:11], v[60:63], v[208:223]
    ds_read_b64_tr_b16 a[184:185], v6 offset:25600
    ds_read_b64_tr_b16 a[186:187], v6 offset:25984
    s_waitcnt lgkmcnt(11)
    v_mfma_f32_32x32x16_bf16 v[224:239], a[16:19], v[60:63], v[224:239]
    ds_write_b128 v7, a[236:239] offset:50176
    ds_read_b64_tr_b16 a[192:193], v6 offset:25632
    ds_read_b64_tr_b16 a[194:195], v6 offset:26016
    s_waitcnt vmcnt(21)
    s_mov_b64 exec, 1
    buffer_store_dword v13, off, s[16:19], s74 offset:0
    s_mov_b64 exec, -1
    s_waitcnt lgkmcnt(12)
    v_mfma_f32_32x32x16_bf16 v[208:223], a[20:23], v[64:67], v[208:223]
    ds_read_b64_tr_b16 a[196:197], v6 offset:27136
    ds_read_b64_tr_b16 a[198:199], v6 offset:27520
    s_waitcnt lgkmcnt(12)
    v_mfma_f32_32x32x16_bf16 v[224:239], a[32:35], v[64:67], v[224:239]
    ds_write_b128 v7, a[240:243] offset:51200
    ds_read_b64_tr_b16 a[204:205], v6 offset:27168
    ds_read_b64_tr_b16 a[206:207], v6 offset:27552
    s_add_u32 s3, s21, 4096
    buffer_load_dwordx4 a[64:67], v11, s[16:19], s3 offen offset:0
    s_waitcnt lgkmcnt(13)
    v_mfma_f32_32x32x16_bf16 v[208:223], a[36:39], v[68:71], v[208:223]
    ds_read_b64_tr_b16 a[68:69], v6 offset:32768
    ds_read_b64_tr_b16 a[70:71], v6 offset:33152
    s_waitcnt lgkmcnt(12)
    v_mfma_f32_32x32x16_bf16 v[224:239], a[52:55], v[68:71], v[224:239]
    ds_write_b128 v8, a[244:247] offset:52224
    ds_read_b64_tr_b16 a[72:73], v6 offset:32800
    ds_read_b64_tr_b16 a[74:75], v6 offset:33184
    s_add_u32 s3, s20, 12288
    buffer_load_dwordx4 a[88:91], v11, s[16:19], s3 offen offset:1024
    s_waitcnt lgkmcnt(13)
    v_mfma_f32_32x32x16_bf16 v[208:223], a[184:187], v[72:75], v[208:223]
    ds_read_b64_tr_b16 a[92:93], v6 offset:34304
    ds_read_b64_tr_b16 a[94:95], v6 offset:34688
    s_waitcnt lgkmcnt(12)
    v_mfma_f32_32x32x16_bf16 v[224:239], a[192:195], v[72:75], v[224:239]
    ds_write_b128 v8, a[248:251] offset:53248
    ds_read_b64_tr_b16 a[96:97], v6 offset:34336
    ds_read_b64_tr_b16 a[98:99], v6 offset:34720
    s_add_u32 s3, s22, 4096
    buffer_load_dwordx4 a[112:115], v11, s[16:19], s3 offen offset:0
    s_waitcnt lgkmcnt(13)
    v_mfma_f32_32x32x16_bf16 v[208:223], a[196:199], v[76:79], v[208:223]
    ds_read_b64_tr_b16 a[116:117], v6 offset:35840
    ds_read_b64_tr_b16 a[118:119], v6 offset:36224
    s_waitcnt lgkmcnt(12)
    v_mfma_f32_32x32x16_bf16 v[224:239], a[204:207], v[76:79], v[224:239]
    ds_write_b128 v8, a[252:255] offset:54272
    ds_read_b64_tr_b16 a[120:121], v6 offset:35872
    ds_read_b64_tr_b16 a[122:123], v6 offset:36256
    s_add_u32 s3, s23, 4096
    buffer_load_dwordx4 a[124:127], v11, s[16:19], s3 offen offset:0
    s_waitcnt lgkmcnt(13)
    v_mfma_f32_32x32x16_bf16 v[208:223], a[68:71], v[80:83], v[208:223]
    ds_read_b64_tr_b16 a[128:129], v6 offset:37376
    ds_read_b64_tr_b16 a[130:131], v6 offset:37760
    s_waitcnt lgkmcnt(12)
    v_mfma_f32_32x32x16_bf16 v[224:239], a[72:75], v[80:83], v[224:239]
    ds_read_b64_tr_b16 a[208:209], v6 offset:37408
    ds_read_b64_tr_b16 a[210:211], v6 offset:37792
    s_add_u32 s3, s21, 4096
    buffer_load_dwordx4 a[212:215], v11, s[16:19], s3 offen offset:1024
    s_waitcnt lgkmcnt(12)
    v_mfma_f32_32x32x16_bf16 v[208:223], a[92:95], v[84:87], v[208:223]
    ds_read_b64_tr_b16 a[216:217], v6 offset:38912
    ds_read_b64_tr_b16 a[218:219], v6 offset:39296
    s_waitcnt lgkmcnt(11)
    v_mfma_f32_32x32x16_bf16 v[224:239], a[96:99], v[84:87], v[224:239]
    ds_read_b64_tr_b16 a[220:221], v6 offset:38944
    ds_read_b64_tr_b16 a[222:223], v6 offset:39328
    s_add_u32 s3, s22, 4096
    buffer_load_dwordx4 a[224:227], v11, s[16:19], s3 offen offset:1024
    s_waitcnt lgkmcnt(11)
    v_mfma_f32_32x32x16_bf16 v[208:223], a[116:119], v[88:91], v[208:223]
    s_waitcnt lgkmcnt(10)
    s_barrier
    ds_read_b64_tr_b16 a[228:229], v6 offset:40448
    ds_read_b64_tr_b16 a[230:231], v6 offset:40832
    s_waitcnt lgkmcnt(10)
    v_mfma_f32_32x32x16_bf16 v[224:239], a[120:123], v[88:91], v[224:239]
    ds_read_b64_tr_b16 a[140:141], v6 offset:40480
    ds_read_b64_tr_b16 a[142:143], v6 offset:40864
    s_add_u32 s3, s23, 4096
    buffer_load_dwordx4 a[160:163], v11, s[16:19], s3 offen offset:1024
    s_waitcnt lgkmcnt(10)
    v_mfma_f32_32x32x16_bf16 v[208:223], a[128:131], v[92:95], v[208:223]
    ds_read_b64_tr_b16 a[168:169], v6 offset:41984
    ds_read_b64_tr_b16 a[170:171], v6 offset:42368
    s_waitcnt lgkmcnt(10)
    v_mfma_f32_32x32x16_bf16 v[224:239], a[208:211], v[92:95], v[224:239]
    ds_read_b64_tr_b16 a[176:177], v6 offset:42016
    ds_read_b64_tr_b16 a[178:179], v6 offset:42400
    s_add_u32 s3, s21, 4096
    buffer_load_dwordx4 a[180:183], v11, s[16:19], s3 offen offset:2048
    s_waitcnt lgkmcnt(10)
    v_mfma_f32_32x32x16_bf16 v[208:223], a[216:219], v[96:99], v[208:223]
    ds_read_b64_tr_b16 a[156:157], v6 offset:43520
    ds_read_b64_tr_b16 a[158:159], v6 offset:43904
    s_waitcnt lgkmcnt(10)
    v_mfma_f32_32x32x16_bf16 v[224:239], a[220:223], v[96:99], v[224:239]
    ds_read_b64_tr_b16 a[8:9], v6 offset:43552
    ds_read_b64_tr_b16 a[10:11], v6 offset:43936
    s_add_u32 s3, s22, 4096
    buffer_load_dwordx4 a[16:19], v11, s[16:19], s3 offen offset:2048
    s_waitcnt lgkmcnt(10)
    v_mfma_f32_32x32x16_bf16 v[208:223], a[228:231], v[100:103], v[208:223]
    ds_read_b64_tr_b16 a[20:21], v6 offset:49152
    ds_read_b64_tr_b16 a[22:23], v6 offset:49536
    s_mov_b64 exec, 255
    buffer_load_dwordx2 v[14:15], v12, s[16:19], s33 offen offset:0 sc1
    s_mov_b64 exec, -1
    s_waitcnt lgkmcnt(10)
    v_mfma_f32_32x32x16_bf16 v[224:239], a[140:143], v[100:103], v[224:239]
    ds_read_b64_tr_b16 a[32:33], v6 offset:49184
    ds_read_b64_tr_b16 a[34:35], v6 offset:49568
    s_add_u32 s3, s23, 4096
    buffer_load_dwordx4 a[36:39], v11, s[16:19], s3 offen offset:2048
    s_waitcnt lgkmcnt(10)
    v_mfma_f32_32x32x16_bf16 v[208:223], a[168:171], v[104:107], v[208:223]
    ds_read_b64_tr_b16 a[52:53], v6 offset:50688
    ds_read_b64_tr_b16 a[54:55], v6 offset:51072
    s_waitcnt lgkmcnt(10)
    v_mfma_f32_32x32x16_bf16 v[224:239], a[176:179], v[104:107], v[224:239]
    ds_read_b64_tr_b16 a[184:185], v6 offset:50720
    ds_read_b64_tr_b16 a[186:187], v6 offset:51104
    s_add_u32 s3, s21, 4096
    buffer_load_dwordx4 a[192:195], v11, s[16:19], s3 offen offset:3072
    s_waitcnt lgkmcnt(10)
    v_mfma_f32_32x32x16_bf16 v[208:223], a[156:159], v[108:111], v[208:223]
    ds_read_b64_tr_b16 a[196:197], v6 offset:52224
    ds_read_b64_tr_b16 a[198:199], v6 offset:52608
    s_waitcnt lgkmcnt(10)
    v_mfma_f32_32x32x16_bf16 v[224:239], a[8:11], v[108:111], v[224:239]
    ds_read_b64_tr_b16 a[204:205], v6 offset:52256
    ds_read_b64_tr_b16 a[206:207], v6 offset:52640
    s_add_u32 s3, s22, 4096
    buffer_load_dwordx4 a[68:71], v11, s[16:19], s3 offen offset:3072
    s_waitcnt lgkmcnt(10)
    v_mfma_f32_32x32x16_bf16 v[208:223], a[20:23], v[112:115], v[208:223]
    ds_read_b64_tr_b16 a[72:73], v6 offset:53760
    ds_read_b64_tr_b16 a[74:75], v6 offset:54144
    s_waitcnt lgkmcnt(10)
    v_mfma_f32_32x32x16_bf16 v[224:239], a[32:35], v[112:115], v[224:239]
    ds_read_b64_tr_b16 a[92:93], v6 offset:53792
    ds_read_b64_tr_b16 a[94:95], v6 offset:54176
    s_add_u32 s3, s23, 4096
    buffer_load_dwordx4 a[96:99], v11, s[16:19], s3 offen offset:3072
    s_waitcnt lgkmcnt(10)
    v_mfma_f32_32x32x16_bf16 v[208:223], a[52:55], v[116:119], v[208:223]
    ds_read_b64_tr_b16 a[232:233], v6 offset:55296
    ds_read_b64_tr_b16 a[234:235], v6 offset:55680
    s_waitcnt lgkmcnt(10)
    v_mfma_f32_32x32x16_bf16 v[224:239], a[184:187], v[116:119], v[224:239]
    ds_read_b64_tr_b16 a[236:237], v6 offset:55328
    ds_read_b64_tr_b16 a[238:239], v6 offset:55712
    s_add_u32 s3, s21, 8192
    buffer_load_dwordx4 a[240:243], v11, s[16:19], s3 offen offset:0
    s_waitcnt lgkmcnt(10)
    v_mfma_f32_32x32x16_bf16 v[208:223], a[196:199], v[120:123], v[208:223]
    ds_read_b64_tr_b16 a[244:245], v6 offset:56832
    ds_read_b64_tr_b16 a[246:247], v6 offset:57216
    s_waitcnt lgkmcnt(10)
    v_mfma_f32_32x32x16_bf16 v[224:239], a[204:207], v[120:123], v[224:239]
    ds_read_b64_tr_b16 a[248:249], v6 offset:56864
    ds_read_b64_tr_b16 a[250:251], v6 offset:57248
    s_add_u32 s3, s22, 8192
    buffer_load_dwordx4 a[252:255], v11, s[16:19], s3 offen offset:0
    s_waitcnt lgkmcnt(10)
    v_mfma_f32_32x32x16_bf16 v[208:223], a[72:75], v[124:127], v[208:223]
    ds_read_b64_tr_b16 a[116:117], v6 offset:58368
    ds_read_b64_tr_b16 a[118:119], v6 offset:58752
    s_waitcnt vmcnt(26)
    s_mov_b64 exec, 1
    buffer_store_dword v13, off, s[16:19], s74 offset:1024
    s_mov_b64 exec, -1
    s_waitcnt lgkmcnt(10)
    v_mfma_f32_32x32x16_bf16 v[224:239], a[92:95], v[124:127], v[224:239]
    ds_read_b64_tr_b16 a[120:121], v6 offset:58400
    ds_read_b64_tr_b16 a[122:123], v6 offset:58784
    s_add_u32 s3, s23, 8192
    buffer_load_dwordx4 a[128:131], v11, s[16:19], s3 offen offset:0
    s_waitcnt lgkmcnt(10)
    v_mfma_f32_32x32x16_bf16 v[208:223], a[232:235], v[128:131], v[208:223]
    ds_read_b64_tr_b16 a[208:209], v6 offset:59904
    ds_read_b64_tr_b16 a[210:211], v6 offset:60288
    s_waitcnt lgkmcnt(10)
    v_mfma_f32_32x32x16_bf16 v[224:239], a[236:239], v[128:131], v[224:239]
    ds_read_b64_tr_b16 a[216:217], v6 offset:59936
    ds_read_b64_tr_b16 a[218:219], v6 offset:60320
    s_add_u32 s3, s21, 8192
    buffer_load_dwordx4 a[220:223], v11, s[16:19], s3 offen offset:1024
    s_waitcnt lgkmcnt(10)
    v_mfma_f32_32x32x16_bf16 v[208:223], a[244:247], v[132:135], v[208:223]
    ds_read_b64_tr_b16 a[228:229], v6 offset:64
    ds_read_b64_tr_b16 a[230:231], v6 offset:448
    s_mov_b64 exec, 255
    s_waitcnt vmcnt(9)
    v_xor_b32 v14, s36, v14
    v_xor_b32 v15, s36, v15
    v_or_b32 v14, v14, v15
    v_cmp_ne_u32 vcc, 0, v14
    s_cbranch_vccnz LL_slow5
LL_back5:
    s_mov_b64 exec, -1
    s_waitcnt lgkmcnt(10)
    v_mfma_f32_32x32x16_bf16 v[224:239], a[248:251], v[132:135], v[224:239]
    ds_read_b64_tr_b16 a[140:141], v6 offset:1600
    ds_read_b64_tr_b16 a[142:143], v6 offset:1984
    buffer_load_dwordx4 v[144:147], v2, s[16:19], s24 offen offset:0
    buffer_load_dwordx4 v[148:151], v3, s[16:19], s24 offen offset:0
    s_waitcnt lgkmcnt(10)
    v_mfma_f32_32x32x16_bf16 v[208:223], a[116:119], v[136:139], v[208:223]
    ds_read_b64_tr_b16 a[168:169], v6 offset:3136
    ds_read_b64_tr_b16 a[170:171], v6 offset:3520
    s_waitcnt lgkmcnt(10)
    v_mfma_f32_32x32x16_bf16 v[224:239], a[120:123], v[136:139], v[224:239]
    ds_read_b64_tr_b16 a[176:177], v6 offset:4672
    ds_read_b64_tr_b16 a[178:179], v6 offset:5056
    s_waitcnt lgkmcnt(10)
    v_mfma_f32_32x32x16_bf16 v[208:223], a[208:211], v[140:143], v[208:223]
    ds_read_b64_tr_b16 a[156:157], v6 offset:6208
    ds_read_b64_tr_b16 a[158:159], v6 offset:6592
    buffer_load_dwordx4 v[152:155], v2, s[16:19], s24 offen offset:1024
    buffer_load_dwordx4 v[156:159], v3, s[16:19], s24 offen offset:1024
    s_waitcnt lgkmcnt(10)
    v_mfma_f32_32x32x16_bf16 v[224:239], a[216:219], v[140:143], v[224:239]
    ds_read_b64_tr_b16 a[8:9], v6 offset:7744
    ds_read_b64_tr_b16 a[10:11], v6 offset:8128
    s_waitcnt lgkmcnt(10)
    v_mfma_f32_32x32x16_bf16 v[240:255], a[228:231], v[16:19], 0
    ds_read_b64_tr_b16 a[20:21], v6 offset:9280
    ds_read_b64_tr_b16 a[22:23], v6 offset:9664
    s_waitcnt lgkmcnt(10)
    v_mfma_f32_32x32x16_bf16 v[240:255], a[140:143], v[20:23], v[240:255]
    ds_read_b64_tr_b16 a[32:33], v6 offset:10816
    ds_read_b64_tr_b16 a[34:35], v6 offset:11200
    v_max_f32 v208, 0, v208
    v_max_f32 v209, 0, v209
    v_max_f32 v210, 0, v210
    v_max_f32 v211, 0, v211
    buffer_load_dwordx4 v[160:163], v2, s[16:19], s25 offen offset:0
    buffer_load_dwordx4 v[164:167], v3, s[16:19], s25 offen offset:0
    s_waitcnt lgkmcnt(10)
    v_mfma_f32_32x32x16_bf16 v[240:255], a[168:171], v[24:27], v[240:255]
    ds_read_b64_tr_b16 a[52:53], v6 offset:16448
    ds_read_b64_tr_b16 a[54:55], v6 offset:16832
    v_max_f32 v212, 0, v212
    v_max_f32 v213, 0, v213
    v_max_f32 v214, 0, v214
    v_max_f32 v215, 0, v215
    s_waitcnt lgkmcnt(10)
    v_mfma_f32_32x32x16_bf16 v[240:255], a[176:179], v[28:31], v[240:255]
    ds_read_b64_tr_b16 a[184:185], v6 offset:17984
    ds_read_b64_tr_b16 a[186:187], v6 offset:18368
    v_pk_mul_f32 v[208:209], v[208:209], v[216:217]
    v_pk_mul_f32 v[210:211], v[210:211], v[218:219]
    v_pk_mul_f32 v[212:213], v[212:213], v[220:221]
    v_pk_mul_f32 v[214:215], v[214:215], v[222:223]
    s_waitcnt lgkmcnt(10)
    v_mfma_f32_32x32x16_bf16 v[240:255], a[156:159], v[32:35], v[240:255]
    s_barrier
    ds_read_b64_tr_b16 a[196:197], v6 offset:19520
    ds_read_b64_tr_b16 a[198:199], v6 offset:19904
    v_cvt_pk_bf16_f32 v216, v208, v209
    v_cvt_pk_bf16_f32 v217, v210, v211
    v_cvt_pk_bf16_f32 v218, v212, v213
    buffer_load_dwordx4 v[168:171], v2, s[16:19], s25 offen offset:1024
    buffer_load_dwordx4 v[172:175], v3, s[16:19], s25 offen offset:1024
    s_waitcnt lgkmcnt(10)
    v_mfma_f32_32x32x16_bf16 v[240:255], a[8:11], v[36:39], v[240:255]
    ds_read_b64_tr_b16 a[204:205], v6 offset:21056
    ds_read_b64_tr_b16 a[206:207], v6 offset:21440
    v_cvt_pk_bf16_f32 v219, v214, v215
    buffer_store_dwordx4 v[216:219], v10, s[16:19], s56 offen offset:0 sc1
    v_max_f32 v224, 0, v224
    v_max_f32 v225, 0, v225
    s_waitcnt lgkmcnt(10)
    v_mfma_f32_32x32x16_bf16 v[240:255], a[20:23], v[40:43], v[240:255]
    ds_read_b64_tr_b16 a[72:73], v6 offset:22592
    ds_read_b64_tr_b16 a[74:75], v6 offset:22976
    v_max_f32 v226, 0, v226
    v_max_f32 v227, 0, v227
    v_max_f32 v228, 0, v228
    v_max_f32 v229, 0, v229
    s_waitcnt lgkmcnt(10)
    v_mfma_f32_32x32x16_bf16 v[240:255], a[32:35], v[44:47], v[240:255]
    ds_read_b64_tr_b16 a[92:93], v6 offset:24128
    ds_read_b64_tr_b16 a[94:95], v6 offset:24512
    v_max_f32 v230, 0, v230
    v_max_f32 v231, 0, v231
    v_pk_mul_f32 v[224:225], v[224:225], v[232:233]
    v_pk_mul_f32 v[226:227], v[226:227], v[234:235]
    buffer_load_dwordx4 v[176:179], v2, s[16:19], s26 offen offset:0
    buffer_load_dwordx4 v[180:183], v3, s[16:19], s26 offen offset:0
    s_waitcnt lgkmcnt(10)
    v_mfma_f32_32x32x16_bf16 v[240:255], a[52:55], v[48:51], v[240:255]
    ds_read_b64_tr_b16 a[232:233], v6 offset:25664
    ds_read_b64_tr_b16 a[234:235], v6 offset:26048
    v_pk_mul_f32 v[228:229], v[228:229], v[236:237]
    v_pk_mul_f32 v[230:231], v[230:231], v[238:239]
    v_cvt_pk_bf16_f32 v232, v224, v225
    v_cvt_pk_bf16_f32 v233, v226, v227
    s_waitcnt lgkmcnt(10)
    v_mfma_f32_32x32x16_bf16 v[240:255], a[184:187], v[52:55], v[240:255]
    ds_read_b64_tr_b16 a[236:237], v6 offset:27200
    ds_read_b64_tr_b16 a[238:239], v6 offset:27584
    v_cvt_pk_bf16_f32 v234, v228, v229
    v_cvt_pk_bf16_f32 v235, v230, v231
    buffer_store_dwordx4 v[232:235], v1, s[16:19], s32 offen offset:0
    s_waitcnt lgkmcnt(10)
    v_mfma_f32_32x32x16_bf16 v[240:255], a[196:199], v[56:59], v[240:255]
    ds_read_b64_tr_b16 a[244:245], v6 offset:32832
    ds_read_b64_tr_b16 a[246:247], v6 offset:33216
    buffer_load_dwordx4 v[184:187], v2, s[16:19], s26 offen offset:1024
    buffer_load_dwordx4 v[188:191], v3, s[16:19], s26 offen offset:1024
    s_waitcnt lgkmcnt(10)
    v_mfma_f32_32x32x16_bf16 v[240:255], a[204:207], v[60:63], v[240:255]
    ds_read_b64_tr_b16 a[248:249], v6 offset:34368
    ds_read_b64_tr_b16 a[250:251], v6 offset:34752
    s_waitcnt lgkmcnt(10)
    v_mfma_f32_32x32x16_bf16 v[240:255], a[72:75], v[64:67], v[240:255]
    ds_read_b64_tr_b16 a[116:117], v6 offset:35904
    ds_read_b64_tr_b16 a[118:119], v6 offset:36288
    s_waitcnt lgkmcnt(10)
    v_mfma_f32_32x32x16_bf16 v[240:255], a[92:95], v[68:71], v[240:255]
    ds_read_b64_tr_b16 a[120:121], v6 offset:37440
    ds_read_b64_tr_b16 a[122:123], v6 offset:37824
    buffer_load_dwordx4 v[192:195], v2, s[16:19], s27 offen offset:0
    buffer_load_dwordx4 v[196:199], v3, s[16:19], s27 offen offset:0
    s_waitcnt lgkmcnt(10)
    v_mfma_f32_32x32x16_bf16 v[240:255], a[232:235], v[72:75], v[240:255]
    ds_read_b64_tr_b16 a[208:209], v6 offset:38976
    ds_read_b64_tr_b16 a[210:211], v6 offset:39360
    s_waitcnt lgkmcnt(10)
    v_mfma_f32_32x32x16_bf16 v[240:255], a[236:239], v[76:79], v[240:255]
    ds_read_b64_tr_b16 a[216:217], v6 offset:40512
    ds_read_b64_tr_b16 a[218:219], v6 offset:40896
    s_waitcnt lgkmcnt(10)
    v_mfma_f32_32x32x16_bf16 v[240:255], a[244:247], v[80:83], v[240:255]
    ds_read_b64_tr_b16 a[228:229], v6 offset:42048
    ds_read_b64_tr_b16 a[230:231], v6 offset:42432
    buffer_load_dwordx4 v[200:203], v2, s[16:19], s27 offen offset:1024
    buffer_load_dwordx4 v[204:207], v3, s[16:19], s27 offen offset:1024
    s_waitcnt lgkmcnt(10)
    v_mfma_f32_32x32x16_bf16 v[240:255], a[248:251], v[84:87], v[240:255]
    ds_read_b64_tr_b16 a[140:141], v6 offset:43584
    ds_read_b64_tr_b16 a[142:143], v6 offset:43968
    s_waitcnt lgkmcnt(10)
    v_mfma_f32_32x32x16_bf16 v[240:255], a[116:119], v[88:91], v[240:255]
    ds_read_b64_tr_b16 a[168:169], v6 offset:49216
    ds_read_b64_tr_b16 a[170:171], v6 offset:49600
    s_mov_b64 exec, 15
    buffer_load_dwordx2 v[14:15], v12, s[16:19], s75 offen offset:1024 sc1
    s_mov_b64 exec, -1
    s_waitcnt lgkmcnt(10)
    v_mfma_f32_32x32x16_bf16 v[240:255], a[120:123], v[92:95], v[240:255]
    ds_read_b64_tr_b16 a[176:177], v6 offset:50752
    ds_read_b64_tr_b16 a[178:179], v6 offset:51136
    s_waitcnt lgkmcnt(10)
    v_mfma_f32_32x32x16_bf16 v[240:255], a[208:211], v[96:99], v[240:255]
    ds_read_b64_tr_b16 a[156:157], v6 offset:52288
    ds_read_b64_tr_b16 a[158:159], v6 offset:52672
    s_waitcnt lgkmcnt(10)
    v_mfma_f32_32x32x16_bf16 v[240:255], a[216:219], v[100:103], v[240:255]
    ds_read_b64_tr_b16 a[8:9], v6 offset:53824
    ds_read_b64_tr_b16 a[10:11], v6 offset:54208
    s_waitcnt lgkmcnt(10)
    v_mfma_f32_32x32x16_bf16 v[240:255], a[228:231], v[104:107], v[240:255]
    ds_read_b64_tr_b16 a[20:21], v6 offset:55360
    ds_read_b64_tr_b16 a[22:23], v6 offset:55744
    s_waitcnt lgkmcnt(10)
    v_mfma_f32_32x32x16_bf16 v[240:255], a[140:143], v[108:111], v[240:255]
    ds_read_b64_tr_b16 a[32:33], v6 offset:56896
    ds_read_b64_tr_b16 a[34:35], v6 offset:57280
    s_waitcnt vmcnt(7)
    s_mov_b64 exec, 1
    buffer_store_dword v13, off, s[16:19], s74 offset:2048
    s_mov_b64 exec, -1
    s_waitcnt lgkmcnt(10)
    v_mfma_f32_32x32x16_bf16 v[240:255], a[168:171], v[112:115], v[240:255]
    ds_read_b64_tr_b16 a[52:53], v6 offset:58432
    ds_read_b64_tr_b16 a[54:55], v6 offset:58816
    s_waitcnt lgkmcnt(10)
    v_mfma_f32_32x32x16_bf16 v[240:255], a[176:179], v[116:119], v[240:255]
    ds_read_b64_tr_b16 a[184:185], v6 offset:59968
    ds_read_b64_tr_b16 a[186:187], v6 offset:60352
    s_waitcnt lgkmcnt(10)
    v_mfma_f32_32x32x16_bf16 v[240:255], a[156:159], v[120:123], v[240:255]
    s_add_u32 s3, s22, 8192
    buffer_load_dwordx4 a[196:199], v11, s[16:19], s3 offen offset:1024
    s_waitcnt lgkmcnt(8)
    v_mfma_f32_32x32x16_bf16 v[240:255], a[8:11], v[124:127], v[240:255]
    s_waitcnt lgkmcnt(6)
    v_mfma_f32_32x32x16_bf16 v[240:255], a[20:23], v[128:131], v[240:255]
    s_add_u32 s3, s23, 8192
    buffer_load_dwordx4 a[204:207], v11, s[16:19], s3 offen offset:1024
    s_waitcnt lgkmcnt(4)
    v_mfma_f32_32x32x16_bf16 v[240:255], a[32:35], v[132:135], v[240:255]
    s_waitcnt lgkmcnt(2)
    v_mfma_f32_32x32x16_bf16 v[240:255], a[52:55], v[136:139], v[240:255]
    s_add_u32 s3, s21, 8192
    buffer_load_dwordx4 a[72:75], v11, s[16:19], s3 offen offset:2048
    s_waitcnt lgkmcnt(0)
    v_mfma_f32_32x32x16_bf16 v[240:255], a[184:187], v[140:143], v[240:255]
    v_mfma_f32_32x32x16_bf16 v[16:31], a[80:83], v[144:147], 0
    s_add_u32 s3, s22, 8192
    buffer_load_dwordx4 a[92:95], v11, s[16:19], s3 offen offset:2048
    v_mfma_f32_32x32x16_bf16 v[32:47], a[80:83], v[148:151], 0
    v_mfma_f32_32x32x16_bf16 v[48:63], a[84:87], v[144:147], 0
    v_max_f32 v240, 0, v240
    v_max_f32 v241, 0, v241
    v_max_f32 v242, 0, v242
    v_max_f32 v243, 0, v243
    v_max_f32 v244, 0, v244
    v_max_f32 v245, 0, v245
    v_mfma_f32_32x32x16_bf16 v[64:79], a[84:87], v[148:151], 0
    v_max_f32 v246, 0, v246
    v_max_f32 v247, 0, v247
    v_pk_mul_f32 v[240:241], v[240:241], v[248:249]
    v_pk_mul_f32 v[242:243], v[242:243], v[250:251]
    v_pk_mul_f32 v[244:245], v[244:245], v[252:253]
    v_pk_mul_f32 v[246:247], v[246:247], v[254:255]
    v_mfma_f32_32x32x16_bf16 v[16:31], a[100:103], v[152:155], v[16:31]
    v_cvt_pk_bf16_f32 v248, v240, v241
    v_cvt_pk_bf16_f32 v249, v242, v243
    v_cvt_pk_bf16_f32 v250, v244, v245
    v_cvt_pk_bf16_f32 v251, v246, v247
    buffer_store_dwordx4 v[248:251], v1, s[16:19], s32 offen offset:1024
    s_add_u32 s3, s23, 8192
    buffer_load_dwordx4 a[232:235], v11, s[16:19], s3 offen offset:2048
    v_mfma_f32_32x32x16_bf16 v[32:47], a[100:103], v[156:159], v[32:47]
    s_mov_b64 exec, 15
    s_waitcnt vmcnt(7)
    v_xor_b32 v14, s36, v14
    v_xor_b32 v15, s36, v15
    v_or_b32 v14, v14, v15
    v_cmp_ne_u32 vcc, 0, v14
    s_cbranch_vccnz LL_slow6
LL_back6:
    s_mov_b64 exec, -1
    v_mfma_f32_32x32x16_bf16 v[48:63], a[104:107], v[152:155], v[48:63]
    buffer_load_dwordx4 v[144:147], v2, s[16:19], s24 offen offset:2048
    buffer_load_dwordx4 v[148:151], v3, s[16:19], s24 offen offset:2048
    s_mov_b64 exec, 15
    buffer_load_dwordx2 v[14:15], v12, s[16:19], s75 offen offset:2048 sc1
    s_mov_b64 exec, -1
    v_mfma_f32_32x32x16_bf16 v[64:79], a[104:107], v[156:159], v[64:79]
    v_mfma_f32_32x32x16_bf16 v[16:31], a[4:7], v[160:163], v[16:31]
    v_mfma_f32_32x32x16_bf16 v[32:47], a[4:7], v[164:167], v[32:47]
    buffer_load_dwordx4 v[152:155], v2, s[16:19], s24 offen offset:3072
    buffer_load_dwordx4 v[156:159], v3, s[16:19], s24 offen offset:3072
    v_mfma_f32_32x32x16_bf16 v[48:63], a[188:191], v[160:163], v[48:63]
    v_mfma_f32_32x32x16_bf16 v[64:79], a[188:191], v[164:167], v[64:79]
    v_mfma_f32_32x32x16_bf16 v[16:31], a[144:147], v[168:171], v[16:31]
    buffer_load_dwordx4 v[160:163], v2, s[16:19], s25 offen offset:2048
    buffer_load_dwordx4 v[164:167], v3, s[16:19], s25 offen offset:2048
    v_mfma_f32_32x32x16_bf16 v[32:47], a[144:147], v[172:175], v[32:47]
    v_mfma_f32_32x32x16_bf16 v[48:63], a[148:151], v[168:171], v[48:63]
    v_mfma_f32_32x32x16_bf16 v[64:79], a[148:151], v[172:175], v[64:79]
    buffer_load_dwordx4 v[80:83], v2, s[16:19], s25 offen offset:3072
    buffer_load_dwordx4 v[84:87], v3, s[16:19], s25 offen offset:3072
    v_mfma_f32_32x32x16_bf16 v[16:31], a[28:31], v[176:179], v[16:31]
    v_mfma_f32_32x32x16_bf16 v[32:47], a[28:31], v[180:183], v[32:47]
    v_mfma_f32_32x32x16_bf16 v[48:63], a[200:203], v[176:179], v[48:63]
    s_waitcnt vmcnt(10)
    s_mov_b64 exec, 1
    buffer_store_dword v13, off, s[16:19], s74 offset:3072
    s_mov_b64 exec, -1
    buffer_load_dwordx4 v[168:171], v2, s[16:19], s26 offen offset:2048
    buffer_load_dwordx4 v[172:175], v3, s[16:19], s26 offen offset:2048
    v_mfma_f32_32x32x16_bf16 v[64:79], a[200:203], v[180:183], v[64:79]
    v_mfma_f32_32x32x16_bf16 v[16:31], a[164:167], v[184:187], v[16:31]
    s_mov_b64 exec, 15
    s_waitcnt vmcnt(9)
    v_xor_b32 v14, s36, v14
    v_xor_b32 v15, s36, v15
    v_or_b32 v14, v14, v15
    v_cmp_ne_u32 vcc, 0, v14
    s_cbranch_vccnz LL_slow7
LL_back7:
    s_mov_b64 exec, -1
    v_mfma_f32_32x32x16_bf16 v[32:47], a[164:167], v[188:191], v[32:47]
    buffer_load_dwordx4 v[176:179], v2, s[16:19], s26 offen offset:3072
    buffer_load_dwordx4 v[180:183], v3, s[16:19], s26 offen offset:3072
    v_mfma_f32_32x32x16_bf16 v[48:63], a[24:27], v[184:187], v[48:63]
    v_mfma_f32_32x32x16_bf16 v[64:79], a[24:27], v[188:191], v[64:79]
    v_mfma_f32_32x32x16_bf16 v[16:31], a[40:43], v[192:195], v[16:31]
    buffer_load_dwordx4 v[184:187], v2, s[16:19], s27 offen offset:2048
    buffer_load_dwordx4 v[188:191], v3, s[16:19], s27 offen offset:2048
    v_mfma_f32_32x32x16_bf16 v[32:47], a[40:43], v[196:199], v[32:47]
    v_mfma_f32_32x32x16_bf16 v[48:63], a[76:79], v[192:195], v[48:63]
    v_mfma_f32_32x32x16_bf16 v[64:79], a[76:79], v[196:199], v[64:79]
    buffer_load_dwordx4 v[88:91], v2, s[16:19], s27 offen offset:3072
    buffer_load_dwordx4 v[92:95], v3, s[16:19], s27 offen offset:3072
    v_mfma_f32_32x32x16_bf16 v[16:31], a[172:175], v[200:203], v[16:31]
    v_mfma_f32_32x32x16_bf16 v[32:47], a[172:175], v[204:207], v[32:47]
    v_mfma_f32_32x32x16_bf16 v[48:63], a[44:47], v[200:203], v[48:63]
    buffer_load_dwordx4 v[192:195], v4, s[16:19], s4 offen offset:0 sc1
    buffer_load_dwordx4 v[196:199], v5, s[16:19], s4 offen offset:0 sc1
    v_mfma_f32_32x32x16_bf16 v[64:79], a[44:47], v[204:207], v[64:79]
    v_mfma_f32_32x32x16_bf16 v[16:31], a[108:111], v[144:147], v[16:31]
    s_barrier
    s_and_b32 s48, s45, 7
    v_lshrrev_b32 v252, 4, v0
    v_and_b32 v253, 15, v0
    v_lshrrev_b32 v254, 3, v252
    v_and_b32 v255, 7, v252
    v_mfma_f32_32x32x16_bf16 v[32:47], a[108:111], v[148:151], v[32:47]
    v_lshlrev_b32 v254, 15, v254
    v_lshl_add_u32 v254, v255, 4, v254
    v_lshl_add_u32 v254, v253, 8, v254
    s_lshl_b32 s53, s72, 16
    s_lshl_b32 s54, s48, 12
    s_add_u32 s54, s54, s53
    buffer_load_dwordx4 v[200:203], v4, s[16:19], s5 offen offset:0 sc1
    buffer_load_dwordx4 v[204:207], v5, s[16:19], s5 offen offset:0 sc1
    v_mfma_f32_32x32x16_bf16 v[48:63], a[132:135], v[144:147], v[48:63]
    s_add_u32 s54, s54, 4194304
    buffer_load_dwordx4 v[240:243], v254, s[16:19], s54 offen offset:0 sc1
    buffer_load_dwordx4 v[244:247], v254, s[16:19], s54 offen offset:128 sc1
    v_and_b32 v8, 31, v0
    v_bfe_u32 v9, v0, 5, 1
    v_mul_u32_u24 v8, 272, v8
    v_mfma_f32_32x32x16_bf16 v[64:79], a[132:135], v[148:151], v[64:79]
    v_lshl_add_u32 v8, v9, 4, v8
    s_mul_i32 s54, s44, 17408
    v_add_u32 v8, s54, v8
    s_mov_b64 exec, 15
    buffer_load_dwordx2 v[14:15], v12, s[16:19], s75 offen offset:3072 sc1
    s_mov_b64 exec, -1
    s_waitcnt vmcnt(20)
    v_mfma_f32_32x32x16_bf16 v[16:31], a[152:155], v[152:155], v[16:31]
    buffer_load_dwordx4 v[144:147], v4, s[16:19], s6 offen offset:0 sc1
    buffer_load_dwordx4 v[148:151], v5, s[16:19], s6 offen offset:0 sc1
    v_mfma_f32_32x32x16_bf16 v[32:47], a[152:155], v[156:159], v[32:47]
    v_mfma_f32_32x32x16_bf16 v[48:63], a[12:15], v[152:155], v[48:63]
    v_mfma_f32_32x32x16_bf16 v[64:79], a[12:15], v[156:159], v[64:79]
    buffer_load_dwordx4 v[96:99], v4, s[16:19], s7 offen offset:0 sc1
    buffer_load_dwordx4 v[100:103], v5, s[16:19], s7 offen offset:0 sc1
    s_waitcnt vmcnt(22)
    v_mfma_f32_32x32x16_bf16 v[16:31], a[64:67], v[160:163], v[16:31]
    v_mfma_f32_32x32x16_bf16 v[32:47], a[64:67], v[164:167], v[32:47]
    v_mfma_f32_32x32x16_bf16 v[48:63], a[212:215], v[160:163], v[48:63]
    v_mfma_f32_32x32x16_bf16 v[64:79], a[212:215], v[164:167], v[64:79]
    s_waitcnt vmcnt(20)
    v_mfma_f32_32x32x16_bf16 v[16:31], a[180:183], v[80:83], v[16:31]
    v_mfma_f32_32x32x16_bf16 v[32:47], a[180:183], v[84:87], v[32:47]
    v_mfma_f32_32x32x16_bf16 v[48:63], a[192:195], v[80:83], v[48:63]
    v_mfma_f32_32x32x16_bf16 v[64:79], a[192:195], v[84:87], v[64:79]
    s_waitcnt vmcnt(17)
    v_mfma_f32_32x32x16_bf16 v[16:31], a[112:115], v[168:171], v[16:31]
    s_add_u32 s3, s21, 8192
    buffer_load_dwordx4 a[236:239], v11, s[16:19], s3 offen offset:3072
    s_mov_b64 exec, 15
    s_waitcnt vmcnt(5)
    v_xor_b32 v14, s36, v14
    v_xor_b32 v15, s36, v15
    v_or_b32 v14, v14, v15
    v_cmp_ne_u32 vcc, 0, v14
    s_cbranch_vccnz LL_slow8
LL_back8:
    s_mov_b64 exec, -1
    v_mfma_f32_32x32x16_bf16 v[32:47], a[112:115], v[172:175], v[32:47]
    buffer_load_dwordx4 v[152:155], v4, s[16:19], s4 offen offset:1024 sc1
    buffer_load_dwordx4 v[156:159], v5, s[16:19], s4 offen offset:1024 sc1
    v_mfma_f32_32x32x16_bf16 v[48:63], a[224:227], v[168:171], v[48:63]
    v_mfma_f32_32x32x16_bf16 v[64:79], a[224:227], v[172:175], v[64:79]
    v_mfma_f32_32x32x16_bf16 v[16:31], a[16:19], v[176:179], v[16:31]
    buffer_load_dwordx4 v[160:163], v4, s[16:19], s5 offen offset:1024 sc1
    buffer_load_dwordx4 v[164:167], v5, s[16:19], s5 offen offset:1024 sc1
    v_mfma_f32_32x32x16_bf16 v[32:47], a[16:19], v[180:183], v[32:47]
    v_mfma_f32_32x32x16_bf16 v[48:63], a[68:71], v[176:179], v[48:63]
    v_mfma_f32_32x32x16_bf16 v[64:79], a[68:71], v[180:183], v[64:79]
    buffer_load_dwordx4 v[168:171], v4, s[16:19], s6 offen offset:1024 sc1
    buffer_load_dwordx4 v[172:175], v5, s[16:19], s6 offen offset:1024 sc1
    v_mfma_f32_32x32x16_bf16 v[16:31], a[124:127], v[184:187], v[16:31]
    v_mfma_f32_32x32x16_bf16 v[32:47], a[124:127], v[188:191], v[32:47]
    v_mfma_f32_32x32x16_bf16 v[48:63], a[160:163], v[184:187], v[48:63]
    buffer_load_dwordx4 v[176:179], v4, s[16:19], s7 offen offset:1024 sc1
    buffer_load_dwordx4 v[180:183], v5, s[16:19], s7 offen offset:1024 sc1
    v_mfma_f32_32x32x16_bf16 v[64:79], a[160:163], v[188:191], v[64:79]
    v_mfma_f32_32x32x16_bf16 v[16:31], a[36:39], v[88:91], v[16:31]
    v_mfma_f32_32x32x16_bf16 v[32:47], a[36:39], v[92:95], v[32:47]
    s_add_u32 s60, s24, 4096
    buffer_load_dwordx4 v[184:187], v2, s[16:19], s60 offen offset:0
    buffer_load_dwordx4 v[188:191], v3, s[16:19], s60 offen offset:0
    v_mfma_f32_32x32x16_bf16 v[48:63], a[96:99], v[88:91], v[48:63]
    v_mfma_f32_32x32x16_bf16 v[64:79], a[96:99], v[92:95], v[64:79]
    v_mfma_f32_32x32x16_bf16 v[16:31], a[136:139], v[192:195], v[16:31]
    s_add_u32 s60, s25, 4096
    buffer_load_dwordx4 v[80:83], v2, s[16:19], s60 offen offset:0
    buffer_load_dwordx4 v[84:87], v3, s[16:19], s60 offen offset:0
    v_mfma_f32_32x32x16_bf16 v[32:47], a[136:139], v[196:199], v[32:47]
    v_mfma_f32_32x32x16_bf16 v[48:63], a[0:3], v[192:195], v[48:63]
    v_mfma_f32_32x32x16_bf16 v[64:79], a[0:3], v[196:199], v[64:79]
    s_add_u32 s60, s26, 4096
    buffer_load_dwordx4 v[88:91], v2, s[16:19], s60 offen offset:0
    buffer_load_dwordx4 v[92:95], v3, s[16:19], s60 offen offset:0
    s_waitcnt vmcnt(14)
    v_mfma_f32_32x32x16_bf16 v[16:31], a[72:75], v[200:203], v[16:31]
    s_add_u32 s3, s22, 8192
    buffer_load_dwordx4 a[244:247], v11, s[16:19], s3 offen offset:3072
    v_mfma_f32_32x32x16_bf16 v[32:47], a[72:75], v[204:207], v[32:47]
    s_add_u32 s3, s23, 8192
    buffer_load_dwordx4 a[248:251], v11, s[16:19], s3 offen offset:3072
    v_mfma_f32_32x32x16_bf16 v[48:63], a[236:239], v[200:203], v[48:63]
    s_add_u32 s60, s27, 4096
    buffer_load_dwordx4 v[192:195], v2, s[16:19], s60 offen offset:0
    buffer_load_dwordx4 v[196:199], v3, s[16:19], s60 offen offset:0
    v_mfma_f32_32x32x16_bf16 v[64:79], a[236:239], v[204:207], v[64:79]
    s_add_u32 s3, s21, 12288
    buffer_load_dwordx4 a[116:119], v11, s[16:19], s3 offen offset:0
    s_waitcnt vmcnt(4)
    v_mfma_f32_32x32x16_bf16 v[16:31], a[92:95], v[144:147], v[16:31]
    s_add_u32 s3, s22, 12288
    buffer_load_dwordx4 a[120:123], v11, s[16:19], s3 offen offset:0
    v_mfma_f32_32x32x16_bf16 v[32:47], a[92:95], v[148:151], v[32:47]
    s_add_u32 s3, s23, 12288
    buffer_load_dwordx4 a[208:211], v11, s[16:19], s3 offen offset:0
    v_mfma_f32_32x32x16_bf16 v[48:63], a[244:247], v[144:147], v[48:63]
    s_add_u32 s3, s21, 12288
    buffer_load_dwordx4 a[216:219], v11, s[16:19], s3 offen offset:1024
    v_mfma_f32_32x32x16_bf16 v[64:79], a[244:247], v[148:151], v[64:79]
    s_add_u32 s3, s22, 12288
    buffer_load_dwordx4 a[228:231], v11, s[16:19], s3 offen offset:1024
    s_waitcnt vmcnt(7)
    v_mfma_f32_32x32x16_bf16 v[16:31], a[232:235], v[96:99], v[16:31]
    s_add_u32 s3, s23, 12288
    buffer_load_dwordx4 a[140:143], v11, s[16:19], s3 offen offset:1024
    v_mfma_f32_32x32x16_bf16 v[32:47], a[232:235], v[100:103], v[32:47]
    v_mfma_f32_32x32x16_bf16 v[48:63], a[248:251], v[96:99], v[48:63]
    v_mfma_f32_32x32x16_bf16 v[64:79], a[248:251], v[100:103], v[64:79]
    v_mfma_f32_32x32x16_bf16 v[16:31], a[56:59], v[152:155], v[16:31]
    s_waitcnt vmcnt(2)
    v_mfma_f32_32x32x16_bf16 v[16:31], a[116:119], v[160:163], v[16:31]
    s_waitcnt vmcnt(1)
    v_mfma_f32_32x32x16_bf16 v[16:31], a[120:123], v[168:171], v[16:31]
    s_waitcnt vmcnt(0)
    v_mfma_f32_32x32x16_bf16 v[16:31], a[208:211], v[176:179], v[16:31]
    v_mfma_f32_32x32x16_bf16 v[16:31], a[48:51], v[184:187], v[16:31]
    v_mfma_f32_32x32x16_bf16 v[16:31], a[240:243], v[80:83], v[16:31]
    v_mfma_f32_32x32x16_bf16 v[16:31], a[252:255], v[88:91], v[16:31]
    v_mfma_f32_32x32x16_bf16 v[16:31], a[128:131], v[192:195], v[16:31]
    v_mfma_f32_32x32x16_bf16 v[32:47], a[56:59], v[156:159], v[32:47]
    v_mfma_f32_32x32x16_bf16 v[32:47], a[116:119], v[164:167], v[32:47]
    v_mfma_f32_32x32x16_bf16 v[32:47], a[120:123], v[172:175], v[32:47]
    ds_write_b128 v8, v[16:19] offset:0
    v_mfma_f32_32x32x16_bf16 v[32:47], a[208:211], v[180:183], v[32:47]
    v_mfma_f32_32x32x16_bf16 v[32:47], a[48:51], v[188:191], v[32:47]
    ds_write_b128 v8, v[20:23] offset:32
    v_mfma_f32_32x32x16_bf16 v[32:47], a[240:243], v[84:87], v[32:47]
    v_mfma_f32_32x32x16_bf16 v[32:47], a[252:255], v[92:95], v[32:47]
    ds_write_b128 v8, v[24:27] offset:64
    v_mfma_f32_32x32x16_bf16 v[32:47], a[128:131], v[196:199], v[32:47]
    v_mfma_f32_32x32x16_bf16 v[48:63], a[88:91], v[152:155], v[48:63]
    ds_write_b128 v8, v[28:31] offset:96
    v_mfma_f32_32x32x16_bf16 v[48:63], a[216:219], v[160:163], v[48:63]
    v_mfma_f32_32x32x16_bf16 v[48:63], a[228:231], v[168:171], v[48:63]
    ds_write_b128 v8, v[32:35] offset:8704
    v_mfma_f32_32x32x16_bf16 v[48:63], a[140:143], v[176:179], v[48:63]
    v_mfma_f32_32x32x16_bf16 v[48:63], a[60:63], v[184:187], v[48:63]
    ds_write_b128 v8, v[36:39] offset:8736
    v_mfma_f32_32x32x16_bf16 v[48:63], a[220:223], v[80:83], v[48:63]
    v_mfma_f32_32x32x16_bf16 v[48:63], a[196:199], v[88:91], v[48:63]
    ds_write_b128 v8, v[40:43] offset:8768
    v_mfma_f32_32x32x16_bf16 v[48:63], a[204:207], v[192:195], v[48:63]
    v_mfma_f32_32x32x16_bf16 v[64:79], a[88:91], v[156:159], v[64:79]
    ds_write_b128 v8, v[44:47] offset:8800
    v_mfma_f32_32x32x16_bf16 v[64:79], a[216:219], v[164:167], v[64:79]
    v_mfma_f32_32x32x16_bf16 v[64:79], a[228:231], v[172:175], v[64:79]
    ds_write_b128 v8, v[48:51] offset:128
    v_mfma_f32_32x32x16_bf16 v[64:79], a[140:143], v[180:183], v[64:79]
    v_mfma_f32_32x32x16_bf16 v[64:79], a[60:63], v[188:191], v[64:79]
    ds_write_b128 v8, v[52:55] offset:160
    v_mfma_f32_32x32x16_bf16 v[64:79], a[220:223], v[84:87], v[64:79]
    v_mfma_f32_32x32x16_bf16 v[64:79], a[196:199], v[92:95], v[64:79]
    ds_write_b128 v8, v[56:59] offset:192
    v_mfma_f32_32x32x16_bf16 v[64:79], a[204:207], v[196:199], v[64:79]
    v_mul_u32_u24 v9, 1088, v252
    v_lshl_add_u32 v9, v253, 4, v9
    v_lshlrev_b32 v10, 12, v252
    v_lshl_add_u32 v10, v253, 3, v10
    s_lshl_b32 s53, s72, 16
    s_lshl_b32 s54, s48, 7
    s_add_u32 s53, s53, s54
    s_nop 7
    ds_write_b128 v8, v[60:63] offset:224
    ds_write_b128 v8, v[64:67] offset:8832
    ds_write_b128 v8, v[68:71] offset:8864
    ds_write_b128 v8, v[72:75] offset:8896
    ds_write_b128 v8, v[76:79] offset:8928
    s_mov_b32 s32, s8
    s_and_b32 s33, s9, 0xffff
    s_mov_b32 s34, 0x200000
    s_mov_b32 s35, 0x00020000
    v_lshlrev_b32 v13, 4, v253
    s_lshl_b32 s54, s48, 8
    s_add_u32 s54, s54, 141312
    v_add_u32 v13, s54, v13
    v_lshlrev_b32 v112, 16, v240
    v_and_b32 v113, s40, v240
    v_lshlrev_b32 v114, 16, v244
    v_and_b32 v115, s40, v244
    v_lshlrev_b32 v116, 16, v241
    v_and_b32 v117, s40, v241
    v_lshlrev_b32 v118, 16, v245
    v_and_b32 v119, s40, v245
    v_lshlrev_b32 v120, 16, v242
    v_and_b32 v121, s40, v242
    v_lshlrev_b32 v122, 16, v246
    v_and_b32 v123, s40, v246
    v_lshlrev_b32 v124, 16, v243
    v_and_b32 v125, s40, v243
    v_lshlrev_b32 v126, 16, v247
    v_and_b32 v127, s40, v247
    s_waitcnt lgkmcnt(0)
    s_barrier
    ds_read_b128 v[128:131], v9 offset:0
    ds_read_b128 v[132:135], v9 offset:272
    ds_read_b128 v[136:139], v9 offset:544
    ds_read_b128 v[140:143], v9 offset:816
    ds_read_b128 v[144:147], v9 offset:17408
    ds_read_b128 v[148:151], v9 offset:17680
    ds_read_b128 v[152:155], v9 offset:17952
    ds_read_b128 v[156:159], v9 offset:18224
    ds_read_b128 v[160:163], v9 offset:34816
    ds_read_b128 v[164:167], v9 offset:35088
    ds_read_b128 v[168:171], v9 offset:35360
    ds_read_b128 v[172:175], v9 offset:35632
    ds_read_b128 v[176:179], v9 offset:52224
    ds_read_b128 v[180:183], v9 offset:52496
    ds_read_b128 v[184:187], v9 offset:52768
    s_waitcnt lgkmcnt(7)
    ds_read_b128 v[188:191], v9 offset:53040
    ds_read_b128 v[96:99], v13
    v_pk_add_f32 v[128:129], v[128:129], v[144:145]
    v_pk_add_f32 v[130:131], v[130:131], v[146:147]
    v_pk_add_f32 v[132:133], v[132:133], v[148:149]
    v_pk_add_f32 v[134:135], v[134:135], v[150:151]
    v_pk_add_f32 v[136:137], v[136:137], v[152:153]
    v_pk_add_f32 v[138:139], v[138:139], v[154:155]
    v_pk_add_f32 v[140:141], v[140:141], v[156:157]
    v_pk_add_f32 v[142:143], v[142:143], v[158:159]
    s_waitcnt lgkmcnt(0)
    v_pk_add_f32 v[160:161], v[160:161], v[176:177]
    v_pk_add_f32 v[162:163], v[162:163], v[178:179]
    v_pk_add_f32 v[164:165], v[164:165], v[180:181]
    v_pk_add_f32 v[166:167], v[166:167], v[182:183]
    v_pk_add_f32 v[168:169], v[168:169], v[184:185]
    v_pk_add_f32 v[170:171], v[170:171], v[186:187]
    v_pk_add_f32 v[172:173], v[172:173], v[188:189]
    v_pk_add_f32 v[174:175], v[174:175], v[190:191]
    v_pk_add_f32 v[128:129], v[128:129], v[160:161]
    v_pk_add_f32 v[130:131], v[130:131], v[162:163]
    v_pk_add_f32 v[132:133], v[132:133], v[164:165]
    v_pk_add_f32 v[134:135], v[134:135], v[166:167]
    v_pk_add_f32 v[136:137], v[136:137], v[168:169]
    v_pk_add_f32 v[138:139], v[138:139], v[170:171]
    v_pk_add_f32 v[140:141], v[140:141], v[172:173]
    v_pk_add_f32 v[142:143], v[142:143], v[174:175]
    v_cvt_pk_bf16_f32 v128, 0, v128
    v_cvt_pk_bf16_f32 v129, 0, v129
    v_cvt_pk_bf16_f32 v130, 0, v130
    v_cvt_pk_bf16_f32 v131, 0, v131
    v_cvt_pk_bf16_f32 v132, 0, v132
    v_cvt_pk_bf16_f32 v133, 0, v133
    v_cvt_pk_bf16_f32 v134, 0, v134
    v_cvt_pk_bf16_f32 v135, 0, v135
    v_cvt_pk_bf16_f32 v136, 0, v136
    v_cvt_pk_bf16_f32 v137, 0, v137
    v_cvt_pk_bf16_f32 v138, 0, v138
    v_cvt_pk_bf16_f32 v139, 0, v139
    v_cvt_pk_bf16_f32 v140, 0, v140
    v_cvt_pk_bf16_f32 v141, 0, v141
    v_cvt_pk_bf16_f32 v142, 0, v142
    v_cvt_pk_bf16_f32 v143, 0, v143
    v_pk_mul_f32 v[128:129], v[128:129], v[96:97]
    v_pk_mul_f32 v[130:131], v[130:131], v[98:99]
    v_pk_mul_f32 v[132:133], v[132:133], v[96:97]
    v_pk_mul_f32 v[134:135], v[134:135], v[98:99]
    v_pk_mul_f32 v[136:137], v[136:137], v[96:97]
    v_pk_mul_f32 v[138:139], v[138:139], v[98:99]
    v_pk_mul_f32 v[140:141], v[140:141], v[96:97]
    v_pk_mul_f32 v[142:143], v[142:143], v[98:99]
    v_cvt_pk_bf16_f32 v128, 0, v128
    v_cvt_pk_bf16_f32 v129, 0, v129
    v_cvt_pk_bf16_f32 v130, 0, v130
    v_cvt_pk_bf16_f32 v131, 0, v131
    v_cvt_pk_bf16_f32 v132, 0, v132
    v_cvt_pk_bf16_f32 v133, 0, v133
    v_cvt_pk_bf16_f32 v134, 0, v134
    v_cvt_pk_bf16_f32 v135, 0, v135
    v_cvt_pk_bf16_f32 v136, 0, v136
    v_cvt_pk_bf16_f32 v137, 0, v137
    v_cvt_pk_bf16_f32 v138, 0, v138
    v_cvt_pk_bf16_f32 v139, 0, v139
    v_cvt_pk_bf16_f32 v140, 0, v140
    v_cvt_pk_bf16_f32 v141, 0, v141
    v_cvt_pk_bf16_f32 v142, 0, v142
    v_cvt_pk_bf16_f32 v143, 0, v143
    v_pk_add_f32 v[128:129], v[128:129], v[112:113]
    v_pk_add_f32 v[130:131], v[130:131], v[114:115]
    v_pk_add_f32 v[132:133], v[132:133], v[116:117]
    v_pk_add_f32 v[134:135], v[134:135], v[118:119]
    v_pk_add_f32 v[136:137], v[136:137], v[120:121]
    v_pk_add_f32 v[138:139], v[138:139], v[122:123]
    v_pk_add_f32 v[140:141], v[140:141], v[124:125]
    v_pk_add_f32 v[142:143], v[142:143], v[126:127]
    v_cvt_pk_bf16_f32 v144, v128, v129
    v_cvt_pk_bf16_f32 v145, v130, v131
    v_cvt_pk_bf16_f32 v146, v132, v133
    v_cvt_pk_bf16_f32 v147, v134, v135
    v_cvt_pk_bf16_f32 v148, v136, v137
    v_cvt_pk_bf16_f32 v149, v138, v139
    v_cvt_pk_bf16_f32 v150, v140, v141
    v_cvt_pk_bf16_f32 v151, v142, v143
    buffer_store_dwordx2 v[144:145], v10, s[32:35], s53 offen offset:0
    buffer_store_dwordx2 v[146:147], v10, s[32:35], s53 offen offset:1024
    buffer_store_dwordx2 v[148:149], v10, s[32:35], s53 offen offset:2048
    buffer_store_dwordx2 v[150:151], v10, s[32:35], s53 offen offset:3072
    s_endpgm
LL_slow0:
    s_mov_b32 s59, 0
LL_slowl0:
    s_sleep 1
    buffer_load_dwordx2 v[48:49], v189, s[16:19], s37 offen sc1
    s_add_u32 s59, s59, 1
    s_waitcnt vmcnt(0)
    v_xor_b32 v48, s36, v48
    v_xor_b32 v49, s36, v49
    v_or_b32 v48, v48, v49
    v_cmp_ne_u32 vcc, 0, v48
    s_cbranch_vccz LL_back0
    s_cmp_lt_u32 s59, 8192
    s_cbranch_scc1 LL_slowl0
    s_branch LL_back0
LL_slow1:
    s_mov_b32 s59, 0
LL_slowl1:
    s_sleep 1
    buffer_load_dwordx2 v[144:145], v24, s[16:19], s54 offen offset:0 sc1
    buffer_load_dwordx2 v[146:147], v24, s[16:19], s54 offen offset:2048 sc1
    buffer_load_dwordx2 v[148:149], v24, s[16:19], s55 offen offset:0 sc1
    buffer_load_dwordx2 v[150:151], v24, s[16:19], s55 offen offset:2048 sc1
    buffer_load_dwordx2 v[152:153], v24, s[16:19], s56 offen offset:0 sc1
    buffer_load_dwordx2 v[154:155], v24, s[16:19], s56 offen offset:2048 sc1
    buffer_load_dwordx2 v[156:157], v189, s[16:19], s56 offen sc1
    s_add_u32 s59, s59, 1
    s_waitcnt vmcnt(0)
    v_xor_b32 v145, s36, v145
    v_xor_b32 v147, s36, v147
    v_xor_b32 v149, s36, v149
    v_xor_b32 v151, s36, v151
    v_xor_b32 v153, s36, v153
    v_xor_b32 v155, s36, v155
    v_xor_b32 v157, s36, v157
    v_or3_b32 v145, v145, v147, v149
    v_or3_b32 v145, v145, v151, v153
    v_or3_b32 v145, v145, v155, v157
    v_cmp_ne_u32 vcc, 0, v145
    s_cbranch_vccz LL_back1
    s_cmp_lt_u32 s59, 8192
    s_cbranch_scc1 LL_slowl1
    s_branch LL_back1
LL_slow2:
    s_mov_b32 s59, 0
LL_slowl2:
    s_sleep 1
    buffer_load_dword v208, v232, s[16:19], s98 offen offset:0 sc1
    buffer_load_dword v209, v232, s[16:19], s98 offen offset:128 sc1
    buffer_load_dword v210, v232, s[16:19], s98 offen offset:256 sc1
    buffer_load_dword v211, v232, s[16:19], s98 offen offset:384 sc1
    buffer_load_dword v212, v232, s[16:19], s58 offen offset:0 sc1
    buffer_load_dword v213, v232, s[16:19], s58 offen offset:128 sc1
    buffer_load_dword v214, v232, s[16:19], s58 offen offset:256 sc1
    buffer_load_dword v215, v232, s[16:19], s58 offen offset:384 sc1
    s_add_u32 s59, s59, 1
    s_waitcnt vmcnt(0)
    v_max3_u32 v217, v208, v209, v210
    v_max3_u32 v217, v217, v211, v212
    v_max3_u32 v217, v217, v213, v214
    v_max_u32 v217, v217, v215
    v_cmp_eq_u32 vcc, -1, v217
    s_cbranch_vccz LL_back2
    s_cmp_lt_u32 s59, 8192
    s_cbranch_scc1 LL_slowl2
    s_branch LL_back2
LL_slow3:
    s_mov_b32 s59, 0
LL_slowl3:
    s_sleep 4
    buffer_load_dword v200, v205, s[16:19], s61 offen sc1
    s_add_u32 s59, s59, 1
    s_waitcnt vmcnt(0)
    v_cmp_ne_u32 vcc, s36, v200
    s_cbranch_vccz LL_back3
    s_cmp_lt_u32 s59, 8192
    s_cbranch_scc1 LL_slowl3
    s_branch LL_back3
LL_slow4:
    s_mov_b32 s59, 0
LL_slowl4:
    s_sleep 0
    buffer_load_dword v14, v250, s[16:19], s67 offen sc1
    s_add_u32 s59, s59, 1
    s_waitcnt vmcnt(0)
    v_cmp_ne_u32 vcc, s36, v14
    s_cbranch_vccz LL_back4
    s_cmp_lt_u32 s59, 8192
    s_cbranch_scc1 LL_slowl4
    s_branch LL_back4
LL_slow5:
    s_mov_b32 s59, 0
LL_slowl5:
    s_sleep 1
    buffer_load_dwordx2 v[14:15], v12, s[16:19], s33 offen offset:0 sc1
    s_add_u32 s59, s59, 1
    s_waitcnt vmcnt(0)
    v_xor_b32 v14, s36, v14
    v_xor_b32 v15, s36, v15
    v_or_b32 v14, v14, v15
    v_cmp_ne_u32 vcc, 0, v14
    s_cbranch_vccz LL_back5
    s_cmp_lt_u32 s59, 8192
    s_cbranch_scc1 LL_slowl5
    s_branch LL_back5
LL_slow6:
    s_mov_b32 s59, 0
LL_slowl6:
    s_sleep 1
    buffer_load_dwordx2 v[14:15], v12, s[16:19], s75 offen offset:1024 sc1
    s_add_u32 s59, s59, 1
    s_waitcnt vmcnt(0)
    v_xor_b32 v14, s36, v14
    v_xor_b32 v15, s36, v15
    v_or_b32 v14, v14, v15
    v_cmp_ne_u32 vcc, 0, v14
    s_cbranch_vccz LL_back6
    s_cmp_lt_u32 s59, 8192
    s_cbranch_scc1 LL_slowl6
    s_branch LL_back6
LL_slow7:
    s_mov_b32 s59, 0
LL_slowl7:
    s_sleep 1
    buffer_load_dwordx2 v[14:15], v12, s[16:19], s75 offen offset:2048 sc1
    s_add_u32 s59, s59, 1
    s_waitcnt vmcnt(0)
    v_xor_b32 v14, s36, v14
    v_xor_b32 v15, s36, v15
    v_or_b32 v14, v14, v15
    v_cmp_ne_u32 vcc, 0, v14
    s_cbranch_vccz LL_back7
    s_cmp_lt_u32 s59, 8192
    s_cbranch_scc1 LL_slowl7
    s_branch LL_back7
LL_slow8:
    s_mov_b32 s59, 0
LL_slowl8:
    s_sleep 1
    buffer_load_dwordx2 v[14:15], v12, s[16:19], s75 offen offset:3072 sc1
    s_add_u32 s59, s59, 1
    s_waitcnt vmcnt(0)
    v_xor_b32 v14, s36, v14
    v_xor_b32 v15, s36, v15
    v_or_b32 v14, v14, v15
    v_cmp_ne_u32 vcc, 0, v14
    s_cbranch_vccz LL_back8
    s_cmp_lt_u32 s59, 8192
    s_cbranch_scc1 LL_slowl8
    s_branch LL_back8

Lm_e0slow:
    s_mov_b32 s59, 0
Lm_e0l:
    s_sleep 2
    buffer_load_dwordx2 v[216:217], v218, s[16:19], s54 offen sc1
    s_add_u32 s59, s59, 1
    s_waitcnt vmcnt(0)
    v_subrev_co_u32 v40, vcc, s68, v216
    v_mov_b32 v41, s69
    v_subb_co_u32 v41, vcc, v217, v41, vcc
    v_lshrrev_b32 v40, 24, v40
    v_or_b32 v40, v40, v41
    v_cmp_ne_u32 vcc, 0, v40
    s_cbranch_vccz Lm_e0back
    s_cmp_lt_u32 s59, 8192
    s_cbranch_scc1 Lm_e0l
    s_branch Lm_e0back

Lm_fast_end:
Lm_G:
    v_mov_b32 v193, s36
    s_lshl_b32 s37, s42, 9
    s_add_u32 s37, s37, 7077888
    s_lshl_b32 s39, s43, 4
    s_lshl_b32 s60, s44, 2
    s_add_u32 s39, s39, s60
    s_add_u32 s39, s39, s37
    v_lshlrev_b32 v189, 3, v3
    s_waitcnt lgkmcnt(1)
    buffer_store_dwordx4 v[10:13], v220, s[16:19], s38 offen sc1
    s_waitcnt lgkmcnt(0)
    buffer_store_dwordx4 v[14:17], v220, s[16:19], s50 offen sc1
    v_lshlrev_b32 v1, 4, v0
    s_lshr_b32 s50, s44, 1
    s_and_b32 s51, s44, 1
    v_and_b32 v60, 15, v3
    v_lshrrev_b32 v61, 4, v3
    v_add_u32 v4, 114752, v1
    v_alignbit_b32 v32, v133, v132, 16
    v_alignbit_b32 v33, v134, v133, 16
    v_alignbit_b32 v34, v135, v134, 16
    v_alignbit_b32 v35, v139, v135, 16
    v_alignbit_b32 v36, v137, v136, 16
    v_alignbit_b32 v37, v138, v137, 16
    v_alignbit_b32 v38, v139, v138, 16
    v_alignbit_b32 v39, v140, v139, 16
    ds_write_b128 v4, v[132:135]
    ds_write_b128 v4, v[136:139] offset:8320
    ds_write_b128 v4, v[32:35] offset:4160
    ds_write_b128 v4, v[36:39] offset:12480
    v_readfirstlane_b32 s54, v132
    v_readfirstlane_b32 s55, v133
    s_waitcnt vmcnt(0)
    s_mov_b64 exec, 1
    buffer_store_dword v193, v219, s[16:19], s39 offen sc1
    s_mov_b64 exec, -1
    v_alignbit_b32 v40, v143, v142, 16
    v_alignbit_b32 v41, v144, v143, 16
    v_alignbit_b32 v42, v145, v144, 16
    v_alignbit_b32 v43, v149, v145, 16
    v_alignbit_b32 v44, v147, v146, 16
    v_alignbit_b32 v45, v148, v147, 16
    v_alignbit_b32 v46, v149, v148, 16
    v_alignbit_b32 v47, v150, v149, 16
    ds_write_b128 v4, v[142:145] offset:16640
    ds_write_b128 v4, v[146:149] offset:24960
    ds_write_b128 v4, v[40:43] offset:20800
    ds_write_b128 v4, v[44:47] offset:29120
    v_readfirstlane_b32 s58, v142
    v_readfirstlane_b32 s59, v143
    buffer_load_dwordx2 v[48:49], v189, s[16:19], s37 offen sc1
    s_cmp_lg_u32 s44, 0
    s_cbranch_scc1 LG_nohead
    v_bfe_u32 v32, v3, 4, 1
    v_bfe_u32 v33, v3, 2, 2
    v_and_b32 v34, 3, v3
    v_mul_u32_u24 v35, 16640, v32
    v_mul_u32_u24 v36, 4160, v33
    v_lshl_add_u32 v35, v34, 4, v35
    v_add_u32 v35, v35, v36
    v_add_u32 v35, 114688, v35
    v_cmp_eq_u32 vcc, 1, v32
    v_mov_b32 v36, s54
    v_mov_b32 v37, s55
    v_mov_b32 v38, s58
    v_mov_b32 v39, s59
    v_cndmask_b32 v36, v36, v38, vcc
    v_cndmask_b32 v37, v37, v39, vcc
    v_lshlrev_b32 v38, 4, v33
    v_sub_u32 v38, 64, v38
    v_lshlrev_b64 v[36:37], v38, v[36:37]
    v_cmp_eq_u32 vcc, 3, v34
    v_cmp_ne_u32 s[54:55], 0, v33
    s_and_b64 vcc, vcc, s[54:55]
    v_cndmask_b32 v158, 0, v36, vcc
    v_cndmask_b32 v159, 0, v37, vcc
    ds_write_b128 v35, v[156:159]
LG_nohead:
    s_mul_i32 s54, s41, 8960
    s_add_u32 s55, s54, 22024576
    s_add_u32 s54, s54, 22020096
    v_lshrrev_b32 v26, 1, v0
    v_lshlrev_b32 v24, 3, v26
    s_cmp_lt_u32 s43, 24
    s_cselect_b32 s58, 24576, 0
    v_mul_u32_u24 v25, s58, v26
    v_and_b32 v26, 1, v0
    v_lshlrev_b32 v26, 4, v26
    s_min_u32 s60, s43, 23
    s_mul_i32 s58, s42, 24
    s_add_u32 s58, s58, s60
    s_lshl_b32 s58, s58, 5
    v_add3_u32 v25, s58, v25, v26
    v_add_u32 v26, 6144, v25
    v_add_u32 v28, 12288, v25
    v_add_u32 v29, 18432, v25
    v_and_b32 v7, 7, v3
    v_lshrrev_b32 v6, 3, v3
    v_lshlrev_b32 v6, 9, v6
    v_lshl_add_u32 v233, v7, 4, v6
    s_lshl_b32 s60, s44, 13
    v_add_u32 v6, s60, v6
    v_lshl_add_u32 v232, v7, 2, v6
    s_mul_i32 s60, s44, 8960
    v_add_u32 v233, s60, v233
    v_lshrrev_b32 v6, 5, v3
    v_and_b32 v27, 31, v3
    v_lshlrev_b32 v27, 4, v27
    v_lshl_add_u32 v27, v6, 10, v27
    v_lshrrev_b32 v6, 3, v0
    v_and_b32 v7, 7, v0
    v_lshlrev_b32 v231, 15, v6
    v_lshl_add_u32 v231, v7, 4, v231
    s_lshl_b32 s58, s41, 7
    v_add_u32 v231, s58, v231
    v_mul_u32_u24 v230, 80, v6
    v_lshl_add_u32 v230, v7, 3, v230
    v_add_u32 v230, 49152, v230
    v_mul_u32_u24 v6, 96, v6
    v_lshl_add_u32 v6, v7, 3, v6
    v_sub_u32 v188, 151000, v6
    v_mov_b32 v40, -1
    v_mov_b32 v41, -1
    v_mov_b32 v42, -1
    v_mov_b32 v43, -1
    s_mov_b32 s94, 4194304
    s_mov_b32 s95, 5242880
    s_lshr_b32 s58, s41, 2
    s_lshl_b32 s96, s58, 15
    s_and_b32 s60, s41, 3
    s_lshl_b32 s61, s60, 5
    s_add_u32 s98, s96, s61
    s_add_u32 s98, s98, 4194304
    s_lshl_b32 s61, s60, 7
    s_mul_i32 s96, s58, 35840
    s_add_u32 s96, s96, s61
    s_add_u32 s96, s96, 22020096
    s_lshl_b32 s58, s58, 7
    s_lshl_b32 s60, s60, 4
    s_add_u32 s58, s58, s60
    s_lshl_b32 s60, s44, 2
    s_add_u32 s58, s58, s60
    s_add_u32 s99, s58, 7094272
    v_lshrrev_b32 v5, 2, v0
    v_and_b32 v6, 3, v0
    v_mul_u32_u24 v5, 96, v5
    v_lshl_add_u32 v5, v6, 4, v5
    v_add_u32 v5, 114688, v5
    s_waitcnt vmcnt(0)
    v_xor_b32 v48, s36, v48
    v_xor_b32 v49, s36, v49
    v_or_b32 v48, v48, v49
    v_cmp_ne_u32 vcc, 0, v48
    s_cbranch_vccnz LG_slow0
LG_back0:
    buffer_load_dwordx4 v[48:51], v1, s[16:19], s54 offen
    buffer_load_dwordx4 v[52:55], v1, s[16:19], s55 offen
    v_lshrrev_b32 v4, 3, v3
    v_bfe_u32 v7, v3, 1, 2
    v_bfe_u32 v6, v3, 4, 1
    s_lshl_b32 s54, s50, 1
    v_or_b32 v6, s54, v6
    v_xor_b32 v7, v7, v6
    v_mul_u32_u24 v4, 3584, v4
    v_lshl_add_u32 v4, v7, 5, v4
    v_and_b32 v7, 1, v3
    v_lshl_add_u32 v4, v7, 4, v4
    s_lshl_b32 s54, s45, 7
    v_add_u32 v224, s54, v4
    v_add_u32 v225, 27648, v224
    v_add_u32 v226, 55296, v224
    v_add_u32 v227, 82944, v224
    s_lshl_b32 s48, s50, 16
    s_lshl_b32 s54, s51, 12
    s_add_u32 s48, s48, s54
    s_mul_i32 s38, s51, 114688
    s_lshl_b32 s39, s51, 5
    s_mov_b32 s62, 0x0f0f0f0f
    s_mov_b32 s63, 0x0f0f0f0f
    s_and_b32 s54, s46, 1
    s_lshl_b32 s55, s54, 13
    s_mul_i32 s54, s54, 229376
    s_add_u32 s32, s48, s55
    s_sub_u32 s33, s48, s55
    s_add_u32 s34, s38, s54
    s_sub_u32 s35, s38, s54
    s_mul_i32 s55, s55, 3
    s_mul_i32 s54, s54, 3
    s_add_u32 s4, s48, s55
    s_sub_u32 s5, s48, s55
    s_add_u32 s6, s38, s54
    s_sub_u32 s7, s38, s54
    v_add_u32 v62, 1, v60
    v_and_b32 v63, 3, v62
    v_and_b32 v62, 28, v62
    v_mul_u32_u24 v63, 4160, v63
    v_lshl_add_u32 v63, v62, 1, v63
    v_lshl_add_u32 v63, v61, 4, v63
    s_mul_i32 s54, s50, 16640
    s_add_u32 s54, s54, s39
    s_add_u32 s54, s54, 114688
    v_add_u32 v63, s54, v63
    v_sub_u32 v62, 15, v60
    v_mul_u32_u24 v62, 96, v62
    s_mul_i32 s54, s50, 7584
    s_add_u32 s54, s54, 147968
    v_add_u32 v62, s54, v62
    v_lshl_add_u32 v62, v61, 4, v62
    s_mov_b32 s28, s12
    s_and_b32 s29, s13, 0xffff
    s_mov_b32 s30, 0x1c0000
    s_mov_b32 s31, 0x00020000
    s_mul_i32 s54, s45, 98304
    s_mul_i32 s55, s50, 49152
    s_add_u32 s54, s54, s55
    s_mul_i32 s55, s51, 6144
    s_add_u32 s54, s54, s55
    s_add_u32 s54, s54, 9437184
    s_and_b32 s55, s46, 1
    s_mul_i32 s55, s55, 3072
    v_lshlrev_b32 v6, 4, v3
    v_add_u32 v6, s54, v6
    v_add_u32 v238, s55, v6
    v_subrev_u32 v239, s55, v6
    v_add_u32 v239, 3072, v239
    s_waitcnt vmcnt(0)
    ds_write_b128 v5, v[48:51] offset:33280
    ds_write_b128 v5, v[52:55] offset:40864
    v_mov_b32 v128, 0
    v_mov_b32 v129, 0
    v_mov_b32 v130, 0
    v_mov_b32 v131, 0
    v_mov_b32 v132, 0
    v_mov_b32 v133, 0
    v_mov_b32 v134, 0
    v_mov_b32 v135, 0
    v_mov_b32 v136, 0
    v_mov_b32 v137, 0
    v_mov_b32 v138, 0
    v_mov_b32 v139, 0
    v_mov_b32 v140, 0
    v_mov_b32 v141, 0
    v_mov_b32 v142, 0
    v_mov_b32 v143, 0
    s_and_b32 s75, s47, s40
    s_lshl_b32 s74, s47, 16
    s_waitcnt lgkmcnt(0)
    s_barrier
    ds_read_b64 v[48:49], v188 offset:0
    ds_read_b64 v[50:51], v188 offset:3072
    ds_read_b64 v[52:53], v188 offset:7584
    ds_read_b64 v[54:55], v188 offset:10656
    ds_read_b64 v[64:65], v63 offset:0
    ds_read_b64 v[66:67], v63 offset:8
    ds_read_b128 v[80:83], v62 offset:4608
    ds_read_b128 v[84:87], v62 offset:3072
    ds_read_b64 v[68:69], v63 offset:1024
    ds_read_b64 v[70:71], v63 offset:1032
    ds_read_b128 v[88:91], v62 offset:1536
    ds_read_b64 v[72:73], v63 offset:2048
    ds_read_b64 v[74:75], v63 offset:2056
    ds_read_b128 v[92:95], v62 offset:0
    ds_read_b64 v[76:77], v63 offset:3072
    s_waitcnt lgkmcnt(11)
    ds_read_b64 v[78:79], v63 offset:3080
    global_load_dwordx2 v[168:169], v24, s[66:67]
    global_load_dwordx4 v[144:147], v25, s[72:73]
    global_load_dwordx4 v[148:151], v26, s[72:73]
    global_load_dwordx4 v[152:155], v28, s[72:73]
    global_load_dwordx4 v[156:159], v29, s[72:73]
    buffer_store_dwordx4 v[40:43], v231, s[16:19], s94 offen sc1
    buffer_store_dwordx4 v[40:43], v231, s[16:19], s95 offen sc1
    s_waitcnt lgkmcnt(9)
    v_mfma_f32_16x16x32_bf16 v[128:131], v[64:67], v[80:83], v[128:131]
    ds_read_b64 v[96:97], v63 offset:64
    ds_read_b64 v[98:99], v63 offset:72
    v_lshrrev_b32 v228, 4, v3
    s_waitcnt lgkmcnt(10)
    v_mfma_f32_16x16x32_bf16 v[132:135], v[64:67], v[84:87], v[132:135]
    ds_read_b128 v[112:115], v62 offset:4704
    v_and_b32 v190, 1, v3
    v_lshl_add_u32 v228, v190, 2, v228
    s_waitcnt lgkmcnt(9)
    v_mfma_f32_16x16x32_bf16 v[132:135], v[68:71], v[80:83], v[132:135]
    ds_read_b128 v[116:119], v62 offset:3168
    v_lshlrev_b32 v228, 3, v228
    s_lshl_b32 s58, s44, 6
    s_waitcnt lgkmcnt(9)
    v_mfma_f32_16x16x32_bf16 v[136:139], v[64:67], v[88:91], v[136:139]
    ds_read_b64 v[100:101], v63 offset:1088
    ds_read_b64 v[102:103], v63 offset:1096
    v_mfma_f32_16x16x32_bf16 v[136:139], v[68:71], v[84:87], v[136:139]
    ds_read_b128 v[120:123], v62 offset:1632
    s_add_u32 s58, s58, 163136
    v_add_u32 v228, s58, v228
    s_waitcnt lgkmcnt(10)
    v_mfma_f32_16x16x32_bf16 v[136:139], v[72:75], v[80:83], v[136:139]
    ds_read_b64 v[104:105], v63 offset:2112
    v_and_b32 v190, 7, v3
    v_lshlrev_b32 v190, 3, v190
    s_waitcnt lgkmcnt(10)
    v_mfma_f32_16x16x32_bf16 v[140:143], v[64:67], v[92:95], v[140:143]
    ds_read_b64 v[106:107], v63 offset:2120
    v_add_u32 v191, 163136, v190
    s_mul_i32 s61, s42, 24
    v_mfma_f32_16x16x32_bf16 v[140:143], v[68:71], v[88:91], v[140:143]
    ds_read_b128 v[124:127], v62 offset:96
    s_add_u32 s61, s61, s43
    s_lshl_b32 s61, s61, 6
    v_mfma_f32_16x16x32_bf16 v[140:143], v[72:75], v[84:87], v[140:143]
    ds_read_b64 v[108:109], v63 offset:3136
    s_lshl_b32 s58, s42, 3
    s_add_u32 s58, s58, s43
    s_waitcnt lgkmcnt(11)
    v_mfma_f32_16x16x32_bf16 v[140:143], v[76:79], v[80:83], v[140:143]
    ds_read_b64 v[110:111], v63 offset:3144
    s_waitcnt lgkmcnt(9)
    v_mfma_f32_16x16x32_bf16 v[128:131], v[96:99], v[112:115], v[128:131]
    ds_read_b64 v[64:65], v63 offset:128
    ds_read_b64 v[66:67], v63 offset:136
    s_lshl_b32 s58, s58, 3
    s_waitcnt lgkmcnt(10)
    v_mfma_f32_16x16x32_bf16 v[132:135], v[96:99], v[116:119], v[132:135]
    ds_read_b128 v[80:83], v62 offset:4800
    s_add_u32 s58, s58, 12096
    s_cmp_lt_u32 s43, 24
    s_cselect_b32 s61, s61, s58
    s_cselect_b32 s58, 1, 0
    s_waitcnt lgkmcnt(9)
    v_mfma_f32_16x16x32_bf16 v[132:135], v[100:103], v[112:115], v[132:135]
    ds_read_b128 v[84:87], v62 offset:3264
    v_mul_u32_u24 v190, s58, v190
    s_add_u32 s61, s61, 6356992
    s_waitcnt lgkmcnt(9)
    v_mfma_f32_16x16x32_bf16 v[136:139], v[96:99], v[120:123], v[136:139]
    ds_read_b64 v[68:69], v63 offset:1152
    ds_read_b64 v[70:71], v63 offset:1160
    s_mov_b32 s55, 0xbfb8aa3b
    v_mfma_f32_16x16x32_bf16 v[136:139], v[100:103], v[116:119], v[136:139]
    ds_read_b128 v[88:91], v62 offset:1728
    v_lshlrev_b32 v15, 16, v48
    v_and_b32 v14, s40, v48
    s_waitcnt lgkmcnt(10)
    v_mfma_f32_16x16x32_bf16 v[136:139], v[104:107], v[112:115], v[136:139]
    ds_read_b64 v[72:73], v63 offset:2176
    global_load_dwordx4 v[160:163], v196, s[56:57]
    global_load_dwordx4 v[164:167], v196, s[56:57] offset:128
    s_waitcnt lgkmcnt(10)
    v_mfma_f32_16x16x32_bf16 v[140:143], v[96:99], v[124:127], v[140:143]
    ds_read_b64 v[74:75], v63 offset:2184
    v_lshlrev_b32 v13, 16, v49
    v_and_b32 v12, s40, v49
    v_mfma_f32_16x16x32_bf16 v[140:143], v[100:103], v[120:123], v[140:143]
    ds_read_b128 v[92:95], v62 offset:192
    v_lshlrev_b32 v11, 16, v50
    v_and_b32 v10, s40, v50
    v_mfma_f32_16x16x32_bf16 v[140:143], v[104:107], v[116:119], v[140:143]
    ds_read_b64 v[76:77], v63 offset:3200
    v_lshlrev_b32 v9, 16, v51
    v_and_b32 v8, s40, v51
    s_waitcnt lgkmcnt(11)
    v_mfma_f32_16x16x32_bf16 v[140:143], v[108:111], v[112:115], v[140:143]
    ds_read_b64 v[78:79], v63 offset:3208
    v_lshlrev_b32 v23, 16, v52
    v_and_b32 v22, s40, v52
    s_waitcnt lgkmcnt(9)
    v_mfma_f32_16x16x32_bf16 v[128:131], v[64:67], v[80:83], v[128:131]
    ds_read_b64 v[96:97], v63 offset:192
    ds_read_b64 v[98:99], v63 offset:200
    v_lshlrev_b32 v21, 16, v53
    s_waitcnt lgkmcnt(10)
    v_mfma_f32_16x16x32_bf16 v[132:135], v[64:67], v[84:87], v[132:135]
    ds_read_b128 v[112:115], v62 offset:4896
    v_and_b32 v20, s40, v53
    v_lshlrev_b32 v19, 16, v54
    s_waitcnt lgkmcnt(9)
    v_mfma_f32_16x16x32_bf16 v[132:135], v[68:71], v[80:83], v[132:135]
    ds_read_b128 v[116:119], v62 offset:3360
    v_and_b32 v18, s40, v54
    v_lshlrev_b32 v17, 16, v55
    s_waitcnt lgkmcnt(9)
    v_mfma_f32_16x16x32_bf16 v[136:139], v[64:67], v[88:91], v[136:139]
    ds_read_b64 v[100:101], v63 offset:1216
    ds_read_b64 v[102:103], v63 offset:1224
    v_and_b32 v16, s40, v55
    v_mfma_f32_16x16x32_bf16 v[136:139], v[68:71], v[84:87], v[136:139]
    ds_read_b128 v[120:123], v62 offset:1824
    v_mul_f32 v8, s74, v8
    v_mul_f32 v9, s74, v9
    s_waitcnt lgkmcnt(10)
    v_mfma_f32_16x16x32_bf16 v[136:139], v[72:75], v[80:83], v[136:139]
    ds_read_b64 v[104:105], v63 offset:2240
    v_mul_f32 v10, s74, v10
    v_mul_f32 v11, s74, v11
    s_waitcnt lgkmcnt(10)
    v_mfma_f32_16x16x32_bf16 v[140:143], v[64:67], v[92:95], v[140:143]
    ds_read_b64 v[106:107], v63 offset:2248
    v_mul_f32 v12, s74, v12
    v_mul_f32 v13, s74, v13
    v_mfma_f32_16x16x32_bf16 v[140:143], v[68:71], v[88:91], v[140:143]
    ds_read_b128 v[124:127], v62 offset:288
    v_mul_f32 v14, s74, v14
    v_mul_f32 v15, s74, v15
    v_mfma_f32_16x16x32_bf16 v[140:143], v[72:75], v[84:87], v[140:143]
    ds_read_b64 v[108:109], v63 offset:3264
    v_mul_f32 v16, s75, v16
    v_mul_f32 v17, s75, v17
    s_waitcnt lgkmcnt(11)
    v_mfma_f32_16x16x32_bf16 v[140:143], v[76:79], v[80:83], v[140:143]
    ds_read_b64 v[110:111], v63 offset:3272
    s_waitcnt vmcnt(4)
    s_mov_b32 s66, 0x3f803f80
    s_waitcnt lgkmcnt(9)
    v_mfma_f32_16x16x32_bf16 v[128:131], v[96:99], v[112:115], v[128:131]
    ds_read_b64 v[64:65], v63 offset:256
    ds_read_b64 v[66:67], v63 offset:264
    v_lshlrev_b32 v170, 16, v168
    s_waitcnt lgkmcnt(10)
    v_mfma_f32_16x16x32_bf16 v[132:135], v[96:99], v[116:119], v[132:135]
    ds_read_b128 v[80:83], v62 offset:4992
    v_and_b32 v171, s40, v168
    v_lshlrev_b32 v172, 16, v169
    s_waitcnt lgkmcnt(9)
    v_mfma_f32_16x16x32_bf16 v[132:135], v[100:103], v[112:115], v[132:135]
    ds_read_b128 v[84:87], v62 offset:3456
    v_and_b32 v173, s40, v169
    v_mul_f32 v174, s55, v170
    s_waitcnt lgkmcnt(9)
    v_mfma_f32_16x16x32_bf16 v[136:139], v[96:99], v[120:123], v[136:139]
    ds_read_b64 v[68:69], v63 offset:1280
    ds_read_b64 v[70:71], v63 offset:1288
    v_mul_f32 v175, s55, v171
    v_mfma_f32_16x16x32_bf16 v[136:139], v[100:103], v[116:119], v[136:139]
    ds_read_b128 v[88:91], v62 offset:1920
    v_mul_f32 v176, s55, v172
    v_mul_f32 v177, s55, v173
    s_waitcnt lgkmcnt(10)
    v_mfma_f32_16x16x32_bf16 v[136:139], v[104:107], v[112:115], v[136:139]
    ds_read_b64 v[72:73], v63 offset:2304
    v_exp_f32 v174, v174
    v_exp_f32 v175, v175
    s_waitcnt lgkmcnt(10)
    v_mfma_f32_16x16x32_bf16 v[140:143], v[96:99], v[124:127], v[140:143]
    ds_read_b64 v[74:75], v63 offset:2312
    v_exp_f32 v176, v176
    v_exp_f32 v177, v177
    v_mfma_f32_16x16x32_bf16 v[140:143], v[100:103], v[120:123], v[140:143]
    ds_read_b128 v[92:95], v62 offset:384
    v_perm_b32 v178, v148, v144, s52
    v_perm_b32 v179, v148, v144, s53
    v_mfma_f32_16x16x32_bf16 v[140:143], v[104:107], v[116:119], v[140:143]
    ds_read_b64 v[76:77], v63 offset:3328
    v_add_f32 v174, 1.0, v174
    v_add_f32 v175, 1.0, v175
    s_waitcnt lgkmcnt(11)
    v_mfma_f32_16x16x32_bf16 v[140:143], v[108:111], v[112:115], v[140:143]
    ds_read_b64 v[78:79], v63 offset:3336
    v_add_f32 v176, 1.0, v176
    v_add_f32 v177, 1.0, v177
    s_waitcnt lgkmcnt(9)
    v_mfma_f32_16x16x32_bf16 v[128:131], v[64:67], v[80:83], v[128:131]
    ds_read_b64 v[96:97], v63 offset:320
    ds_read_b64 v[98:99], v63 offset:328
    v_rcp_f32 v174, v174
    s_waitcnt lgkmcnt(10)
    v_mfma_f32_16x16x32_bf16 v[132:135], v[64:67], v[84:87], v[132:135]
    ds_read_b128 v[112:115], v62 offset:5088
    v_rcp_f32 v175, v175
    v_rcp_f32 v176, v176
    s_waitcnt lgkmcnt(9)
    v_mfma_f32_16x16x32_bf16 v[132:135], v[68:71], v[80:83], v[132:135]
    ds_read_b128 v[116:119], v62 offset:3552
    v_rcp_f32 v177, v177
    v_perm_b32 v180, v149, v145, s52
    s_waitcnt lgkmcnt(9)
    v_mfma_f32_16x16x32_bf16 v[136:139], v[64:67], v[88:91], v[136:139]
    ds_read_b64 v[100:101], v63 offset:1344
    ds_read_b64 v[102:103], v63 offset:1352
    v_perm_b32 v181, v149, v145, s53
    v_mfma_f32_16x16x32_bf16 v[136:139], v[68:71], v[84:87], v[136:139]
    ds_read_b128 v[120:123], v62 offset:2016
    v_mul_f32 v170, v170, v174
    v_mul_f32 v171, v171, v175
    s_waitcnt lgkmcnt(10)
    v_mfma_f32_16x16x32_bf16 v[136:139], v[72:75], v[80:83], v[136:139]
    ds_read_b64 v[104:105], v63 offset:2368
    v_mul_f32 v172, v172, v176
    v_mul_f32 v173, v173, v177
    s_waitcnt lgkmcnt(10)
    v_mfma_f32_16x16x32_bf16 v[140:143], v[64:67], v[92:95], v[140:143]
    ds_read_b64 v[106:107], v63 offset:2376
    v_cvt_pk_bf16_f32 v168, v170, v171
    v_cvt_pk_bf16_f32 v169, v172, v173
    v_mfma_f32_16x16x32_bf16 v[140:143], v[68:71], v[88:91], v[140:143]
    ds_read_b128 v[124:127], v62 offset:480
    v_perm_b32 v182, v150, v146, s52
    v_perm_b32 v183, v150, v146, s53
    v_mfma_f32_16x16x32_bf16 v[140:143], v[72:75], v[84:87], v[140:143]
    ds_read_b64 v[108:109], v63 offset:3392
    v_perm_b32 v184, v151, v147, s52
    v_perm_b32 v185, v151, v147, s53
    s_waitcnt lgkmcnt(11)
    v_mfma_f32_16x16x32_bf16 v[140:143], v[76:79], v[80:83], v[140:143]
    ds_read_b64 v[110:111], v63 offset:3400
    v_perm_b32 v170, v156, v152, s52
    v_perm_b32 v171, v156, v152, s53
    s_waitcnt lgkmcnt(9)
    v_mfma_f32_16x16x32_bf16 v[128:131], v[96:99], v[112:115], v[128:131]
    ds_read_b64 v[64:65], v63 offset:384
    ds_read_b64 v[66:67], v63 offset:392
    v_perm_b32 v172, v157, v153, s52
    s_waitcnt lgkmcnt(10)
    v_mfma_f32_16x16x32_bf16 v[132:135], v[96:99], v[116:119], v[132:135]
    ds_read_b128 v[80:83], v62 offset:5184
    v_perm_b32 v173, v157, v153, s53
    v_perm_b32 v174, v158, v154, s52
    s_waitcnt lgkmcnt(9)
    v_mfma_f32_16x16x32_bf16 v[132:135], v[100:103], v[112:115], v[132:135]
    ds_read_b128 v[84:87], v62 offset:3648
    v_perm_b32 v175, v158, v154, s53
    v_perm_b32 v176, v159, v155, s52
    s_waitcnt lgkmcnt(9)
    v_mfma_f32_16x16x32_bf16 v[136:139], v[96:99], v[120:123], v[136:139]
    ds_read_b64 v[68:69], v63 offset:1408
    ds_read_b64 v[70:71], v63 offset:1416
    v_perm_b32 v177, v159, v155, s53
    v_mfma_f32_16x16x32_bf16 v[136:139], v[100:103], v[116:119], v[136:139]
    ds_read_b128 v[88:91], v62 offset:2112
    v_dot2_f32_bf16 v178, v178, v168, 0
    v_dot2_f32_bf16 v179, v179, v168, 0
    s_waitcnt lgkmcnt(10)
    v_mfma_f32_16x16x32_bf16 v[136:139], v[104:107], v[112:115], v[136:139]
    ds_read_b64 v[72:73], v63 offset:2432
    v_dot2_f32_bf16 v180, v180, v168, 0
    v_dot2_f32_bf16 v181, v181, v168, 0
    s_waitcnt lgkmcnt(10)
    v_mfma_f32_16x16x32_bf16 v[140:143], v[96:99], v[124:127], v[140:143]
    ds_read_b64 v[74:75], v63 offset:2440
    v_dot2_f32_bf16 v182, v182, v168, 0
    v_dot2_f32_bf16 v183, v183, v168, 0
    v_mfma_f32_16x16x32_bf16 v[140:143], v[100:103], v[120:123], v[140:143]
    ds_read_b128 v[92:95], v62 offset:576
    v_dot2_f32_bf16 v184, v184, v168, 0
    v_dot2_f32_bf16 v185, v185, v168, 0
    v_mfma_f32_16x16x32_bf16 v[140:143], v[104:107], v[116:119], v[140:143]
    ds_read_b64 v[76:77], v63 offset:3456
    v_dot2_f32_bf16 v178, v170, v169, v178
    v_dot2_f32_bf16 v179, v171, v169, v179
    s_waitcnt lgkmcnt(11)
    v_mfma_f32_16x16x32_bf16 v[140:143], v[108:111], v[112:115], v[140:143]
    ds_read_b64 v[78:79], v63 offset:3464
    v_dot2_f32_bf16 v180, v172, v169, v180
    v_dot2_f32_bf16 v181, v173, v169, v181
    s_waitcnt lgkmcnt(9)
    v_mfma_f32_16x16x32_bf16 v[128:131], v[64:67], v[80:83], v[128:131]
    ds_read_b64 v[96:97], v63 offset:448
    ds_read_b64 v[98:99], v63 offset:456
    v_dot2_f32_bf16 v182, v174, v169, v182
    s_waitcnt lgkmcnt(10)
    v_mfma_f32_16x16x32_bf16 v[132:135], v[64:67], v[84:87], v[132:135]
    ds_read_b128 v[112:115], v62 offset:5280
    v_dot2_f32_bf16 v183, v175, v169, v183
    v_dot2_f32_bf16 v184, v176, v169, v184
    s_waitcnt lgkmcnt(9)
    v_mfma_f32_16x16x32_bf16 v[132:135], v[68:71], v[80:83], v[132:135]
    ds_read_b128 v[116:119], v62 offset:3744
    v_dot2_f32_bf16 v185, v177, v169, v185
    s_nop 2
    s_waitcnt lgkmcnt(9)
    v_mfma_f32_16x16x32_bf16 v[136:139], v[64:67], v[88:91], v[136:139]
    ds_read_b64 v[100:101], v63 offset:1472
    ds_read_b64 v[102:103], v63 offset:1480
    v_permlane32_swap_b32 v178, v182
    v_mfma_f32_16x16x32_bf16 v[136:139], v[68:71], v[84:87], v[136:139]
    ds_read_b128 v[120:123], v62 offset:2208
    v_permlane32_swap_b32 v179, v183
    v_permlane32_swap_b32 v180, v184
    s_waitcnt lgkmcnt(10)
    v_mfma_f32_16x16x32_bf16 v[136:139], v[72:75], v[80:83], v[136:139]
    ds_read_b64 v[104:105], v63 offset:2496
    s_add_u32 m0, s4, 0
    s_add_u32 s101, s6, 0
    buffer_load_dwordx4 v224, s[28:31], s101 offen offset:0 lds
    s_waitcnt lgkmcnt(10)
    v_mfma_f32_16x16x32_bf16 v[140:143], v[64:67], v[92:95], v[140:143]
    ds_read_b64 v[106:107], v63 offset:2504
    v_permlane32_swap_b32 v181, v185
    v_add_f32 v178, v178, v182
    v_mfma_f32_16x16x32_bf16 v[140:143], v[68:71], v[88:91], v[140:143]
    ds_read_b128 v[124:127], v62 offset:672
    v_add_f32 v179, v179, v183
    v_add_f32 v180, v180, v184
    v_mfma_f32_16x16x32_bf16 v[140:143], v[72:75], v[84:87], v[140:143]
    ds_read_b64 v[108:109], v63 offset:3520
    v_add_f32 v181, v181, v185
    s_nop 1
    s_waitcnt lgkmcnt(11)
    v_mfma_f32_16x16x32_bf16 v[140:143], v[76:79], v[80:83], v[140:143]
    ds_read_b64 v[110:111], v63 offset:3528
    v_permlane16_swap_b32 v178, v180
    v_permlane16_swap_b32 v179, v181
    s_waitcnt lgkmcnt(9)
    v_mfma_f32_16x16x32_bf16 v[128:131], v[96:99], v[112:115], v[128:131]
    ds_read_b64 v[64:65], v63 offset:512
    ds_read_b64 v[66:67], v63 offset:520
    s_nop 0
    s_waitcnt lgkmcnt(10)
    v_mfma_f32_16x16x32_bf16 v[132:135], v[96:99], v[116:119], v[132:135]
    ds_read_b128 v[80:83], v62 offset:5376
    v_add_f32 v178, v178, v180
    v_add_f32 v179, v179, v181
    s_waitcnt lgkmcnt(9)
    v_mfma_f32_16x16x32_bf16 v[132:135], v[100:103], v[112:115], v[132:135]
    ds_read_b128 v[84:87], v62 offset:3840
    s_nop 0
    v_add_f32_dpp v178, v178, v178 row_shr:2 row_mask:0xf bank_mask:0xf bound_ctrl:0
    s_waitcnt lgkmcnt(9)
    v_mfma_f32_16x16x32_bf16 v[136:139], v[96:99], v[120:123], v[136:139]
    ds_read_b64 v[68:69], v63 offset:1536
    ds_read_b64 v[70:71], v63 offset:1544
    buffer_load_dwordx4 v225, s[28:31], s101 offen offset:1024 lds
    v_mfma_f32_16x16x32_bf16 v[136:139], v[100:103], v[116:119], v[136:139]
    ds_read_b128 v[88:91], v62 offset:2304
    v_add_f32_dpp v179, v179, v179 row_shr:2 row_mask:0xf bank_mask:0xf bound_ctrl:0
    s_nop 0
    s_waitcnt lgkmcnt(10)
    v_mfma_f32_16x16x32_bf16 v[136:139], v[104:107], v[112:115], v[136:139]
    ds_read_b64 v[72:73], v63 offset:2560
    v_add_f32_dpp v178, v178, v178 row_shr:4 row_mask:0xf bank_mask:0xf bound_ctrl:0
    v_add_f32_dpp v179, v179, v179 row_shr:4 row_mask:0xf bank_mask:0xf bound_ctrl:0
    s_waitcnt lgkmcnt(10)
    v_mfma_f32_16x16x32_bf16 v[140:143], v[96:99], v[124:127], v[140:143]
    ds_read_b64 v[74:75], v63 offset:2568
    s_nop 0
    v_add_f32_dpp v178, v178, v178 row_shr:8 row_mask:0xf bank_mask:0xf bound_ctrl:0
    v_mfma_f32_16x16x32_bf16 v[140:143], v[100:103], v[120:123], v[140:143]
    ds_read_b128 v[92:95], v62 offset:768
    v_add_f32_dpp v179, v179, v179 row_shr:8 row_mask:0xf bank_mask:0xf bound_ctrl:0
    v_mul_f32 v18, s75, v18
    v_mfma_f32_16x16x32_bf16 v[140:143], v[104:107], v[116:119], v[140:143]
    ds_read_b64 v[76:77], v63 offset:3584
    v_mul_f32 v19, s75, v19
    v_mul_f32 v20, s75, v20
    s_waitcnt lgkmcnt(11)
    v_mfma_f32_16x16x32_bf16 v[140:143], v[108:111], v[112:115], v[140:143]
    ds_read_b64 v[78:79], v63 offset:3592
    v_mul_f32 v21, s75, v21
    v_mul_f32 v22, s75, v22
    s_waitcnt lgkmcnt(9)
    v_mfma_f32_16x16x32_bf16 v[128:131], v[64:67], v[80:83], v[128:131]
    ds_read_b64 v[96:97], v63 offset:576
    ds_read_b64 v[98:99], v63 offset:584
    v_mul_f32 v23, s75, v23
    s_waitcnt lgkmcnt(10)
    v_mfma_f32_16x16x32_bf16 v[132:135], v[64:67], v[84:87], v[132:135]
    ds_read_b128 v[112:115], v62 offset:5472
    buffer_load_dwordx4 v226, s[28:31], s101 offen offset:2048 lds
    s_waitcnt lgkmcnt(9)
    v_mfma_f32_16x16x32_bf16 v[132:135], v[68:71], v[80:83], v[132:135]
    ds_read_b128 v[116:119], v62 offset:3936
    v_cvt_pk_bf16_f32 v8, 0, v8
    v_cvt_pk_bf16_f32 v9, 0, v9
    s_waitcnt lgkmcnt(9)
    v_mfma_f32_16x16x32_bf16 v[136:139], v[64:67], v[88:91], v[136:139]
    ds_read_b64 v[100:101], v63 offset:1600
    ds_read_b64 v[102:103], v63 offset:1608
    v_cvt_pk_bf16_f32 v10, 0, v10
    v_mfma_f32_16x16x32_bf16 v[136:139], v[68:71], v[84:87], v[136:139]
    ds_read_b128 v[120:123], v62 offset:2400
    v_cvt_pk_bf16_f32 v11, 0, v11
    v_cvt_pk_bf16_f32 v12, 0, v12
    s_waitcnt lgkmcnt(10)
    v_mfma_f32_16x16x32_bf16 v[136:139], v[72:75], v[80:83], v[136:139]
    ds_read_b64 v[104:105], v63 offset:2624
    v_cvt_pk_bf16_f32 v13, 0, v13
    v_cvt_pk_bf16_f32 v14, 0, v14
    s_waitcnt lgkmcnt(10)
    v_mfma_f32_16x16x32_bf16 v[140:143], v[64:67], v[92:95], v[140:143]
    ds_read_b64 v[106:107], v63 offset:2632
    v_cvt_pk_bf16_f32 v15, 0, v15
    v_cvt_pk_bf16_f32 v16, 0, v16
    v_mfma_f32_16x16x32_bf16 v[140:143], v[68:71], v[88:91], v[140:143]
    ds_read_b128 v[124:127], v62 offset:864
    v_cvt_pk_bf16_f32 v17, 0, v17
    v_cvt_pk_bf16_f32 v18, 0, v18
    v_mfma_f32_16x16x32_bf16 v[140:143], v[72:75], v[84:87], v[140:143]
    ds_read_b64 v[108:109], v63 offset:3648
    v_cvt_pk_bf16_f32 v19, 0, v19
    v_cvt_pk_bf16_f32 v20, 0, v20
    s_waitcnt lgkmcnt(11)
    v_mfma_f32_16x16x32_bf16 v[140:143], v[76:79], v[80:83], v[140:143]
    ds_read_b64 v[110:111], v63 offset:3656
    buffer_load_dwordx4 v227, s[28:31], s101 offen offset:3072 lds
    s_waitcnt lgkmcnt(9)
    v_mfma_f32_16x16x32_bf16 v[128:131], v[96:99], v[112:115], v[128:131]
    ds_read_b64 v[64:65], v63 offset:640
    ds_read_b64 v[66:67], v63 offset:648
    v_cvt_pk_bf16_f32 v21, 0, v21
    s_waitcnt lgkmcnt(10)
    v_mfma_f32_16x16x32_bf16 v[132:135], v[96:99], v[116:119], v[132:135]
    ds_read_b128 v[80:83], v62 offset:5568
    v_cvt_pk_bf16_f32 v22, 0, v22
    v_cvt_pk_bf16_f32 v23, 0, v23
    s_waitcnt lgkmcnt(9)
    v_mfma_f32_16x16x32_bf16 v[132:135], v[100:103], v[112:115], v[132:135]
    ds_read_b128 v[84:87], v62 offset:4032
    s_mov_b32 exec_lo, 0xc000c000
    s_mov_b32 exec_hi, 0xc000c000
    ds_write_b64 v228, v[178:179]
    s_mov_b64 exec, -1
    s_waitcnt lgkmcnt(9)
    v_mfma_f32_16x16x32_bf16 v[136:139], v[96:99], v[120:123], v[136:139]
    ds_read_b64 v[68:69], v63 offset:1664
    ds_read_b64 v[70:71], v63 offset:1672
    v_mul_u32_u24 v229, 80, v60
    v_mfma_f32_16x16x32_bf16 v[136:139], v[100:103], v[116:119], v[136:139]
    ds_read_b128 v[88:91], v62 offset:2496
    v_lshl_add_u32 v229, v61, 3, v229
    s_mul_i32 s58, s50, 5120
    s_waitcnt lgkmcnt(10)
    v_mfma_f32_16x16x32_bf16 v[136:139], v[104:107], v[112:115], v[136:139]
    ds_read_b64 v[72:73], v63 offset:2688
    s_add_u32 s58, s58, s39
    s_add_u32 s58, s58, 49152
    s_waitcnt lgkmcnt(10)
    v_mfma_f32_16x16x32_bf16 v[140:143], v[96:99], v[124:127], v[140:143]
    ds_read_b64 v[74:75], v63 offset:2696
    v_add_u32 v229, s58, v229
    v_lshlrev_b32 v250, 2, v3
    v_mfma_f32_16x16x32_bf16 v[140:143], v[100:103], v[120:123], v[140:143]
    ds_read_b128 v[92:95], v62 offset:960
    s_add_u32 m0, s4, 8192
    s_add_u32 s101, s6, 229376
    buffer_load_dwordx4 v224, s[28:31], s101 offen offset:0 lds
    v_mfma_f32_16x16x32_bf16 v[140:143], v[104:107], v[116:119], v[140:143]
    ds_read_b64 v[76:77], v63 offset:3712
    s_lshr_b32 s58, s43, 3
    s_add_u32 s58, s58, s43
    s_waitcnt lgkmcnt(11)
    v_mfma_f32_16x16x32_bf16 v[140:143], v[108:111], v[112:115], v[140:143]
    ds_read_b64 v[78:79], v63 offset:3720
    s_and_b32 s58, s58, 3
    s_mul_i32 s20, s58, 14336
    s_waitcnt lgkmcnt(9)
    v_mfma_f32_16x16x32_bf16 v[128:131], v[64:67], v[80:83], v[128:131]
    ds_read_b64 v[96:97], v63 offset:704
    ds_read_b64 v[98:99], v63 offset:712
    s_add_u32 s59, s58, 1
    s_waitcnt lgkmcnt(10)
    v_mfma_f32_16x16x32_bf16 v[132:135], v[64:67], v[84:87], v[132:135]
    ds_read_b128 v[112:115], v62 offset:5664
    s_and_b32 s59, s59, 3
    s_mul_i32 s21, s59, 14336
    s_waitcnt lgkmcnt(9)
    v_mfma_f32_16x16x32_bf16 v[132:135], v[68:71], v[80:83], v[132:135]
    ds_read_b128 v[116:119], v62 offset:4128
    s_waitcnt vmcnt(7)
    s_barrier
    ds_read2_b64 v[168:171], v191 offset1:8
    ds_read2_b64 v[172:175], v191 offset0:16 offset1:24
    s_waitcnt lgkmcnt(9)
    v_mfma_f32_16x16x32_bf16 v[136:139], v[64:67], v[88:91], v[136:139]
    ds_read_b64 v[100:101], v63 offset:1728
    ds_read_b64 v[102:103], v63 offset:1736
    s_xor_b32 s59, s58, 2
    v_mfma_f32_16x16x32_bf16 v[136:139], v[68:71], v[84:87], v[136:139]
    ds_read_b128 v[120:123], v62 offset:2592
    s_mul_i32 s22, s59, 14336
    s_add_u32 s59, s58, 3
    s_waitcnt lgkmcnt(10)
    v_mfma_f32_16x16x32_bf16 v[136:139], v[72:75], v[80:83], v[136:139]
    ds_read_b64 v[104:105], v63 offset:2752
    buffer_load_dwordx4 v225, s[28:31], s101 offen offset:1024 lds
    s_waitcnt lgkmcnt(10)
    v_mfma_f32_16x16x32_bf16 v[140:143], v[64:67], v[92:95], v[140:143]
    ds_read_b64 v[106:107], v63 offset:2760
    s_and_b32 s59, s59, 3
    s_mul_i32 s23, s59, 14336
    v_mfma_f32_16x16x32_bf16 v[140:143], v[68:71], v[88:91], v[140:143]
    ds_read_b128 v[124:127], v62 offset:1056
    s_lshr_b32 s24, s20, 1
    s_lshr_b32 s25, s21, 1
    v_mfma_f32_16x16x32_bf16 v[140:143], v[72:75], v[84:87], v[140:143]
    ds_read_b64 v[108:109], v63 offset:3776
    s_lshr_b32 s26, s22, 1
    s_lshr_b32 s27, s23, 1
    s_waitcnt lgkmcnt(11)
    v_mfma_f32_16x16x32_bf16 v[140:143], v[76:79], v[80:83], v[140:143]
    ds_read_b64 v[110:111], v63 offset:3784
    s_lshl_b32 s47, s46, 2
    s_add_u32 s47, s47, s44
    s_waitcnt lgkmcnt(9)
    v_mfma_f32_16x16x32_bf16 v[128:131], v[96:99], v[112:115], v[128:131]
    ds_read_b64 v[64:65], v63 offset:768
    ds_read_b64 v[66:67], v63 offset:776
    s_mul_i32 s58, s47, 112
    s_waitcnt lgkmcnt(10)
    v_mfma_f32_16x16x32_bf16 v[132:135], v[96:99], v[116:119], v[132:135]
    ds_read_b128 v[80:83], v62 offset:5760
    s_mul_i32 s59, s45, 7
    s_add_u32 s58, s58, s59
    s_waitcnt lgkmcnt(9)
    v_mfma_f32_16x16x32_bf16 v[132:135], v[100:103], v[112:115], v[132:135]
    ds_read_b128 v[84:87], v62 offset:4224
    s_cmp_lg_u32 s44, 3
    s_cbranch_scc1 LG_nomod
    v_pk_add_f32 v[168:169], v[168:169], v[170:171]
    v_pk_add_f32 v[172:173], v[172:173], v[174:175]
    v_pk_add_f32 v[168:169], v[168:169], v[172:173]
    v_cvt_pk_bf16_f32 v192, v168, v169
    s_mov_b64 exec, 0xff
    buffer_store_dwordx2 v[192:193], v190, s[16:19], s61 offen sc1
    s_mov_b64 exec, -1
LG_nomod:
    s_waitcnt lgkmcnt(9)
    v_mfma_f32_16x16x32_bf16 v[136:139], v[96:99], v[120:123], v[136:139]
    ds_read_b64 v[68:69], v63 offset:1792
    ds_read_b64 v[70:71], v63 offset:1800
    buffer_load_dwordx4 v226, s[28:31], s101 offen offset:2048 lds
    v_mfma_f32_16x16x32_bf16 v[136:139], v[100:103], v[116:119], v[136:139]
    ds_read_b128 v[88:91], v62 offset:2688
    s_lshl_b32 s58, s58, 10
    s_add_u32 s97, s58, 11534336
    s_waitcnt lgkmcnt(10)
    v_mfma_f32_16x16x32_bf16 v[136:139], v[104:107], v[112:115], v[136:139]
    ds_read_b64 v[72:73], v63 offset:2816
    v_min_u32 v251, -1, v3
    v_lshlrev_b32 v251, 7, v251
    s_waitcnt lgkmcnt(10)
    v_mfma_f32_16x16x32_bf16 v[140:143], v[96:99], v[124:127], v[140:143]
    ds_read_b64 v[74:75], v63 offset:2824
    s_add_u32 s58, s97, 0
    v_add_u32 v251, s58, v251
    v_mfma_f32_16x16x32_bf16 v[140:143], v[100:103], v[120:123], v[140:143]
    ds_read_b128 v[92:95], v62 offset:1152
    s_and_b32 s58, s45, 7
    s_mul_i32 s58, s58, 229376
    v_mfma_f32_16x16x32_bf16 v[140:143], v[104:107], v[116:119], v[140:143]
    ds_read_b64 v[76:77], v63 offset:3840
    s_mul_i32 s59, s44, 57344
    s_add_u32 s58, s58, s59
    s_waitcnt lgkmcnt(11)
    v_mfma_f32_16x16x32_bf16 v[140:143], v[108:111], v[112:115], v[140:143]
    ds_read_b64 v[78:79], v63 offset:3848
    s_add_u32 s58, s58, 19922944
    v_lshlrev_b32 v248, 4, v3
    s_waitcnt lgkmcnt(9)
    v_mfma_f32_16x16x32_bf16 v[128:131], v[64:67], v[80:83], v[128:131]
    ds_read_b64 v[96:97], v63 offset:832
    ds_read_b64 v[98:99], v63 offset:840
    v_add_u32 v248, s58, v248
    s_waitcnt lgkmcnt(10)
    v_mfma_f32_16x16x32_bf16 v[132:135], v[64:67], v[84:87], v[132:135]
    ds_read_b128 v[112:115], v62 offset:5856
    buffer_load_dwordx4 v227, s[28:31], s101 offen offset:3072 lds
    s_waitcnt lgkmcnt(9)
    v_mfma_f32_16x16x32_bf16 v[132:135], v[68:71], v[80:83], v[132:135]
    ds_read_b128 v[116:119], v62 offset:4320
    s_lshl_b32 s67, s47, 7
    s_add_u32 s67, s67, 7094272
    s_waitcnt lgkmcnt(9)
    v_mfma_f32_16x16x32_bf16 v[136:139], v[64:67], v[88:91], v[136:139]
    ds_read_b64 v[100:101], v63 offset:1856
    ds_read_b64 v[102:103], v63 offset:1864
    s_lshr_b32 s72, s41, 3
    v_mfma_f32_16x16x32_bf16 v[136:139], v[68:71], v[84:87], v[136:139]
    ds_read_b128 v[120:123], v62 offset:2784
    s_mul_i32 s58, s72, 224
    s_mul_i32 s59, s44, 28
    s_waitcnt lgkmcnt(10)
    v_mfma_f32_16x16x32_bf16 v[136:139], v[72:75], v[80:83], v[136:139]
    ds_read_b64 v[104:105], v63 offset:2880
    s_add_u32 s58, s58, s59
    s_lshl_b32 s58, s58, 10
    s_waitcnt lgkmcnt(10)
    v_mfma_f32_16x16x32_bf16 v[140:143], v[64:67], v[92:95], v[140:143]
    ds_read_b64 v[106:107], v63 offset:2888
    s_add_u32 s73, s58, 11534336
    s_lshl_b32 s74, s46, 12
    v_mfma_f32_16x16x32_bf16 v[140:143], v[68:71], v[88:91], v[140:143]
    ds_read_b128 v[124:127], v62 offset:1248
    s_add_u32 s74, s74, 7208960
    s_and_b32 s58, s72, 1
    v_mfma_f32_16x16x32_bf16 v[140:143], v[72:75], v[84:87], v[140:143]
    ds_read_b64 v[108:109], v63 offset:3904
    s_lshl_b32 s58, s58, 2
    s_add_u32 s58, s58, s44
    s_waitcnt lgkmcnt(11)
    v_mfma_f32_16x16x32_bf16 v[140:143], v[76:79], v[80:83], v[140:143]
    ds_read_b64 v[110:111], v63 offset:3912
    s_add_u32 m0, s4, 16384
    s_add_u32 s101, s6, 458752
    buffer_load_dwordx4 v224, s[28:31], s101 offen offset:0 lds
    s_waitcnt lgkmcnt(9)
    v_mfma_f32_16x16x32_bf16 v[128:131], v[96:99], v[112:115], v[128:131]
    ds_read_b64 v[64:65], v63 offset:896
    ds_read_b64 v[66:67], v63 offset:904
    s_lshl_b32 s58, s58, 7
    s_waitcnt lgkmcnt(10)
    v_mfma_f32_16x16x32_bf16 v[132:135], v[96:99], v[116:119], v[132:135]
    ds_read_b128 v[80:83], v62 offset:5952
    s_add_u32 s75, s74, s58
    s_lshl_b32 s58, s50, 2
    s_waitcnt lgkmcnt(9)
    v_mfma_f32_16x16x32_bf16 v[132:135], v[100:103], v[112:115], v[132:135]
    ds_read_b128 v[84:87], v62 offset:4416
    s_lshr_b32 s59, s45, 2
    s_add_u32 s58, s58, s59
    s_waitcnt lgkmcnt(9)
    v_mfma_f32_16x16x32_bf16 v[136:139], v[96:99], v[120:123], v[136:139]
    ds_read_b64 v[68:69], v63 offset:1920
    ds_read_b64 v[70:71], v63 offset:1928
    s_lshl_b32 s58, s58, 7
    v_mfma_f32_16x16x32_bf16 v[136:139], v[100:103], v[116:119], v[136:139]
    ds_read_b128 v[88:91], v62 offset:2880
    s_add_u32 s74, s74, s58
    s_and_b32 s58, s45, 3
    s_waitcnt lgkmcnt(10)
    v_mfma_f32_16x16x32_bf16 v[136:139], v[104:107], v[112:115], v[136:139]
    ds_read_b64 v[72:73], v63 offset:2944
    s_lshl_b32 s58, s58, 3
    s_add_u32 s74, s74, s58
    s_waitcnt lgkmcnt(10)
    v_mfma_f32_16x16x32_bf16 v[140:143], v[96:99], v[124:127], v[140:143]
    ds_read_b64 v[74:75], v63 offset:2952
    s_lshl_b32 s58, s51, 2
    s_add_u32 s74, s74, s58
    v_mfma_f32_16x16x32_bf16 v[140:143], v[100:103], v[120:123], v[140:143]
    ds_read_b128 v[92:95], v62 offset:1344
    buffer_load_dwordx4 v225, s[28:31], s101 offen offset:1024 lds
    v_mfma_f32_16x16x32_bf16 v[140:143], v[104:107], v[116:119], v[140:143]
    ds_read_b64 v[76:77], v63 offset:3968
    v_lshlrev_b32 v246, 10, v3
    s_mov_b32 s68, 0x3b000000
    s_waitcnt lgkmcnt(11)
    v_mfma_f32_16x16x32_bf16 v[140:143], v[108:111], v[112:115], v[140:143]
    ds_read_b64 v[78:79], v63 offset:3976
    s_mov_b32 s69, 0x3727c5ac
    s_waitcnt lgkmcnt(9)
    v_mfma_f32_16x16x32_bf16 v[128:131], v[64:67], v[80:83], v[128:131]
    ds_read_b64 v[96:97], v63 offset:960
    ds_read_b64 v[98:99], v63 offset:968
    s_waitcnt lgkmcnt(10)
    v_mfma_f32_16x16x32_bf16 v[132:135], v[64:67], v[84:87], v[132:135]
    ds_read_b128 v[112:115], v62 offset:6048
    s_waitcnt lgkmcnt(9)
    v_mfma_f32_16x16x32_bf16 v[132:135], v[68:71], v[80:83], v[132:135]
    ds_read_b128 v[116:119], v62 offset:4512
    s_waitcnt lgkmcnt(9)
    v_mfma_f32_16x16x32_bf16 v[136:139], v[64:67], v[88:91], v[136:139]
    ds_read_b64 v[100:101], v63 offset:1984
    ds_read_b64 v[102:103], v63 offset:1992
    v_mfma_f32_16x16x32_bf16 v[136:139], v[68:71], v[84:87], v[136:139]
    ds_read_b128 v[120:123], v62 offset:2976
    s_waitcnt lgkmcnt(10)
    v_mfma_f32_16x16x32_bf16 v[136:139], v[72:75], v[80:83], v[136:139]
    ds_read_b64 v[104:105], v63 offset:3008
    buffer_load_dwordx4 v226, s[28:31], s101 offen offset:2048 lds
    s_waitcnt lgkmcnt(10)
    v_mfma_f32_16x16x32_bf16 v[140:143], v[64:67], v[92:95], v[140:143]
    ds_read_b64 v[106:107], v63 offset:3016
    v_mfma_f32_16x16x32_bf16 v[140:143], v[68:71], v[88:91], v[140:143]
    ds_read_b128 v[124:127], v62 offset:1440
    v_mfma_f32_16x16x32_bf16 v[140:143], v[72:75], v[84:87], v[140:143]
    ds_read_b64 v[108:109], v63 offset:4032
    s_waitcnt lgkmcnt(11)
    v_mfma_f32_16x16x32_bf16 v[140:143], v[76:79], v[80:83], v[140:143]
    ds_read_b64 v[110:111], v63 offset:4040
    s_waitcnt lgkmcnt(9)
    v_mfma_f32_16x16x32_bf16 v[128:131], v[96:99], v[112:115], v[128:131]
    s_waitcnt lgkmcnt(8)
    v_mfma_f32_16x16x32_bf16 v[132:135], v[96:99], v[116:119], v[132:135]
    s_waitcnt lgkmcnt(6)
    v_mfma_f32_16x16x32_bf16 v[132:135], v[100:103], v[112:115], v[132:135]
    s_waitcnt lgkmcnt(5)
    v_mfma_f32_16x16x32_bf16 v[136:139], v[96:99], v[120:123], v[136:139]
    v_mfma_f32_16x16x32_bf16 v[136:139], v[100:103], v[116:119], v[136:139]
    s_waitcnt lgkmcnt(3)
    v_mfma_f32_16x16x32_bf16 v[136:139], v[104:107], v[112:115], v[136:139]
    s_waitcnt lgkmcnt(2)
    v_mfma_f32_16x16x32_bf16 v[140:143], v[96:99], v[124:127], v[140:143]
    v_mfma_f32_16x16x32_bf16 v[140:143], v[100:103], v[120:123], v[140:143]
    v_mfma_f32_16x16x32_bf16 v[140:143], v[104:107], v[116:119], v[140:143]
    s_waitcnt lgkmcnt(0)
    v_mfma_f32_16x16x32_bf16 v[140:143], v[108:111], v[112:115], v[140:143]
    s_nop 7
    v_cvt_pk_bf16_f32 v64, v128, v129
    v_cvt_pk_bf16_f32 v65, v130, v131
    v_cvt_pk_bf16_f32 v66, v132, v133
    v_cvt_pk_bf16_f32 v67, v134, v135
    v_cvt_pk_bf16_f32 v68, v136, v137
    v_cvt_pk_bf16_f32 v69, v138, v139
    v_cvt_pk_bf16_f32 v70, v140, v141
    v_cvt_pk_bf16_f32 v71, v142, v143
    ds_write_b64 v229, v[64:65] offset:0
    ds_write_b64 v229, v[66:67] offset:1280
    ds_write_b64 v229, v[68:69] offset:2560
    ds_write_b64 v229, v[70:71] offset:3840
    s_waitcnt lgkmcnt(0)
    s_barrier
    ds_read_b64 v[64:65], v230
    ds_read_b64 v[66:67], v230 offset:2560
    ds_read_b64 v[68:69], v230 offset:5120
    ds_read_b64 v[70:71], v230 offset:7680
    s_waitcnt lgkmcnt(0)
    v_lshlrev_b32 v72, 16, v64
    v_and_b32 v73, s40, v64
    v_lshlrev_b32 v74, 16, v65
    v_and_b32 v75, s40, v65
    v_lshlrev_b32 v76, 16, v66
    v_and_b32 v77, s40, v66
    v_lshlrev_b32 v78, 16, v67
    v_and_b32 v79, s40, v67
    v_lshlrev_b32 v80, 16, v68
    v_and_b32 v81, s40, v68
    v_lshlrev_b32 v82, 16, v69
    v_and_b32 v83, s40, v69
    v_lshlrev_b32 v84, 16, v70
    v_and_b32 v85, s40, v70
    v_lshlrev_b32 v86, 16, v71
    v_and_b32 v87, s40, v71
    v_pk_add_f32 v[72:73], v[72:73], v[8:9]
    v_pk_add_f32 v[74:75], v[74:75], v[10:11]
    v_pk_add_f32 v[76:77], v[76:77], v[12:13]
    v_pk_add_f32 v[78:79], v[78:79], v[14:15]
    v_pk_add_f32 v[80:81], v[80:81], v[16:17]
    v_pk_add_f32 v[82:83], v[82:83], v[18:19]
    v_pk_add_f32 v[84:85], v[84:85], v[20:21]
    v_pk_add_f32 v[86:87], v[86:87], v[22:23]
    v_cvt_pk_bf16_f32 v64, v72, v80
    v_cvt_pk_bf16_f32 v65, v73, v81
    v_cvt_pk_bf16_f32 v66, v74, v82
    v_cvt_pk_bf16_f32 v67, v75, v83
    v_cvt_pk_bf16_f32 v68, v76, v84
    v_cvt_pk_bf16_f32 v69, v77, v85
    v_cvt_pk_bf16_f32 v70, v78, v86
    v_cvt_pk_bf16_f32 v71, v79, v87
    buffer_store_dwordx4 v[64:67], v231, s[16:19], s94 offen sc1
    buffer_store_dwordx4 v[68:71], v231, s[16:19], s95 offen sc1
    v_lshlrev_b32 v24, 3, v0
    s_mov_b32 s54, 6356992
    s_mov_b32 s55, 6361088
    s_mov_b32 s56, 6365184
    v_add_u32 v189, 0x1000, v189
    buffer_load_dwordx2 v[144:145], v24, s[16:19], s54 offen offset:0 sc1
    buffer_load_dwordx2 v[146:147], v24, s[16:19], s54 offen offset:2048 sc1
    buffer_load_dwordx2 v[148:149], v24, s[16:19], s55 offen offset:0 sc1
    buffer_load_dwordx2 v[150:151], v24, s[16:19], s55 offen offset:2048 sc1
    buffer_load_dwordx2 v[152:153], v24, s[16:19], s56 offen offset:0 sc1
    buffer_load_dwordx2 v[154:155], v24, s[16:19], s56 offen offset:2048 sc1
    buffer_load_dwordx2 v[156:157], v189, s[16:19], s56 offen sc1
    v_bfe_u32 v204, v3, 2, 2
    v_lshrrev_b32 v205, 4, v3
    v_lshlrev_b32 v204, 7, v204
    v_lshl_add_u32 v204, v205, 5, v204
    v_and_b32 v205, 3, v3
    v_lshl_add_u32 v204, v205, 3, v204
    s_lshl_b32 s60, s44, 11
    s_add_u32 s60, s60, 147456
    v_add_u32 v204, s60, v204
    v_lshlrev_b32 v205, 4, v3
    v_add_u32 v206, s60, v205
    ds_write_b128 v206, a[8:11]
    ds_write_b128 v206, a[12:15] offset:1024
    ds_read_b64_tr_b16 v[200:201], v204 offset:0
    ds_read_b64_tr_b16 v[202:203], v204 offset:512
    ds_read_b64_tr_b16 v[208:209], v204 offset:1024
    ds_read_b64_tr_b16 v[210:211], v204 offset:1536
    buffer_store_dwordx4 a[0:3], v242, s[16:19], 0 offen sc1
    s_mov_b32 exec_hi, 0
    buffer_store_dwordx4 a[4:7], v243, s[16:19], 0 offen sc1
    s_mov_b64 exec, -1
    s_waitcnt lgkmcnt(0)
    buffer_store_dwordx4 v[200:203], v27, s[16:19], s49 offen sc1
    buffer_store_dwordx4 v[208:211], v27, s[16:19], s100 offen sc1
    v_and_b32 v7, 7, v3
    v_lshrrev_b32 v6, 5, v3
    v_lshlrev_b32 v7, 2, v7
    v_add_u32 v235, 143360, v7
    v_lshl_add_u32 v234, v6, 5, v235
    s_lshl_b32 s58, s44, 6
    v_add_u32 v234, s58, v234
    s_mov_b32 s64, 0xff
    s_mov_b32 s65, 0xff
    buffer_load_dwordx4 v227, s[28:31], s101 offen offset:3072 lds
    s_waitcnt vmcnt(25)
    v_dot2_f32_bf16 v96, v160, s66, 0
    v_dot2_f32_bf16 v98, v160, v160, 0
    v_dot2_f32_bf16 v97, v164, s66, 0
    v_dot2_f32_bf16 v99, v164, v164, 0
    v_dot2_f32_bf16 v96, v161, s66, v96
    v_dot2_f32_bf16 v98, v161, v161, v98
    v_dot2_f32_bf16 v97, v165, s66, v97
    v_dot2_f32_bf16 v99, v165, v165, v99
    v_dot2_f32_bf16 v96, v162, s66, v96
    v_dot2_f32_bf16 v98, v162, v162, v98
    v_dot2_f32_bf16 v97, v166, s66, v97
    v_dot2_f32_bf16 v99, v166, v166, v99
    v_dot2_f32_bf16 v96, v163, s66, v96
    v_dot2_f32_bf16 v98, v163, v163, v98
    v_dot2_f32_bf16 v97, v167, s66, v97
    v_dot2_f32_bf16 v99, v167, v167, v99
    s_nop 2
    v_add_f32 v96, v96, v97
    v_add_f32 v98, v98, v99
    s_nop 1
    v_permlane32_swap_b32 v96, v98
    s_nop 0
    v_add_f32 v96, v96, v98
    v_mov_b32 v97, v96
    s_nop 1
    v_permlane16_swap_b32 v96, v97
    s_nop 0
    v_add_f32 v96, v96, v97
    s_nop 1
    v_add_f32_dpp v96, v96, v96 row_ror:8 row_mask:0xf bank_mask:0xf
    s_mov_b64 exec, s[64:65]
    ds_write_b32 v234, v96 offset:0
    s_mov_b64 exec, -1
    v_lshlrev_b32 v64, 16, v160
    v_and_b32 v65, s40, v160
    v_lshlrev_b32 v66, 16, v161
    v_and_b32 v67, s40, v161
    v_lshlrev_b32 v68, 16, v162
    v_and_b32 v69, s40, v162
    v_lshlrev_b32 v70, 16, v163
    v_and_b32 v71, s40, v163
    s_add_u32 m0, s5, 24576
    s_add_u32 s101, s7, 688128
    buffer_load_dwordx4 v224, s[28:31], s101 offen offset:0 lds
    v_lshlrev_b32 v72, 16, v164
    v_and_b32 v73, s40, v164
    v_lshlrev_b32 v74, 16, v165
    v_and_b32 v75, s40, v165
    v_lshlrev_b32 v76, 16, v166
    v_and_b32 v77, s40, v166
    v_lshlrev_b32 v78, 16, v167
    v_and_b32 v79, s40, v167
    buffer_load_dwordx4 v225, s[28:31], s101 offen offset:1024 lds
    v_add_u32 v25, 131072, v24
    v_lshrrev_b32 v26, 3, v3
    v_lshlrev_b32 v26, 5, v26
    s_lshl_b32 s58, s44, 9
    s_add_u32 s58, s58, 131072
    v_add_u32 v26, s58, v26
    s_waitcnt vmcnt(7)
    v_xor_b32 v145, s36, v145
    v_xor_b32 v147, s36, v147
    v_xor_b32 v149, s36, v149
    v_xor_b32 v151, s36, v151
    v_xor_b32 v153, s36, v153
    v_xor_b32 v155, s36, v155
    v_xor_b32 v157, s36, v157
    v_or3_b32 v145, v145, v147, v149
    v_or3_b32 v145, v145, v151, v153
    v_or3_b32 v145, v145, v155, v157
    v_cmp_ne_u32 vcc, 0, v145
    s_cbranch_vccnz LG_slow1
LG_back1:
    v_and_b32 v145, s40, v144
    v_lshlrev_b32 v144, 16, v144
    v_and_b32 v147, s40, v146
    v_lshlrev_b32 v146, 16, v146
    v_and_b32 v149, s40, v148
    v_lshlrev_b32 v148, 16, v148
    v_and_b32 v151, s40, v150
    v_lshlrev_b32 v150, 16, v150
    buffer_load_dwordx4 v226, s[28:31], s101 offen offset:2048 lds
    v_and_b32 v153, s40, v152
    v_lshlrev_b32 v152, 16, v152
    v_and_b32 v155, s40, v154
    v_lshlrev_b32 v154, 16, v154
    v_pk_add_f32 v[146:147], v[146:147], 1.0 op_sel_hi:[1,0]
    v_pk_add_f32 v[152:153], v[152:153], 1.0 op_sel_hi:[1,0]
    v_cvt_pk_bf16_f32 v146, 0, v146
    v_cvt_pk_bf16_f32 v147, 0, v147
    buffer_load_dwordx4 v227, s[28:31], s101 offen offset:3072 lds
    v_cvt_pk_bf16_f32 v152, 0, v152
    v_cvt_pk_bf16_f32 v153, 0, v153
    ds_write_b64 v25, v[144:145] offset:0
    ds_write_b64 v25, v[146:147] offset:2048
    ds_write_b64 v25, v[148:149] offset:4096
    ds_write_b64 v25, v[150:151] offset:6144
    ds_write_b64 v25, v[152:153] offset:8192
    ds_write_b64 v25, v[154:155] offset:10240
    s_waitcnt vmcnt(5)
    s_waitcnt lgkmcnt(0)
    s_barrier
    s_mov_b32 s61, 7110656
    v_lshlrev_b32 v205, 6, v0
    s_cmp_lg_u32 s44, 0
    s_cbranch_scc1 LG_not2
    s_lshl_b32 s60, s41, 6
    s_add_u32 s60, s60, s61
    v_mov_b32 v206, s36
    s_mov_b64 exec, 1
    buffer_store_dword v206, off, s[16:19], s60 sc1
    s_mov_b64 exec, -1
LG_not2:
    ds_read2_b32 v[96:97], v235 offset0:0 offset1:8
    ds_read2_b32 v[98:99], v235 offset0:16 offset1:24
    ds_read2_b32 v[100:101], v235 offset0:32 offset1:40
    ds_read2_b32 v[102:103], v235 offset0:48 offset1:56
    s_waitcnt lgkmcnt(0)
    v_pk_add_f32 v[96:97], v[96:97], v[98:99]
    v_pk_add_f32 v[100:101], v[100:101], v[102:103]
    v_pk_add_f32 v[96:97], v[96:97], v[100:101]
    v_mul_f32 v96, s68, v96
    v_mul_f32 v97, s68, v97
    v_fma_f32 v97, -v96, v96, v97
    v_max_f32 v97, 0, v97
    v_cvt_pk_bf16_f32 v97, 0, v97
    v_add_f32 v97, s69, v97
    v_cvt_pk_bf16_f32 v97, 0, v97
    v_sqrt_f32 v97, v97
    v_cvt_pk_bf16_f32 v96, 0, v96
    v_cvt_pk_bf16_f32 v97, 0, v97
    v_rcp_f32 v97, v97
    s_nop 0
    v_pk_add_f32 v[80:81], v[64:65], v[96:97] op_sel:[0,0] op_sel_hi:[1,0] neg_lo:[0,1] neg_hi:[0,1]
    v_pk_add_f32 v[82:83], v[66:67], v[96:97] op_sel:[0,0] op_sel_hi:[1,0] neg_lo:[0,1] neg_hi:[0,1]
    v_pk_add_f32 v[84:85], v[68:69], v[96:97] op_sel:[0,0] op_sel_hi:[1,0] neg_lo:[0,1] neg_hi:[0,1]
    v_pk_add_f32 v[86:87], v[70:71], v[96:97] op_sel:[0,0] op_sel_hi:[1,0] neg_lo:[0,1] neg_hi:[0,1]
    v_pk_add_f32 v[88:89], v[72:73], v[96:97] op_sel:[0,0] op_sel_hi:[1,0] neg_lo:[0,1] neg_hi:[0,1]
    v_pk_add_f32 v[90:91], v[74:75], v[96:97] op_sel:[0,0] op_sel_hi:[1,0] neg_lo:[0,1] neg_hi:[0,1]
    s_add_u32 m0, s5, 32768
    s_add_u32 s101, s7, 917504
    buffer_load_dwordx4 v224, s[28:31], s101 offen offset:0 lds
    v_pk_add_f32 v[92:93], v[76:77], v[96:97] op_sel:[0,0] op_sel_hi:[1,0] neg_lo:[0,1] neg_hi:[0,1]
    v_pk_add_f32 v[94:95], v[78:79], v[96:97] op_sel:[0,0] op_sel_hi:[1,0] neg_lo:[0,1] neg_hi:[0,1]
    v_cvt_pk_bf16_f32 v80, 0, v80
    v_cvt_pk_bf16_f32 v81, 0, v81
    v_cvt_pk_bf16_f32 v82, 0, v82
    v_cvt_pk_bf16_f32 v83, 0, v83
    buffer_load_dwordx4 v225, s[28:31], s101 offen offset:1024 lds
    v_cvt_pk_bf16_f32 v84, 0, v84
    v_cvt_pk_bf16_f32 v85, 0, v85
    v_cvt_pk_bf16_f32 v86, 0, v86
    v_cvt_pk_bf16_f32 v87, 0, v87
    v_cvt_pk_bf16_f32 v88, 0, v88
    v_cvt_pk_bf16_f32 v89, 0, v89
    buffer_load_dwordx4 v226, s[28:31], s101 offen offset:2048 lds
    v_cvt_pk_bf16_f32 v90, 0, v90
    v_cvt_pk_bf16_f32 v91, 0, v91
    v_cvt_pk_bf16_f32 v92, 0, v92
    v_cvt_pk_bf16_f32 v93, 0, v93
    v_cvt_pk_bf16_f32 v94, 0, v94
    v_cvt_pk_bf16_f32 v95, 0, v95
    buffer_load_dwordx4 v227, s[28:31], s101 offen offset:3072 lds
    v_pk_mul_f32 v[80:81], v[80:81], v[96:97] op_sel:[0,1] op_sel_hi:[1,1]
    v_pk_mul_f32 v[82:83], v[82:83], v[96:97] op_sel:[0,1] op_sel_hi:[1,1]
    v_pk_mul_f32 v[84:85], v[84:85], v[96:97] op_sel:[0,1] op_sel_hi:[1,1]
    v_pk_mul_f32 v[86:87], v[86:87], v[96:97] op_sel:[0,1] op_sel_hi:[1,1]
    v_pk_mul_f32 v[88:89], v[88:89], v[96:97] op_sel:[0,1] op_sel_hi:[1,1]
    v_pk_mul_f32 v[90:91], v[90:91], v[96:97] op_sel:[0,1] op_sel_hi:[1,1]
    s_add_u32 m0, s5, 40960
    s_add_u32 s101, s7, 1146880
    buffer_load_dwordx4 v224, s[28:31], s101 offen offset:0 lds
    v_pk_mul_f32 v[92:93], v[92:93], v[96:97] op_sel:[0,1] op_sel_hi:[1,1]
    v_pk_mul_f32 v[94:95], v[94:95], v[96:97] op_sel:[0,1] op_sel_hi:[1,1]
    v_cvt_pk_bf16_f32 v80, 0, v80
    v_cvt_pk_bf16_f32 v81, 0, v81
    v_cvt_pk_bf16_f32 v82, 0, v82
    v_cvt_pk_bf16_f32 v83, 0, v83
    buffer_load_dwordx4 v225, s[28:31], s101 offen offset:1024 lds
    v_cvt_pk_bf16_f32 v84, 0, v84
    v_cvt_pk_bf16_f32 v85, 0, v85
    v_cvt_pk_bf16_f32 v86, 0, v86
    v_cvt_pk_bf16_f32 v87, 0, v87
    v_cvt_pk_bf16_f32 v88, 0, v88
    v_cvt_pk_bf16_f32 v89, 0, v89
    buffer_load_dwordx4 v226, s[28:31], s101 offen offset:2048 lds
    v_cvt_pk_bf16_f32 v90, 0, v90
    v_cvt_pk_bf16_f32 v91, 0, v91
    v_cvt_pk_bf16_f32 v92, 0, v92
    v_cvt_pk_bf16_f32 v93, 0, v93
    v_cvt_pk_bf16_f32 v94, 0, v94
    v_cvt_pk_bf16_f32 v95, 0, v95
    buffer_load_dwordx4 v227, s[28:31], s101 offen offset:3072 lds
    ds_read_b128 v[112:115], v26 offset:2048
    ds_read_b128 v[116:119], v26 offset:2064
    ds_read_b128 v[120:123], v26 offset:2304
    ds_read_b128 v[124:127], v26 offset:2320
    ds_read_b128 v[128:131], v26 offset:0
    ds_read_b128 v[132:135], v26 offset:16
    ds_read_b128 v[136:139], v26 offset:256
    ds_read_b128 v[140:143], v26 offset:272
    ds_read_b128 v[144:147], v26 offset:4096
    ds_read_b128 v[148:151], v26 offset:4112
    ds_read_b128 v[152:155], v26 offset:4352
    ds_read_b128 v[156:159], v26 offset:4368
    s_add_u32 s58, s98, 4096
    buffer_load_dword v208, v232, s[16:19], s98 offen offset:0 sc1
    buffer_load_dword v209, v232, s[16:19], s98 offen offset:128 sc1
    buffer_load_dword v210, v232, s[16:19], s98 offen offset:256 sc1
    buffer_load_dword v211, v232, s[16:19], s98 offen offset:384 sc1
    buffer_load_dword v212, v232, s[16:19], s58 offen offset:0 sc1
    buffer_load_dword v213, v232, s[16:19], s58 offen offset:128 sc1
    buffer_load_dword v214, v232, s[16:19], s58 offen offset:256 sc1
    buffer_load_dword v215, v232, s[16:19], s58 offen offset:384 sc1
    s_waitcnt lgkmcnt(8)
    v_pk_mul_f32 v[80:81], v[80:81], v[112:113]
    v_pk_mul_f32 v[82:83], v[82:83], v[114:115]
    v_pk_mul_f32 v[84:85], v[84:85], v[116:117]
    v_pk_mul_f32 v[86:87], v[86:87], v[118:119]
    v_pk_mul_f32 v[88:89], v[88:89], v[120:121]
    v_pk_mul_f32 v[90:91], v[90:91], v[122:123]
    v_pk_mul_f32 v[92:93], v[92:93], v[124:125]
    v_pk_mul_f32 v[94:95], v[94:95], v[126:127]
    v_cvt_pk_bf16_f32 v80, 0, v80
    v_cvt_pk_bf16_f32 v81, 0, v81
    s_add_u32 m0, s32, 49152
    s_add_u32 s101, s34, 1376256
    buffer_load_dwordx4 v224, s[28:31], s101 offen offset:0 lds
    v_cvt_pk_bf16_f32 v82, 0, v82
    v_cvt_pk_bf16_f32 v83, 0, v83
    v_cvt_pk_bf16_f32 v84, 0, v84
    v_cvt_pk_bf16_f32 v85, 0, v85
    v_cvt_pk_bf16_f32 v86, 0, v86
    v_cvt_pk_bf16_f32 v87, 0, v87
    v_cvt_pk_bf16_f32 v88, 0, v88
    v_cvt_pk_bf16_f32 v89, 0, v89
    v_cvt_pk_bf16_f32 v90, 0, v90
    v_cvt_pk_bf16_f32 v91, 0, v91
    buffer_load_dwordx4 v225, s[28:31], s101 offen offset:1024 lds
    v_cvt_pk_bf16_f32 v92, 0, v92
    v_cvt_pk_bf16_f32 v93, 0, v93
    v_cvt_pk_bf16_f32 v94, 0, v94
    v_cvt_pk_bf16_f32 v95, 0, v95
    s_waitcnt lgkmcnt(4)
    ds_read_b128 v[168:171], v26 offset:8192
    ds_read_b128 v[172:175], v26 offset:8208
    ds_read_b128 v[176:179], v26 offset:8448
    ds_read_b128 v[180:183], v26 offset:8464
    v_mov_b32 v216, s36
    ds_read_b128 v[184:187], v26 offset:6144
    ds_read_b128 v[188:191], v26 offset:6160
    ds_read_b128 v[192:195], v26 offset:6400
    ds_read_b128 v[196:199], v26 offset:6416
    v_pk_add_f32 v[80:81], v[80:81], v[128:129]
    v_pk_add_f32 v[82:83], v[82:83], v[130:131]
    v_pk_add_f32 v[84:85], v[84:85], v[132:133]
    v_pk_add_f32 v[86:87], v[86:87], v[134:135]
    v_pk_add_f32 v[88:89], v[88:89], v[136:137]
    buffer_load_dwordx4 v226, s[28:31], s101 offen offset:2048 lds
    v_pk_add_f32 v[90:91], v[90:91], v[138:139]
    v_pk_add_f32 v[92:93], v[92:93], v[140:141]
    v_pk_add_f32 v[94:95], v[94:95], v[142:143]
    v_cvt_pk_bf16_f32 v80, 0, v80
    v_cvt_pk_bf16_f32 v81, 0, v81
    v_cvt_pk_bf16_f32 v82, 0, v82
    v_cvt_pk_bf16_f32 v83, 0, v83
    v_cvt_pk_bf16_f32 v84, 0, v84
    v_cvt_pk_bf16_f32 v85, 0, v85
    v_cvt_pk_bf16_f32 v86, 0, v86
    buffer_load_dwordx4 v227, s[28:31], s101 offen offset:3072 lds
    v_cvt_pk_bf16_f32 v87, 0, v87
    v_cvt_pk_bf16_f32 v88, 0, v88
    v_cvt_pk_bf16_f32 v89, 0, v89
    v_cvt_pk_bf16_f32 v90, 0, v90
    v_cvt_pk_bf16_f32 v91, 0, v91
    v_cvt_pk_bf16_f32 v92, 0, v92
    v_cvt_pk_bf16_f32 v93, 0, v93
    v_cvt_pk_bf16_f32 v94, 0, v94
    v_cvt_pk_bf16_f32 v95, 0, v95
    v_lshlrev_b32 v10, 4, v3
    s_mul_i32 s54, s47, 35840
    s_add_u32 s54, s54, 22020096
    v_add_u32 v1, s54, v10
    v_add_u32 v10, s97, v10
    v_mov_b32 v11, v248
    v_lshrrev_b32 v13, 5, v3
    v_bfe_u32 v14, v3, 4, 1
    v_bfe_u32 v15, v3, 2, 2
    v_and_b32 v12, 3, v3
    v_lshl_add_u32 v13, v13, 3, v15
    v_lshlrev_b32 v2, 7, v13
    v_lshl_add_u32 v2, v14, 16, v2
    v_lshl_add_u32 v2, v12, 3, v2
    v_mul_u32_u24 v6, 96, v13
    v_lshl_add_u32 v6, v12, 3, v6
    v_mul_u32_u24 v12, 65664, v14
    v_add_u32 v6, v6, v12
    v_lshrrev_b32 v15, 1, v15
    v_lshl_or_b32 v15, v14, 1, v15
    v_lshlrev_b32 v15, 5, v15
    v_xor_b32 v5, 0x60, v15
    v_xor_b32 v4, 0x40, v15
    v_xor_b32 v12, 0x20, v15
    v_add_u32 v5, v5, v2
    v_add_u32 v4, v4, v2
    v_add_u32 v247, v12, v2
    v_add_u32 v2, v15, v2

    s_add_u32 m0, s33, 57344
    s_add_u32 s101, s35, 1605632
    buffer_load_dwordx4 v224, s[28:31], s101 offen offset:0 lds
    s_mul_i32 s52, s50, 65664
    s_mul_i32 s54, s51, 6144
    s_add_u32 s52, s52, s54
    v_lshlrev_b32 v7, 4, v3
    v_add_u32 v7, s52, v7
    s_and_b32 s54, s46, 1
    s_mul_i32 s54, s54, 3072
    v_subrev_u32 v8, s54, v7
    v_add_u32 v7, s54, v7
    v_mov_b32 v13, s36
    v_and_b32 v12, 3, v3
    v_lshlrev_b32 v12, 3, v12
    v_and_b32 v9, 4, v3
    v_lshl_add_u32 v12, v9, 7, v12
    s_mov_b32 s56, 4096
    v_mov_b32 v3, v247
    s_add_u32 s55, s96, 4480
    s_waitcnt lgkmcnt(0)
    buffer_load_dwordx4 v225, s[28:31], s101 offen offset:1024 lds
    buffer_load_dwordx4 v226, s[28:31], s101 offen offset:2048 lds
    buffer_load_dwordx4 v227, s[28:31], s101 offen offset:3072 lds
    s_waitcnt vmcnt(8)
    v_max3_u32 v217, v208, v209, v210
    v_max3_u32 v217, v217, v211, v212
    v_max3_u32 v217, v217, v213, v214
    v_max_u32 v217, v217, v215
    v_cmp_eq_u32 vcc, -1, v217
    s_cbranch_vccnz LG_slow2
LG_back2:
    buffer_load_dword v200, v205, s[16:19], s61 offen sc1
    v_lshlrev_b32 v112, 16, v208
    v_and_b32 v113, s40, v208
    v_lshlrev_b32 v114, 16, v209
    v_and_b32 v115, s40, v209
    v_lshlrev_b32 v116, 16, v210
    v_and_b32 v117, s40, v210
    v_lshlrev_b32 v118, 16, v211
    v_and_b32 v119, s40, v211
    v_lshlrev_b32 v120, 16, v212
    v_and_b32 v121, s40, v212
    v_lshlrev_b32 v122, 16, v213
    v_and_b32 v123, s40, v213
    v_lshlrev_b32 v124, 16, v214
    v_and_b32 v125, s40, v214
    v_lshlrev_b32 v126, 16, v215
    v_and_b32 v127, s40, v215
    v_pk_mul_f32 v[112:113], v[112:113], v[80:81]
    v_pk_mul_f32 v[114:115], v[114:115], v[82:83]
    v_pk_mul_f32 v[116:117], v[116:117], v[84:85]
    v_pk_mul_f32 v[118:119], v[118:119], v[86:87]
    v_pk_mul_f32 v[120:121], v[120:121], v[88:89]
    v_pk_mul_f32 v[122:123], v[122:123], v[90:91]
    v_pk_mul_f32 v[124:125], v[124:125], v[92:93]
    v_pk_mul_f32 v[126:127], v[126:127], v[94:95]
    v_cvt_pk_bf16_f32 v112, 0, v112
    v_cvt_pk_bf16_f32 v113, 0, v113
    v_cvt_pk_bf16_f32 v114, 0, v114
    v_cvt_pk_bf16_f32 v115, 0, v115
    v_cvt_pk_bf16_f32 v116, 0, v116
    v_cvt_pk_bf16_f32 v117, 0, v117
    v_cvt_pk_bf16_f32 v118, 0, v118
    v_cvt_pk_bf16_f32 v119, 0, v119
    v_cvt_pk_bf16_f32 v120, 0, v120
    v_cvt_pk_bf16_f32 v121, 0, v121
    v_cvt_pk_bf16_f32 v122, 0, v122
    v_cvt_pk_bf16_f32 v123, 0, v123
    v_cvt_pk_bf16_f32 v124, 0, v124
    v_cvt_pk_bf16_f32 v125, 0, v125
    v_cvt_pk_bf16_f32 v126, 0, v126
    v_cvt_pk_bf16_f32 v127, 0, v127
    v_pk_mul_f32 v[112:113], v[112:113], v[144:145]
    v_pk_mul_f32 v[114:115], v[114:115], v[146:147]
    v_pk_mul_f32 v[116:117], v[116:117], v[148:149]
    v_pk_mul_f32 v[118:119], v[118:119], v[150:151]
    v_pk_mul_f32 v[120:121], v[120:121], v[152:153]
    v_pk_mul_f32 v[122:123], v[122:123], v[154:155]
    v_pk_mul_f32 v[124:125], v[124:125], v[156:157]
    v_pk_mul_f32 v[126:127], v[126:127], v[158:159]
    v_cvt_pk_bf16_f32 v112, 0, v112
    v_cvt_pk_bf16_f32 v113, 0, v113
    v_cvt_pk_bf16_f32 v114, 0, v114
    v_cvt_pk_bf16_f32 v115, 0, v115
    v_cvt_pk_bf16_f32 v116, 0, v116
    v_cvt_pk_bf16_f32 v117, 0, v117
    v_cvt_pk_bf16_f32 v118, 0, v118
    v_cvt_pk_bf16_f32 v119, 0, v119
    v_cvt_pk_bf16_f32 v120, 0, v120
    v_cvt_pk_bf16_f32 v121, 0, v121
    v_cvt_pk_bf16_f32 v122, 0, v122
    v_cvt_pk_bf16_f32 v123, 0, v123
    v_cvt_pk_bf16_f32 v124, 0, v124
    v_cvt_pk_bf16_f32 v125, 0, v125
    v_cvt_pk_bf16_f32 v126, 0, v126
    v_cvt_pk_bf16_f32 v127, 0, v127
    v_pk_add_f32 v[112:113], v[112:113], v[64:65]
    v_pk_add_f32 v[114:115], v[114:115], v[66:67]
    v_pk_add_f32 v[116:117], v[116:117], v[68:69]
    v_pk_add_f32 v[118:119], v[118:119], v[70:71]
    v_pk_add_f32 v[120:121], v[120:121], v[72:73]
    v_pk_add_f32 v[122:123], v[122:123], v[74:75]
    v_pk_add_f32 v[124:125], v[124:125], v[76:77]
    v_pk_add_f32 v[126:127], v[126:127], v[78:79]
    v_cvt_pk_bf16_f32 v208, v112, v113
    v_cvt_pk_bf16_f32 v209, v114, v115
    v_cvt_pk_bf16_f32 v210, v116, v117
    v_cvt_pk_bf16_f32 v211, v118, v119
    v_cvt_pk_bf16_f32 v212, v120, v121
    v_cvt_pk_bf16_f32 v213, v122, v123
    v_cvt_pk_bf16_f32 v214, v124, v125
    v_cvt_pk_bf16_f32 v215, v126, v127
    v_dot2_f32_bf16 v96, v208, s66, 0
    v_dot2_f32_bf16 v98, v208, v208, 0
    v_dot2_f32_bf16 v97, v212, s66, 0
    v_dot2_f32_bf16 v99, v212, v212, 0
    v_dot2_f32_bf16 v96, v209, s66, v96
    v_dot2_f32_bf16 v98, v209, v209, v98
    v_dot2_f32_bf16 v97, v213, s66, v97
    v_dot2_f32_bf16 v99, v213, v213, v99
    v_dot2_f32_bf16 v96, v210, s66, v96
    v_dot2_f32_bf16 v98, v210, v210, v98
    v_dot2_f32_bf16 v97, v214, s66, v97
    v_dot2_f32_bf16 v99, v214, v214, v99
    v_dot2_f32_bf16 v96, v211, s66, v96
    v_dot2_f32_bf16 v98, v211, v211, v98
    v_dot2_f32_bf16 v97, v215, s66, v97
    v_dot2_f32_bf16 v99, v215, v215, v99
    s_nop 2
    v_add_f32 v96, v96, v97
    v_add_f32 v98, v98, v99
    s_nop 1
    v_permlane32_swap_b32 v96, v98
    s_nop 0
    v_add_f32 v96, v96, v98
    v_mov_b32 v97, v96
    s_nop 1
    v_permlane16_swap_b32 v96, v97
    s_nop 0
    v_add_f32 v96, v96, v97
    s_nop 1
    v_add_f32_dpp v96, v96, v96 row_ror:8 row_mask:0xf bank_mask:0xf
    s_mov_b64 exec, s[64:65]
    ds_write_b32 v234, v96 offset:256
    s_mov_b64 exec, -1
    s_waitcnt vmcnt(0)
    v_cmp_ne_u32 vcc, s36, v200
    s_cbranch_vccnz LG_slow3
LG_back3:
    s_waitcnt lgkmcnt(0)
    s_barrier
    ds_read2_b32 v[96:97], v235 offset0:64 offset1:72
    ds_read2_b32 v[98:99], v235 offset0:80 offset1:88
    ds_read2_b32 v[100:101], v235 offset0:96 offset1:104
    ds_read2_b32 v[102:103], v235 offset0:112 offset1:120
    v_lshlrev_b32 v112, 16, v208
    v_and_b32 v113, s40, v208
    v_lshlrev_b32 v114, 16, v209
    v_and_b32 v115, s40, v209
    v_lshlrev_b32 v116, 16, v210
    v_and_b32 v117, s40, v210
    v_lshlrev_b32 v118, 16, v211
    v_and_b32 v119, s40, v211
    v_lshlrev_b32 v120, 16, v212
    v_and_b32 v121, s40, v212
    v_lshlrev_b32 v122, 16, v213
    v_and_b32 v123, s40, v213
    v_lshlrev_b32 v124, 16, v214
    v_and_b32 v125, s40, v214
    v_lshlrev_b32 v126, 16, v215
    v_and_b32 v127, s40, v215
    s_waitcnt lgkmcnt(0)
    v_pk_add_f32 v[96:97], v[96:97], v[98:99]
    v_pk_add_f32 v[100:101], v[100:101], v[102:103]
    v_pk_add_f32 v[96:97], v[96:97], v[100:101]
    v_mul_f32 v96, s68, v96
    v_mul_f32 v97, s68, v97
    v_fma_f32 v97, -v96, v96, v97
    v_max_f32 v97, 0, v97
    v_cvt_pk_bf16_f32 v97, 0, v97
    v_add_f32 v97, s69, v97
    v_cvt_pk_bf16_f32 v97, 0, v97
    v_sqrt_f32 v97, v97
    v_cvt_pk_bf16_f32 v96, 0, v96
    v_cvt_pk_bf16_f32 v97, 0, v97
    v_rcp_f32 v97, v97
    s_nop 0
    v_mul_f32 v96, -v96, v97
    v_pk_fma_f32 v[112:113], v[112:113], v[96:97], v[96:97] op_sel:[0,1,0] op_sel_hi:[1,1,0]
    v_pk_fma_f32 v[114:115], v[114:115], v[96:97], v[96:97] op_sel:[0,1,0] op_sel_hi:[1,1,0]
    v_pk_fma_f32 v[116:117], v[116:117], v[96:97], v[96:97] op_sel:[0,1,0] op_sel_hi:[1,1,0]
    v_pk_fma_f32 v[118:119], v[118:119], v[96:97], v[96:97] op_sel:[0,1,0] op_sel_hi:[1,1,0]
    v_pk_fma_f32 v[120:121], v[120:121], v[96:97], v[96:97] op_sel:[0,1,0] op_sel_hi:[1,1,0]
    v_pk_fma_f32 v[122:123], v[122:123], v[96:97], v[96:97] op_sel:[0,1,0] op_sel_hi:[1,1,0]
    v_pk_fma_f32 v[124:125], v[124:125], v[96:97], v[96:97] op_sel:[0,1,0] op_sel_hi:[1,1,0]
    v_pk_fma_f32 v[126:127], v[126:127], v[96:97], v[96:97] op_sel:[0,1,0] op_sel_hi:[1,1,0]
    v_pk_fma_f32 v[112:113], v[112:113], v[168:169], v[184:185]
    v_pk_fma_f32 v[114:115], v[114:115], v[170:171], v[186:187]
    v_pk_fma_f32 v[116:117], v[116:117], v[172:173], v[188:189]
    v_pk_fma_f32 v[118:119], v[118:119], v[174:175], v[190:191]
    v_pk_fma_f32 v[120:121], v[120:121], v[176:177], v[192:193]
    v_pk_fma_f32 v[122:123], v[122:123], v[178:179], v[194:195]
    v_pk_fma_f32 v[124:125], v[124:125], v[180:181], v[196:197]
    v_pk_fma_f32 v[126:127], v[126:127], v[182:183], v[198:199]
    v_cvt_pk_bf16_f32 v128, v112, v113
    v_cvt_pk_bf16_f32 v129, v114, v115
    v_cvt_pk_bf16_f32 v130, v116, v117
    v_cvt_pk_bf16_f32 v131, v118, v119
    v_cvt_pk_bf16_f32 v132, v120, v121
    v_cvt_pk_bf16_f32 v133, v122, v123
    v_cvt_pk_bf16_f32 v134, v124, v125
    v_cvt_pk_bf16_f32 v135, v126, v127
    buffer_store_dwordx4 v[128:131], v233, s[16:19], s96 offen sc1
    buffer_store_dwordx4 v[132:135], v233, s[16:19], s55 offen sc1
    ds_read_b64_tr_b16 a[0:1], v2 offset:0
    ds_read_b64_tr_b16 a[2:3], v2 offset:512
    ds_read_b64_tr_b16 a[4:5], v3 offset:0
    ds_read_b64_tr_b16 a[6:7], v3 offset:512
    ds_read_b64_tr_b16 a[8:9], v4 offset:0
    ds_read_b64_tr_b16 a[10:11], v4 offset:512
    ds_read_b64_tr_b16 a[12:13], v5 offset:0
    ds_read_b64_tr_b16 a[14:15], v5 offset:512
    ds_read_b64_tr_b16 a[16:17], v2 offset:2048
    ds_read_b64_tr_b16 a[18:19], v2 offset:2560
    ds_read_b64_tr_b16 a[20:21], v3 offset:2048
    ds_read_b64_tr_b16 a[22:23], v3 offset:2560
    ds_read_b64_tr_b16 a[24:25], v4 offset:2048
    ds_read_b64_tr_b16 a[26:27], v4 offset:2560
    ds_read_b64_tr_b16 a[28:29], v5 offset:2048
    s_waitcnt lgkmcnt(11)
    ds_read_b64_tr_b16 a[30:31], v5 offset:2560
    ds_read_b64_tr_b16 a[32:33], v2 offset:4096
    ds_read_b64_tr_b16 a[34:35], v2 offset:4608
    ds_read_b64_tr_b16 a[36:37], v3 offset:4096
    s_waitcnt lgkmcnt(11)
    ds_read_b64_tr_b16 a[38:39], v3 offset:4608
    ds_read_b64_tr_b16 a[40:41], v4 offset:4096
    ds_read_b64_tr_b16 a[42:43], v4 offset:4608
    ds_read_b64_tr_b16 a[44:45], v5 offset:4096
    s_waitcnt lgkmcnt(11)
    ds_read_b64_tr_b16 a[46:47], v5 offset:4608
    s_waitcnt vmcnt(0)
    s_mov_b64 exec, 1
    buffer_store_dword v216, v219, s[16:19], s99 offen sc1
    s_mov_b64 exec, -1
    s_mov_b64 exec, 65535
    buffer_load_dword v14, v250, s[16:19], s67 offen sc1
    s_mov_b64 exec, -1
    ds_read_b64_tr_b16 a[48:49], v2 offset:6144
    ds_read_b64_tr_b16 a[50:51], v2 offset:6656
    ds_read_b64_tr_b16 a[52:53], v3 offset:6144
    s_waitcnt lgkmcnt(11)
    ds_read_b64_tr_b16 a[54:55], v3 offset:6656
    ds_read_b64_tr_b16 a[56:57], v4 offset:6144
    ds_read_b64_tr_b16 a[58:59], v4 offset:6656
    ds_read_b64_tr_b16 a[60:61], v5 offset:6144
    s_waitcnt lgkmcnt(11)
    ds_read_b64_tr_b16 a[62:63], v5 offset:6656
    ds_read_b64_tr_b16 a[64:65], v2 offset:8192
    ds_read_b64_tr_b16 a[66:67], v2 offset:8704
    ds_read_b64_tr_b16 a[68:69], v3 offset:8192
    s_waitcnt lgkmcnt(11)
    ds_read_b64_tr_b16 a[70:71], v3 offset:8704
    ds_read_b64_tr_b16 a[72:73], v4 offset:8192
    ds_read_b64_tr_b16 a[74:75], v4 offset:8704
    ds_read_b64_tr_b16 a[76:77], v5 offset:8192
    s_waitcnt lgkmcnt(11)
    ds_read_b64_tr_b16 a[78:79], v5 offset:8704
    ds_read_b64_tr_b16 a[80:81], v2 offset:10240
    ds_read_b64_tr_b16 a[82:83], v2 offset:10752
    ds_read_b64_tr_b16 a[84:85], v3 offset:10240
    s_waitcnt lgkmcnt(11)
    ds_read_b64_tr_b16 a[86:87], v3 offset:10752
    ds_read_b64_tr_b16 a[88:89], v4 offset:10240
    ds_read_b64_tr_b16 a[90:91], v4 offset:10752
    ds_read_b64_tr_b16 a[92:93], v5 offset:10240
    s_waitcnt lgkmcnt(11)
    ds_read_b64_tr_b16 a[94:95], v5 offset:10752
    ds_read_b64_tr_b16 a[96:97], v2 offset:12288
    ds_read_b64_tr_b16 a[98:99], v2 offset:12800
    ds_read_b64_tr_b16 a[100:101], v3 offset:12288
    s_waitcnt lgkmcnt(11)
    ds_read_b64_tr_b16 a[102:103], v3 offset:12800
    ds_read_b64_tr_b16 a[104:105], v4 offset:12288
    ds_read_b64_tr_b16 a[106:107], v4 offset:12800
    ds_read_b64_tr_b16 a[108:109], v5 offset:12288
    s_waitcnt lgkmcnt(11)
    ds_read_b64_tr_b16 a[110:111], v5 offset:12800
    s_mov_b64 exec, 65535
    s_waitcnt vmcnt(0)
    v_cmp_ne_u32 vcc, s36, v14
    s_cbranch_vccnz LG_slow4
LG_back4:
    s_mov_b64 exec, -1
    s_mov_b32 s60, 0
    buffer_load_dwordx4 v[16:19], v1, s[16:19], s60 offen offset:0
    buffer_load_dwordx4 v[20:23], v1, s[16:19], s60 offen offset:1024
    buffer_load_dwordx4 v[24:27], v1, s[16:19], s60 offen offset:2048
    buffer_load_dwordx4 v[28:31], v1, s[16:19], s60 offen offset:3072
    s_mov_b32 s60, 4480
    buffer_load_dwordx4 v[32:35], v1, s[16:19], s60 offen offset:0
    ds_read_b64_tr_b16 a[112:113], v2 offset:14336
    ds_read_b64_tr_b16 a[114:115], v2 offset:14848
    ds_read_b64_tr_b16 a[116:117], v3 offset:14336
    s_waitcnt lgkmcnt(11)
    ds_read_b64_tr_b16 a[118:119], v3 offset:14848
    ds_read_b64_tr_b16 a[120:121], v4 offset:14336
    ds_read_b64_tr_b16 a[122:123], v4 offset:14848
    ds_read_b64_tr_b16 a[124:125], v5 offset:14336
    s_waitcnt lgkmcnt(11)
    ds_read_b64_tr_b16 a[126:127], v5 offset:14848
    ds_read_b64_tr_b16 a[128:129], v2 offset:16384
    ds_read_b64_tr_b16 a[130:131], v2 offset:16896
    ds_read_b64_tr_b16 a[132:133], v3 offset:16384
    s_waitcnt lgkmcnt(11)
    ds_read_b64_tr_b16 a[134:135], v3 offset:16896
    ds_read_b64_tr_b16 a[136:137], v4 offset:16384
    ds_read_b64_tr_b16 a[138:139], v4 offset:16896
    ds_read_b64_tr_b16 a[140:141], v5 offset:16384
    s_waitcnt lgkmcnt(11)
    ds_read_b64_tr_b16 a[142:143], v5 offset:16896
    ds_read_b64_tr_b16 a[144:145], v2 offset:18432
    ds_read_b64_tr_b16 a[146:147], v2 offset:18944
    ds_read_b64_tr_b16 a[148:149], v3 offset:18432
    s_waitcnt lgkmcnt(11)
    ds_read_b64_tr_b16 a[150:151], v3 offset:18944
    ds_read_b64_tr_b16 a[152:153], v4 offset:18432
    ds_read_b64_tr_b16 a[154:155], v4 offset:18944
    ds_read_b64_tr_b16 a[156:157], v5 offset:18432
    s_waitcnt lgkmcnt(11)
    ds_read_b64_tr_b16 a[158:159], v5 offset:18944
    s_waitcnt vmcnt(4)
    v_mfma_f32_32x32x16_bf16 v[144:159], a[0:3], v[16:19], 0
    buffer_load_dwordx4 v[36:39], v1, s[16:19], s60 offen offset:1024
    v_mfma_f32_32x32x16_bf16 v[160:175], a[4:7], v[16:19], 0
    buffer_load_dwordx4 v[40:43], v1, s[16:19], s60 offen offset:2048
    v_mfma_f32_32x32x16_bf16 v[176:191], a[8:11], v[16:19], 0
    ds_read_b64_tr_b16 a[0:1], v2 offset:20480
    ds_read_b64_tr_b16 a[2:3], v2 offset:20992
    buffer_load_dwordx4 v[44:47], v1, s[16:19], s60 offen offset:3072
    v_mfma_f32_32x32x16_bf16 v[192:207], a[12:15], v[16:19], 0
    ds_read_b64_tr_b16 a[4:5], v3 offset:20480
    s_waitcnt lgkmcnt(11)
    ds_read_b64_tr_b16 a[6:7], v3 offset:20992
    s_mov_b32 s60, 8960
    buffer_load_dwordx4 v[48:51], v1, s[16:19], s60 offen offset:0
    s_waitcnt vmcnt(7)
    v_mfma_f32_32x32x16_bf16 v[144:159], a[16:19], v[20:23], v[144:159]
    ds_read_b64_tr_b16 a[8:9], v4 offset:20480
    ds_read_b64_tr_b16 a[10:11], v4 offset:20992
    buffer_load_dwordx4 v[52:55], v1, s[16:19], s60 offen offset:1024
    v_mfma_f32_32x32x16_bf16 v[160:175], a[20:23], v[20:23], v[160:175]
    ds_read_b64_tr_b16 a[12:13], v5 offset:20480
    s_waitcnt lgkmcnt(11)
    ds_read_b64_tr_b16 a[14:15], v5 offset:20992
    buffer_load_dwordx4 v[56:59], v1, s[16:19], s60 offen offset:2048
    v_mfma_f32_32x32x16_bf16 v[176:191], a[24:27], v[20:23], v[176:191]
    ds_read_b64_tr_b16 a[16:17], v2 offset:22528
    ds_read_b64_tr_b16 a[18:19], v2 offset:23040
    buffer_load_dwordx4 v[60:63], v1, s[16:19], s60 offen offset:3072
    v_mfma_f32_32x32x16_bf16 v[192:207], a[28:31], v[20:23], v[192:207]
    ds_read_b64_tr_b16 a[20:21], v3 offset:22528
    s_waitcnt lgkmcnt(11)
    ds_read_b64_tr_b16 a[22:23], v3 offset:23040
    s_mov_b32 s60, 13440
    buffer_load_dwordx4 v[64:67], v1, s[16:19], s60 offen offset:0
    s_waitcnt vmcnt(10)
    v_mfma_f32_32x32x16_bf16 v[144:159], a[32:35], v[24:27], v[144:159]
    ds_read_b64_tr_b16 a[24:25], v4 offset:22528
    ds_read_b64_tr_b16 a[26:27], v4 offset:23040
    buffer_load_dwordx4 v[68:71], v1, s[16:19], s60 offen offset:1024
    v_mfma_f32_32x32x16_bf16 v[160:175], a[36:39], v[24:27], v[160:175]
    ds_read_b64_tr_b16 a[28:29], v5 offset:22528
    s_waitcnt lgkmcnt(11)
    ds_read_b64_tr_b16 a[30:31], v5 offset:23040
    buffer_load_dwordx4 v[72:75], v1, s[16:19], s60 offen offset:2048
    v_mfma_f32_32x32x16_bf16 v[176:191], a[40:43], v[24:27], v[176:191]
    ds_read_b64_tr_b16 a[32:33], v2 offset:24576
    ds_read_b64_tr_b16 a[34:35], v2 offset:25088
    s_mov_b32 s57, 0
    buffer_load_dwordx4 a[160:163], v238, s[16:19], s57 offen offset:0
    v_mfma_f32_32x32x16_bf16 v[192:207], a[44:47], v[24:27], v[192:207]
    ds_read_b64_tr_b16 a[36:37], v3 offset:24576
    s_waitcnt lgkmcnt(11)
    ds_read_b64_tr_b16 a[38:39], v3 offset:25088
    buffer_load_dwordx4 v[76:79], v1, s[16:19], s60 offen offset:3072
    s_waitcnt vmcnt(13)
    v_mfma_f32_32x32x16_bf16 v[144:159], a[48:51], v[28:31], v[144:159]
    ds_read_b64_tr_b16 a[40:41], v4 offset:24576
    ds_read_b64_tr_b16 a[42:43], v4 offset:25088
    buffer_load_dwordx4 a[164:167], v238, s[16:19], s57 offen offset:1024
    v_mfma_f32_32x32x16_bf16 v[160:175], a[52:55], v[28:31], v[160:175]
    ds_read_b64_tr_b16 a[44:45], v5 offset:24576
    s_waitcnt lgkmcnt(11)
    ds_read_b64_tr_b16 a[46:47], v5 offset:25088
    v_mfma_f32_32x32x16_bf16 v[176:191], a[56:59], v[28:31], v[176:191]
    ds_read_b64_tr_b16 a[48:49], v2 offset:26624
    ds_read_b64_tr_b16 a[50:51], v2 offset:27136
    buffer_load_dwordx4 a[168:171], v238, s[16:19], s57 offen offset:2048
    v_mfma_f32_32x32x16_bf16 v[192:207], a[60:63], v[28:31], v[192:207]
    ds_read_b64_tr_b16 a[52:53], v3 offset:26624
    s_waitcnt lgkmcnt(11)
    ds_read_b64_tr_b16 a[54:55], v3 offset:27136
    s_mov_b32 s60, 17920
    buffer_load_dwordx4 v[80:83], v1, s[16:19], s60 offen offset:0
    s_waitcnt vmcnt(15)
    v_mfma_f32_32x32x16_bf16 v[144:159], a[64:67], v[32:35], v[144:159]
    ds_read_b64_tr_b16 a[56:57], v4 offset:26624
    ds_read_b64_tr_b16 a[58:59], v4 offset:27136
    buffer_load_dwordx4 v[84:87], v1, s[16:19], s60 offen offset:1024
    v_mfma_f32_32x32x16_bf16 v[160:175], a[68:71], v[32:35], v[160:175]
    ds_read_b64_tr_b16 a[60:61], v5 offset:26624
    s_waitcnt lgkmcnt(11)
    ds_read_b64_tr_b16 a[62:63], v5 offset:27136
    s_mov_b32 s57, 12288
    buffer_load_dwordx4 a[184:187], v238, s[16:19], s57 offen offset:0
    v_mfma_f32_32x32x16_bf16 v[176:191], a[72:75], v[32:35], v[176:191]
    ds_read_b64_tr_b16 a[64:65], v2 offset:28672
    ds_read_b64_tr_b16 a[66:67], v2 offset:29184
    buffer_load_dwordx4 v[88:91], v1, s[16:19], s60 offen offset:2048
    v_mfma_f32_32x32x16_bf16 v[192:207], a[76:79], v[32:35], v[192:207]
    ds_read_b64_tr_b16 a[68:69], v3 offset:28672
    s_waitcnt lgkmcnt(11)
    ds_read_b64_tr_b16 a[70:71], v3 offset:29184
    s_waitcnt vmcnt(17)
    v_mfma_f32_32x32x16_bf16 v[144:159], a[80:83], v[36:39], v[144:159]
    ds_read_b64_tr_b16 a[72:73], v4 offset:28672
    ds_read_b64_tr_b16 a[74:75], v4 offset:29184
    buffer_load_dwordx4 a[188:191], v238, s[16:19], s57 offen offset:1024
    v_mfma_f32_32x32x16_bf16 v[160:175], a[84:87], v[36:39], v[160:175]
    ds_read_b64_tr_b16 a[76:77], v5 offset:28672
    s_waitcnt lgkmcnt(11)
    ds_read_b64_tr_b16 a[78:79], v5 offset:29184
    buffer_load_dwordx4 v[92:95], v1, s[16:19], s60 offen offset:3072
    v_mfma_f32_32x32x16_bf16 v[176:191], a[88:91], v[36:39], v[176:191]
    ds_read_b64_tr_b16 a[80:81], v2 offset:30720
    ds_read_b64_tr_b16 a[82:83], v2 offset:31232
    s_mov_b32 s60, 22400
    buffer_load_dwordx4 v[96:99], v1, s[16:19], s60 offen offset:0
    v_mfma_f32_32x32x16_bf16 v[192:207], a[92:95], v[36:39], v[192:207]
    ds_read_b64_tr_b16 a[84:85], v3 offset:30720
    s_waitcnt lgkmcnt(11)
    ds_read_b64_tr_b16 a[86:87], v3 offset:31232
    buffer_load_dwordx4 a[192:195], v238, s[16:19], s57 offen offset:2048
    s_waitcnt vmcnt(20)
    v_mfma_f32_32x32x16_bf16 v[144:159], a[96:99], v[40:43], v[144:159]
    ds_read_b64_tr_b16 a[88:89], v4 offset:30720
    ds_read_b64_tr_b16 a[90:91], v4 offset:31232
    buffer_load_dwordx4 v[100:103], v1, s[16:19], s60 offen offset:1024
    v_mfma_f32_32x32x16_bf16 v[160:175], a[100:103], v[40:43], v[160:175]
    ds_read_b64_tr_b16 a[92:93], v5 offset:30720
    s_waitcnt lgkmcnt(11)
    ds_read_b64_tr_b16 a[94:95], v5 offset:31232
    v_mfma_f32_32x32x16_bf16 v[176:191], a[104:107], v[40:43], v[176:191]
    ds_read_b64_tr_b16 a[96:97], v2 offset:32768
    ds_read_b64_tr_b16 a[98:99], v2 offset:33280
    s_mov_b32 s57, 0
    buffer_load_dwordx4 a[172:175], v239, s[16:19], s57 offen offset:0
    v_mfma_f32_32x32x16_bf16 v[192:207], a[108:111], v[40:43], v[192:207]
    ds_read_b64_tr_b16 a[100:101], v3 offset:32768
    s_waitcnt lgkmcnt(11)
    ds_read_b64_tr_b16 a[102:103], v3 offset:33280
    buffer_load_dwordx4 v[104:107], v1, s[16:19], s60 offen offset:2048
    s_waitcnt vmcnt(22)
    v_mfma_f32_32x32x16_bf16 v[144:159], a[112:115], v[44:47], v[144:159]
    ds_read_b64_tr_b16 a[104:105], v2 offset:34816
    ds_read_b64_tr_b16 a[106:107], v2 offset:35328
    buffer_load_dwordx4 v[108:111], v1, s[16:19], s60 offen offset:3072
    v_mfma_f32_32x32x16_bf16 v[160:175], a[116:119], v[44:47], v[160:175]
    ds_read_b64_tr_b16 a[108:109], v3 offset:34816
    s_waitcnt lgkmcnt(11)
    ds_read_b64_tr_b16 a[110:111], v3 offset:35328
    buffer_load_dwordx4 a[176:179], v239, s[16:19], s57 offen offset:1024
    v_mfma_f32_32x32x16_bf16 v[176:191], a[120:123], v[44:47], v[176:191]
    ds_read_b64_tr_b16 a[112:113], v2 offset:36864
    ds_read_b64_tr_b16 a[114:115], v2 offset:37376
    s_mov_b32 s60, 26880
    buffer_load_dwordx4 v[112:115], v1, s[16:19], s60 offen offset:0
    v_mfma_f32_32x32x16_bf16 v[192:207], a[124:127], v[44:47], v[192:207]
    ds_read_b64_tr_b16 a[116:117], v3 offset:36864
    s_waitcnt lgkmcnt(11)
    ds_read_b64_tr_b16 a[118:119], v3 offset:37376
    s_waitcnt vmcnt(24)
    v_mfma_f32_32x32x16_bf16 v[144:159], a[128:131], v[48:51], v[144:159]
    ds_read_b64_tr_b16 a[120:121], v2 offset:38912
    ds_read_b64_tr_b16 a[122:123], v2 offset:39424
    buffer_load_dwordx4 a[180:183], v239, s[16:19], s57 offen offset:2048
    v_mfma_f32_32x32x16_bf16 v[160:175], a[132:135], v[48:51], v[160:175]
    ds_read_b64_tr_b16 a[124:125], v3 offset:38912
    s_waitcnt lgkmcnt(11)
    ds_read_b64_tr_b16 a[126:127], v3 offset:39424
    buffer_load_dwordx4 v[116:119], v1, s[16:19], s60 offen offset:1024
    v_mfma_f32_32x32x16_bf16 v[176:191], a[136:139], v[48:51], v[176:191]
    ds_read_b64_tr_b16 a[128:129], v2 offset:40960
    ds_read_b64_tr_b16 a[130:131], v2 offset:41472
    buffer_load_dwordx4 v[120:123], v1, s[16:19], s60 offen offset:2048
    v_mfma_f32_32x32x16_bf16 v[192:207], a[140:143], v[48:51], v[192:207]
    ds_read_b64_tr_b16 a[132:133], v3 offset:40960
    s_waitcnt lgkmcnt(11)
    ds_read_b64_tr_b16 a[134:135], v3 offset:41472
    s_waitcnt vmcnt(26)
    v_mfma_f32_32x32x16_bf16 v[144:159], a[144:147], v[52:55], v[144:159]
    ds_read_b64_tr_b16 a[136:137], v2 offset:43008
    ds_read_b64_tr_b16 a[138:139], v2 offset:43520
    s_mov_b32 s57, 12288
    buffer_load_dwordx4 a[196:199], v239, s[16:19], s57 offen offset:0
    v_mfma_f32_32x32x16_bf16 v[160:175], a[148:151], v[52:55], v[160:175]
    ds_read_b64_tr_b16 a[140:141], v3 offset:43008
    s_waitcnt lgkmcnt(11)
    ds_read_b64_tr_b16 a[142:143], v3 offset:43520
    buffer_load_dwordx4 v[124:127], v1, s[16:19], s60 offen offset:3072
    v_mfma_f32_32x32x16_bf16 v[176:191], a[152:155], v[52:55], v[176:191]
    ds_read_b64_tr_b16 a[144:145], v2 offset:45056
    ds_read_b64_tr_b16 a[146:147], v2 offset:45568
    s_mov_b32 s60, 31360
    buffer_load_dwordx4 v[128:131], v1, s[16:19], s60 offen offset:0
    v_mfma_f32_32x32x16_bf16 v[192:207], a[156:159], v[52:55], v[192:207]
    ds_read_b64_tr_b16 a[148:149], v3 offset:45056
    s_waitcnt lgkmcnt(11)
    ds_read_b64_tr_b16 a[150:151], v3 offset:45568
    buffer_load_dwordx4 a[200:203], v239, s[16:19], s57 offen offset:1024
    s_waitcnt vmcnt(29)
    v_mfma_f32_32x32x16_bf16 v[144:159], a[0:3], v[56:59], v[144:159]
    ds_read_b64_tr_b16 a[152:153], v2 offset:47104
    ds_read_b64_tr_b16 a[154:155], v2 offset:47616
    buffer_load_dwordx4 v[132:135], v1, s[16:19], s60 offen offset:1024
    v_mfma_f32_32x32x16_bf16 v[160:175], a[4:7], v[56:59], v[160:175]
    ds_read_b64_tr_b16 a[156:157], v3 offset:47104
    s_waitcnt lgkmcnt(11)
    ds_read_b64_tr_b16 a[158:159], v3 offset:47616
    v_mfma_f32_32x32x16_bf16 v[176:191], a[8:11], v[56:59], v[176:191]
    ds_read_b64_tr_b16 a[0:1], v2 offset:49152
    ds_read_b64_tr_b16 a[2:3], v2 offset:49664
    buffer_load_dwordx4 a[204:207], v239, s[16:19], s57 offen offset:2048
    v_mfma_f32_32x32x16_bf16 v[192:207], a[12:15], v[56:59], v[192:207]
    ds_read_b64_tr_b16 a[4:5], v3 offset:49152
    s_waitcnt lgkmcnt(11)
    ds_read_b64_tr_b16 a[6:7], v3 offset:49664
    buffer_load_dwordx4 v[136:139], v1, s[16:19], s60 offen offset:2048
    s_waitcnt vmcnt(31)
    v_mfma_f32_32x32x16_bf16 v[144:159], a[16:19], v[60:63], v[144:159]
    ds_read_b64_tr_b16 a[8:9], v2 offset:51200
    ds_read_b64_tr_b16 a[10:11], v2 offset:51712
    buffer_load_dwordx4 v[140:143], v1, s[16:19], s60 offen offset:3072
    v_mfma_f32_32x32x16_bf16 v[160:175], a[20:23], v[60:63], v[160:175]
    ds_read_b64_tr_b16 a[12:13], v3 offset:51200
    s_waitcnt lgkmcnt(11)
    ds_read_b64_tr_b16 a[14:15], v3 offset:51712
    v_mfma_f32_32x32x16_bf16 v[176:191], a[24:27], v[60:63], v[176:191]
    ds_read_b64_tr_b16 a[16:17], v2 offset:53248
    ds_read_b64_tr_b16 a[18:19], v2 offset:53760
    v_mfma_f32_32x32x16_bf16 v[192:207], a[28:31], v[60:63], v[192:207]
    ds_read_b64_tr_b16 a[20:21], v3 offset:53248
    s_waitcnt lgkmcnt(11)
    ds_read_b64_tr_b16 a[22:23], v3 offset:53760
    s_waitcnt vmcnt(31)
    v_mfma_f32_32x32x16_bf16 v[144:159], a[32:35], v[64:67], v[144:159]
    ds_read_b64_tr_b16 a[24:25], v2 offset:55296
    ds_read_b64_tr_b16 a[26:27], v2 offset:55808
    v_mfma_f32_32x32x16_bf16 v[160:175], a[36:39], v[64:67], v[160:175]
    ds_read_b64_tr_b16 a[28:29], v3 offset:55296
    s_waitcnt lgkmcnt(11)
    ds_read_b64_tr_b16 a[30:31], v3 offset:55808
    v_mfma_f32_32x32x16_bf16 v[176:191], a[40:43], v[64:67], v[176:191]
    ds_read_b64_tr_b16 a[32:33], v2 offset:57344
    ds_read_b64_tr_b16 a[34:35], v2 offset:57856
    v_mfma_f32_32x32x16_bf16 v[192:207], a[44:47], v[64:67], v[192:207]
    ds_read_b64_tr_b16 a[36:37], v3 offset:57344
    s_waitcnt lgkmcnt(11)
    ds_read_b64_tr_b16 a[38:39], v3 offset:57856
    s_mov_b32 s57, 24576
    buffer_load_dwordx4 a[208:211], v238, s[16:19], s57 offen offset:0
    s_waitcnt vmcnt(31)
    v_mfma_f32_32x32x16_bf16 v[144:159], a[48:51], v[68:71], v[144:159]
    ds_read_b64_tr_b16 a[40:41], v2 offset:59392
    ds_read_b64_tr_b16 a[42:43], v2 offset:59904
    v_mfma_f32_32x32x16_bf16 v[160:175], a[52:55], v[68:71], v[160:175]
    ds_read_b64_tr_b16 a[44:45], v3 offset:59392
    s_waitcnt lgkmcnt(11)
    ds_read_b64_tr_b16 a[46:47], v3 offset:59904
    v_mfma_f32_32x32x16_bf16 v[176:191], a[56:59], v[68:71], v[176:191]
    ds_read_b64_tr_b16 a[48:49], v2 offset:61440
    ds_read_b64_tr_b16 a[50:51], v2 offset:61952
    buffer_load_dwordx4 a[212:215], v238, s[16:19], s57 offen offset:1024
    v_mfma_f32_32x32x16_bf16 v[192:207], a[60:63], v[68:71], v[192:207]
    ds_read_b64_tr_b16 a[52:53], v3 offset:61440
    s_waitcnt lgkmcnt(11)
    ds_read_b64_tr_b16 a[54:55], v3 offset:61952
    s_waitcnt vmcnt(31)
    v_mfma_f32_32x32x16_bf16 v[144:159], a[64:67], v[72:75], v[144:159]
    ds_read_b64_tr_b16 a[56:57], v2 offset:63488
    ds_read_b64_tr_b16 a[58:59], v2 offset:64000
    v_mfma_f32_32x32x16_bf16 v[160:175], a[68:71], v[72:75], v[160:175]
    ds_read_b64_tr_b16 a[60:61], v3 offset:63488
    s_waitcnt lgkmcnt(11)
    ds_read_b64_tr_b16 a[62:63], v3 offset:64000
    buffer_load_dwordx4 a[216:219], v238, s[16:19], s57 offen offset:2048
    v_mfma_f32_32x32x16_bf16 v[176:191], a[72:75], v[72:75], v[176:191]
    ds_read_b64_tr_b16 a[64:65], v4 offset:32768
    ds_read_b64_tr_b16 a[66:67], v4 offset:33280
    v_mfma_f32_32x32x16_bf16 v[192:207], a[76:79], v[72:75], v[192:207]
    ds_read_b64_tr_b16 a[68:69], v5 offset:32768
    s_waitcnt lgkmcnt(11)
    ds_read_b64_tr_b16 a[70:71], v5 offset:33280
    s_mov_b32 s57, 36864
    buffer_load_dwordx4 a[232:235], v238, s[16:19], s57 offen offset:0
    s_waitcnt vmcnt(31)
    v_mfma_f32_32x32x16_bf16 v[144:159], a[80:83], v[76:79], v[144:159]
    ds_read_b64_tr_b16 a[72:73], v4 offset:34816
    ds_read_b64_tr_b16 a[74:75], v4 offset:35328
    v_mfma_f32_32x32x16_bf16 v[160:175], a[84:87], v[76:79], v[160:175]
    ds_read_b64_tr_b16 a[76:77], v5 offset:34816
    s_waitcnt lgkmcnt(11)
    ds_read_b64_tr_b16 a[78:79], v5 offset:35328
    buffer_load_dwordx4 a[236:239], v238, s[16:19], s57 offen offset:1024
    v_mfma_f32_32x32x16_bf16 v[176:191], a[88:91], v[76:79], v[176:191]
    s_barrier
    s_waitcnt vmcnt(15)
    ds_write_b128 v7, a[160:163] offset:0
    v_mfma_f32_32x32x16_bf16 v[192:207], a[92:95], v[76:79], v[192:207]
    buffer_load_dwordx4 a[240:243], v238, s[16:19], s57 offen offset:2048
    v_mfma_f32_32x32x16_bf16 v[144:159], a[96:99], v[80:83], v[144:159]
    ds_write_b128 v7, a[164:167] offset:1024
    s_add_u32 s3, s20, 0
    buffer_load_dwordx4 a[80:83], v11, s[16:19], s3 offen offset:0
    v_mfma_f32_32x32x16_bf16 v[160:175], a[100:103], v[80:83], v[160:175]
    v_mfma_f32_32x32x16_bf16 v[144:159], a[104:107], v[84:87], v[144:159]
    ds_write_b128 v7, a[168:171] offset:2048
    v_mfma_f32_32x32x16_bf16 v[160:175], a[108:111], v[84:87], v[160:175]
    s_mov_b32 s57, 24576
    buffer_load_dwordx4 a[220:223], v239, s[16:19], s57 offen offset:0
    v_mfma_f32_32x32x16_bf16 v[144:159], a[112:115], v[88:91], v[144:159]
    s_waitcnt lgkmcnt(11)
    ds_write_b128 v8, a[172:175] offset:3072
    v_mfma_f32_32x32x16_bf16 v[160:175], a[116:119], v[88:91], v[160:175]
    buffer_load_dwordx4 a[224:227], v239, s[16:19], s57 offen offset:1024
    v_mfma_f32_32x32x16_bf16 v[144:159], a[120:123], v[92:95], v[144:159]
    ds_write_b128 v8, a[176:179] offset:4096
    buffer_load_dwordx4 a[84:87], v11, s[16:19], s3 offen offset:1024
    v_mfma_f32_32x32x16_bf16 v[160:175], a[124:127], v[92:95], v[160:175]
    v_mfma_f32_32x32x16_bf16 v[144:159], a[128:131], v[96:99], v[144:159]
    ds_write_b128 v8, a[180:183] offset:5120
    v_mfma_f32_32x32x16_bf16 v[160:175], a[132:135], v[96:99], v[160:175]
    buffer_load_dwordx4 a[228:231], v239, s[16:19], s57 offen offset:2048
    v_mfma_f32_32x32x16_bf16 v[144:159], a[136:139], v[100:103], v[144:159]
    ds_read_b64_tr_b16 a[88:89], v4 offset:36864
    s_waitcnt lgkmcnt(11)
    ds_read_b64_tr_b16 a[90:91], v4 offset:37376
    v_mfma_f32_32x32x16_bf16 v[160:175], a[140:143], v[100:103], v[160:175]
    ds_read_b64_tr_b16 a[92:93], v5 offset:36864
    ds_read_b64_tr_b16 a[94:95], v5 offset:37376
    s_mov_b32 s57, 36864
    buffer_load_dwordx4 a[244:247], v239, s[16:19], s57 offen offset:0
    v_mfma_f32_32x32x16_bf16 v[144:159], a[144:147], v[104:107], v[144:159]
    ds_read_b64_tr_b16 a[96:97], v4 offset:38912
    s_waitcnt lgkmcnt(11)
    ds_read_b64_tr_b16 a[98:99], v4 offset:39424
    buffer_load_dwordx4 a[100:103], v11, s[16:19], s3 offen offset:2048
    v_mfma_f32_32x32x16_bf16 v[160:175], a[148:151], v[104:107], v[160:175]
    s_waitcnt lgkmcnt(6)
    s_barrier
    v_mfma_f32_32x32x16_bf16 v[144:159], a[152:155], v[108:111], v[144:159]
    s_waitcnt vmcnt(15)
    ds_write_b128 v7, a[184:187] offset:16384
    v_mfma_f32_32x32x16_bf16 v[160:175], a[156:159], v[108:111], v[160:175]
    buffer_load_dwordx4 a[248:251], v239, s[16:19], s57 offen offset:1024
    v_mfma_f32_32x32x16_bf16 v[144:159], a[0:3], v[112:115], v[144:159]
    ds_write_b128 v7, a[188:191] offset:17408
    v_mfma_f32_32x32x16_bf16 v[160:175], a[4:7], v[112:115], v[160:175]
    buffer_load_dwordx4 a[252:255], v239, s[16:19], s57 offen offset:2048
    v_mfma_f32_32x32x16_bf16 v[144:159], a[8:11], v[116:119], v[144:159]
    ds_write_b128 v7, a[192:195] offset:18432
    buffer_load_dwordx4 a[104:107], v11, s[16:19], s3 offen offset:3072
    v_mfma_f32_32x32x16_bf16 v[160:175], a[12:15], v[116:119], v[160:175]
    v_mfma_f32_32x32x16_bf16 v[144:159], a[16:19], v[120:123], v[144:159]
    ds_write_b128 v8, a[196:199] offset:19456
    v_mfma_f32_32x32x16_bf16 v[160:175], a[20:23], v[120:123], v[160:175]
    buffer_store_dword v208, v232, s[16:19], s98 offen offset:0 sc1
    v_mfma_f32_32x32x16_bf16 v[144:159], a[24:27], v[124:127], v[144:159]
    ds_write_b128 v8, a[200:203] offset:20480
    v_mfma_f32_32x32x16_bf16 v[160:175], a[28:31], v[124:127], v[160:175]
    buffer_store_dword v209, v232, s[16:19], s98 offen offset:128 sc1
    v_mfma_f32_32x32x16_bf16 v[144:159], a[32:35], v[128:131], v[144:159]
    ds_write_b128 v8, a[204:207] offset:21504
    s_add_u32 s3, s20, 4096
    buffer_load_dwordx4 a[108:111], v11, s[16:19], s3 offen offset:0
    v_mfma_f32_32x32x16_bf16 v[160:175], a[36:39], v[128:131], v[160:175]
    v_mfma_f32_32x32x16_bf16 v[144:159], a[40:43], v[132:135], v[144:159]
    ds_read_b64_tr_b16 a[112:113], v5 offset:38912
    ds_read_b64_tr_b16 a[114:115], v5 offset:39424
    v_mfma_f32_32x32x16_bf16 v[160:175], a[44:47], v[132:135], v[160:175]
    ds_read_b64_tr_b16 a[116:117], v4 offset:40960
    s_waitcnt lgkmcnt(11)
    ds_read_b64_tr_b16 a[118:119], v4 offset:41472
    buffer_store_dword v210, v232, s[16:19], s98 offen offset:256 sc1
    s_waitcnt vmcnt(21)
    v_mfma_f32_32x32x16_bf16 v[144:159], a[48:51], v[136:139], v[144:159]
    ds_read_b64_tr_b16 a[120:121], v5 offset:40960
    ds_read_b64_tr_b16 a[122:123], v5 offset:41472
    v_mfma_f32_32x32x16_bf16 v[160:175], a[52:55], v[136:139], v[160:175]
    ds_read_b64_tr_b16 a[124:125], v4 offset:43008
    s_waitcnt lgkmcnt(11)
    ds_read_b64_tr_b16 a[126:127], v4 offset:43520
    buffer_store_dword v211, v232, s[16:19], s98 offen offset:384 sc1
    s_waitcnt vmcnt(21)
    v_mfma_f32_32x32x16_bf16 v[144:159], a[56:59], v[140:143], v[144:159]
    ds_read_b64_tr_b16 a[128:129], v5 offset:43008
    ds_read_b64_tr_b16 a[130:131], v5 offset:43520
    buffer_load_dwordx4 a[132:135], v11, s[16:19], s3 offen offset:1024
    v_mfma_f32_32x32x16_bf16 v[160:175], a[60:63], v[140:143], v[160:175]
    ds_read_b64_tr_b16 a[136:137], v4 offset:45056
    s_waitcnt lgkmcnt(11)
    ds_read_b64_tr_b16 a[138:139], v4 offset:45568
    v_mfma_f32_32x32x16_bf16 v[176:191], a[64:67], v[80:83], v[176:191]
    ds_read_b64_tr_b16 a[140:141], v5 offset:45056
    ds_read_b64_tr_b16 a[142:143], v5 offset:45568
    v_and_b32 v2, 63, v0
    v_lshlrev_b32 v9, 7, v2
    v_add_u32 v9, s97, v9
    v_lshlrev_b32 v2, 4, v2
    v_mfma_f32_32x32x16_bf16 v[192:207], a[68:71], v[80:83], v[192:207]
    ds_read_b64_tr_b16 a[144:145], v4 offset:47104
    s_waitcnt lgkmcnt(11)
    ds_read_b64_tr_b16 a[146:147], v4 offset:47616
    v_max_f32 v144, 0, v144
    v_max_f32 v145, 0, v145
    v_max_f32 v146, 0, v146
    v_mfma_f32_32x32x16_bf16 v[176:191], a[72:75], v[84:87], v[176:191]
    ds_read_b64_tr_b16 a[160:161], v5 offset:47104
    ds_read_b64_tr_b16 a[162:163], v5 offset:47616
    v_max_f32 v147, 0, v147
    v_max_f32 v148, 0, v148
    v_max_f32 v149, 0, v149
    v_max_f32 v150, 0, v150
    v_mfma_f32_32x32x16_bf16 v[192:207], a[76:79], v[84:87], v[192:207]
    ds_read_b64_tr_b16 a[164:165], v4 offset:49152
    s_waitcnt lgkmcnt(11)
    ds_read_b64_tr_b16 a[166:167], v4 offset:49664
    v_max_f32 v151, 0, v151
    v_pk_mul_f32 v[144:145], v[144:145], v[152:153]
    v_pk_mul_f32 v[146:147], v[146:147], v[154:155]
    v_mfma_f32_32x32x16_bf16 v[176:191], a[88:91], v[88:91], v[176:191]
    ds_read_b64_tr_b16 a[168:169], v5 offset:49152
    ds_read_b64_tr_b16 a[170:171], v5 offset:49664
    v_pk_mul_f32 v[148:149], v[148:149], v[156:157]
    v_pk_mul_f32 v[150:151], v[150:151], v[158:159]
    v_cvt_pk_bf16_f32 v152, v144, v145
    v_cvt_pk_bf16_f32 v153, v146, v147
    buffer_store_dword v212, v232, s[16:19], s58 offen offset:0 sc1
    v_mfma_f32_32x32x16_bf16 v[192:207], a[92:95], v[88:91], v[192:207]
    ds_read_b64_tr_b16 a[172:173], v4 offset:51200
    s_waitcnt lgkmcnt(11)
    ds_read_b64_tr_b16 a[174:175], v4 offset:51712
    v_cvt_pk_bf16_f32 v154, v148, v149
    v_cvt_pk_bf16_f32 v155, v150, v151
    buffer_store_dwordx4 v[152:155], v10, s[16:19], 0 offen offset:0 sc1
    buffer_store_dword v213, v232, s[16:19], s58 offen offset:128 sc1
    v_mfma_f32_32x32x16_bf16 v[176:191], a[96:99], v[92:95], v[176:191]
    ds_read_b64_tr_b16 a[176:177], v5 offset:51200
    ds_read_b64_tr_b16 a[178:179], v5 offset:51712
    v_max_f32 v160, 0, v160
    v_max_f32 v161, 0, v161
    v_max_f32 v162, 0, v162
    v_max_f32 v163, 0, v163
    buffer_store_dword v214, v232, s[16:19], s58 offen offset:256 sc1
    v_mfma_f32_32x32x16_bf16 v[192:207], a[112:115], v[92:95], v[192:207]
    ds_read_b64_tr_b16 a[180:181], v4 offset:53248
    s_waitcnt lgkmcnt(11)
    ds_read_b64_tr_b16 a[182:183], v4 offset:53760
    v_max_f32 v164, 0, v164
    v_max_f32 v165, 0, v165
    v_max_f32 v166, 0, v166
    buffer_store_dword v215, v232, s[16:19], s58 offen offset:384 sc1
    v_mfma_f32_32x32x16_bf16 v[176:191], a[116:119], v[96:99], v[176:191]
    ds_read_b64_tr_b16 a[148:149], v5 offset:53248
    ds_read_b64_tr_b16 a[150:151], v5 offset:53760
    v_max_f32 v167, 0, v167
    v_pk_mul_f32 v[160:161], v[160:161], v[168:169]
    v_pk_mul_f32 v[162:163], v[162:163], v[170:171]
    v_pk_mul_f32 v[164:165], v[164:165], v[172:173]
    v_mfma_f32_32x32x16_bf16 v[192:207], a[120:123], v[96:99], v[192:207]
    s_waitcnt lgkmcnt(12)
    s_barrier
    s_waitcnt vmcnt(16)
    ds_write_b128 v7, a[208:211] offset:32768
    v_pk_mul_f32 v[166:167], v[166:167], v[174:175]
    v_cvt_pk_bf16_f32 v168, v160, v161
    v_mfma_f32_32x32x16_bf16 v[176:191], a[124:127], v[100:103], v[176:191]
    v_cvt_pk_bf16_f32 v169, v162, v163
    v_cvt_pk_bf16_f32 v170, v164, v165
    v_cvt_pk_bf16_f32 v171, v166, v167
    buffer_store_dwordx4 v[168:171], v10, s[16:19], 0 offen offset:1024 sc1
    buffer_load_dwordx4 a[152:155], v11, s[16:19], s3 offen offset:2048
    v_add_u32 v2, s73, v2
    v_mfma_f32_32x32x16_bf16 v[192:207], a[128:131], v[100:103], v[192:207]
    ds_write_b128 v7, a[212:215] offset:33792
    v_add_u32 v3, 114688, v2
    s_lshr_b32 s32, s45, 1
    s_mul_i32 s32, s32, 4480
    s_and_b32 s33, s45, 1
    s_lshl_b32 s33, s33, 11
    v_mfma_f32_32x32x16_bf16 v[176:191], a[136:139], v[104:107], v[176:191]
    s_add_u32 s32, s32, s33
    s_andn2_b32 s33, s75, 512
    s_mul_i32 s34, s24, 10
    s_lshr_b32 s34, s34, 16
    s_lshr_b32 s35, s34, 1
    s_mul_i32 s35, s35, 4480
    v_mfma_f32_32x32x16_bf16 v[192:207], a[140:143], v[104:107], v[192:207]
    ds_read_b64_tr_b16 a[156:157], v4 offset:55296
    s_waitcnt lgkmcnt(11)
    ds_read_b64_tr_b16 a[158:159], v4 offset:55808
    s_and_b32 s34, s34, 1
    s_lshl_b32 s34, s34, 11
    s_add_u32 s4, s34, s35
    v_mfma_f32_32x32x16_bf16 v[176:191], a[144:147], v[108:111], v[176:191]
    s_mul_i32 s34, s25, 10
    s_lshr_b32 s34, s34, 16
    s_lshr_b32 s35, s34, 1
    s_mul_i32 s35, s35, 4480
    s_and_b32 s34, s34, 1
    s_lshl_b32 s34, s34, 11
    v_mfma_f32_32x32x16_bf16 v[192:207], a[160:163], v[108:111], v[192:207]
    ds_read_b64_tr_b16 a[0:1], v5 offset:55296
    ds_read_b64_tr_b16 a[2:3], v5 offset:55808
    s_add_u32 s3, s21, 0
    buffer_load_dwordx4 a[4:7], v11, s[16:19], s3 offen offset:0
    s_add_u32 s5, s34, s35
    s_mul_i32 s34, s26, 10
    v_mfma_f32_32x32x16_bf16 v[176:191], a[164:167], v[112:115], v[176:191]
    ds_read_b64_tr_b16 a[8:9], v4 offset:57344
    s_waitcnt lgkmcnt(11)
    ds_read_b64_tr_b16 a[10:11], v4 offset:57856
    s_add_u32 s3, s20, 4096
    buffer_load_dwordx4 a[12:15], v11, s[16:19], s3 offen offset:3072
    s_lshr_b32 s34, s34, 16
    v_mfma_f32_32x32x16_bf16 v[192:207], a[168:171], v[112:115], v[192:207]
    ds_read_b64_tr_b16 a[16:17], v5 offset:57344
    ds_read_b64_tr_b16 a[18:19], v5 offset:57856
    s_lshr_b32 s35, s34, 1
    s_mul_i32 s35, s35, 4480
    s_and_b32 s34, s34, 1
    s_lshl_b32 s34, s34, 11
    v_mfma_f32_32x32x16_bf16 v[176:191], a[172:175], v[116:119], v[176:191]
    ds_read_b64_tr_b16 a[20:21], v4 offset:59392
    s_waitcnt lgkmcnt(11)
    ds_read_b64_tr_b16 a[22:23], v4 offset:59904
    s_add_u32 s6, s34, s35
    s_mul_i32 s34, s27, 10
    s_lshr_b32 s34, s34, 16
    v_mfma_f32_32x32x16_bf16 v[192:207], a[176:179], v[116:119], v[192:207]
    ds_read_b64_tr_b16 a[24:25], v5 offset:59392
    ds_read_b64_tr_b16 a[26:27], v5 offset:59904
    s_add_u32 s3, s22, 0
    buffer_load_dwordx4 a[28:31], v11, s[16:19], s3 offen offset:0
    s_lshr_b32 s35, s34, 1
    s_mul_i32 s35, s35, 4480
    v_mfma_f32_32x32x16_bf16 v[176:191], a[180:183], v[120:123], v[176:191]
    ds_read_b64_tr_b16 a[32:33], v4 offset:61440
    s_waitcnt lgkmcnt(11)
    ds_read_b64_tr_b16 a[34:35], v4 offset:61952
    s_and_b32 s34, s34, 1
    s_lshl_b32 s34, s34, 11
    s_add_u32 s7, s34, s35
    v_mfma_f32_32x32x16_bf16 v[192:207], a[148:151], v[120:123], v[192:207]
    ds_read_b64_tr_b16 a[36:37], v5 offset:61440
    ds_read_b64_tr_b16 a[38:39], v5 offset:61952
    s_add_u32 s3, s23, 0
    buffer_load_dwordx4 a[40:43], v11, s[16:19], s3 offen offset:0
    v_mfma_f32_32x32x16_bf16 v[176:191], a[156:159], v[124:127], v[176:191]
    ds_read_b64_tr_b16 a[44:45], v4 offset:63488
    s_waitcnt lgkmcnt(11)
    ds_read_b64_tr_b16 a[46:47], v4 offset:64000
    s_add_u32 s3, s20, 8192
    buffer_load_dwordx4 a[48:51], v11, s[16:19], s3 offen offset:0
    v_mfma_f32_32x32x16_bf16 v[192:207], a[0:3], v[124:127], v[192:207]
    ds_read_b64_tr_b16 a[52:53], v5 offset:63488
    ds_read_b64_tr_b16 a[54:55], v5 offset:64000
    v_mfma_f32_32x32x16_bf16 v[176:191], a[8:11], v[128:131], v[176:191]
    ds_read_b64_tr_b16 a[56:57], v6 offset:0
    s_waitcnt lgkmcnt(11)
    ds_read_b64_tr_b16 a[58:59], v6 offset:384
    v_mfma_f32_32x32x16_bf16 v[192:207], a[16:19], v[128:131], v[192:207]
    ds_read_b64_tr_b16 a[184:185], v6 offset:32
    ds_read_b64_tr_b16 a[186:187], v6 offset:416
    s_add_u32 s3, s21, 0
    buffer_load_dwordx4 a[188:191], v11, s[16:19], s3 offen offset:1024
    v_mfma_f32_32x32x16_bf16 v[176:191], a[20:23], v[132:135], v[176:191]
    ds_read_b64_tr_b16 a[192:193], v6 offset:1536
    s_waitcnt lgkmcnt(11)
    ds_read_b64_tr_b16 a[194:195], v6 offset:1920
    v_mfma_f32_32x32x16_bf16 v[192:207], a[24:27], v[132:135], v[192:207]
    ds_read_b64_tr_b16 a[196:197], v6 offset:1568
    ds_read_b64_tr_b16 a[198:199], v6 offset:1952
    s_add_u32 s3, s22, 0
    buffer_load_dwordx4 a[200:203], v11, s[16:19], s3 offen offset:1024
    v_mfma_f32_32x32x16_bf16 v[176:191], a[32:35], v[136:139], v[176:191]
    ds_read_b64_tr_b16 a[204:205], v6 offset:3072
    s_waitcnt lgkmcnt(11)
    ds_read_b64_tr_b16 a[206:207], v6 offset:3456
    s_add_u32 s3, s20, 8192
    buffer_load_dwordx4 a[60:63], v11, s[16:19], s3 offen offset:1024
    v_mfma_f32_32x32x16_bf16 v[192:207], a[36:39], v[136:139], v[192:207]
    ds_read_b64_tr_b16 a[64:65], v6 offset:3104
    ds_read_b64_tr_b16 a[66:67], v6 offset:3488
    v_mfma_f32_32x32x16_bf16 v[176:191], a[44:47], v[140:143], v[176:191]
    ds_read_b64_tr_b16 a[68:69], v6 offset:4608
    s_waitcnt lgkmcnt(11)
    ds_read_b64_tr_b16 a[70:71], v6 offset:4992
    v_mfma_f32_32x32x16_bf16 v[192:207], a[52:55], v[140:143], v[192:207]
    ds_read_b64_tr_b16 a[72:73], v6 offset:4640
    ds_read_b64_tr_b16 a[74:75], v6 offset:5024
    s_add_u32 s3, s23, 0
    buffer_load_dwordx4 a[76:79], v11, s[16:19], s3 offen offset:1024
    v_mfma_f32_32x32x16_bf16 v[208:223], a[56:59], v[16:19], 0
    s_mul_i32 s34, s72, 71680
    s_mul_i32 s35, s44, 8960
    s_add_u32 s34, s34, s35
    s_add_u32 s34, s34, 22020096
    v_and_b32 v4, 63, v0
    v_lshlrev_b32 v4, 4, v4
    s_waitcnt lgkmcnt(12)
    v_mfma_f32_32x32x16_bf16 v[224:239], a[184:187], v[16:19], 0
    ds_read_b64_tr_b16 a[88:89], v6 offset:6144
    ds_read_b64_tr_b16 a[90:91], v6 offset:6528
    v_max_f32 v176, 0, v176
    v_max_f32 v177, 0, v177
    v_max_f32 v178, 0, v178
    v_max_f32 v179, 0, v179
    s_waitcnt lgkmcnt(12)
    v_mfma_f32_32x32x16_bf16 v[208:223], a[192:195], v[20:23], v[208:223]
    ds_read_b64_tr_b16 a[92:93], v6 offset:6176
    ds_read_b64_tr_b16 a[94:95], v6 offset:6560
    v_max_f32 v180, 0, v180
    v_max_f32 v181, 0, v181
    v_max_f32 v182, 0, v182
    v_max_f32 v183, 0, v183
    s_waitcnt lgkmcnt(12)
    v_mfma_f32_32x32x16_bf16 v[224:239], a[196:199], v[20:23], v[224:239]
    ds_read_b64_tr_b16 a[96:97], v6 offset:7680
    ds_read_b64_tr_b16 a[98:99], v6 offset:8064
    v_pk_mul_f32 v[176:177], v[176:177], v[184:185]
    v_pk_mul_f32 v[178:179], v[178:179], v[186:187]
    v_pk_mul_f32 v[180:181], v[180:181], v[188:189]
    v_pk_mul_f32 v[182:183], v[182:183], v[190:191]
    s_waitcnt lgkmcnt(12)
    v_mfma_f32_32x32x16_bf16 v[208:223], a[204:207], v[24:27], v[208:223]
    ds_read_b64_tr_b16 a[112:113], v6 offset:7712
    ds_read_b64_tr_b16 a[114:115], v6 offset:8096
    v_cvt_pk_bf16_f32 v184, v176, v177
    v_cvt_pk_bf16_f32 v185, v178, v179
    v_cvt_pk_bf16_f32 v186, v180, v181
    v_cvt_pk_bf16_f32 v187, v182, v183
    s_waitcnt lgkmcnt(12)
    v_mfma_f32_32x32x16_bf16 v[224:239], a[64:67], v[24:27], v[224:239]
    ds_write_b128 v7, a[216:219] offset:34816
    buffer_store_dwordx4 v[184:187], v10, s[16:19], 0 offen offset:2048 sc1
    v_max_f32 v192, 0, v192
    v_max_f32 v193, 0, v193
    v_max_f32 v194, 0, v194
    v_max_f32 v195, 0, v195
    s_waitcnt lgkmcnt(11)
    v_mfma_f32_32x32x16_bf16 v[208:223], a[68:71], v[28:31], v[208:223]
    ds_read_b64_tr_b16 a[116:117], v6 offset:9216
    ds_read_b64_tr_b16 a[118:119], v6 offset:9600
    v_max_f32 v196, 0, v196
    v_max_f32 v197, 0, v197
    v_max_f32 v198, 0, v198
    v_max_f32 v199, 0, v199
    s_waitcnt lgkmcnt(11)
    v_mfma_f32_32x32x16_bf16 v[224:239], a[72:75], v[28:31], v[224:239]
    ds_write_b128 v8, a[220:223] offset:35840
    ds_read_b64_tr_b16 a[120:121], v6 offset:9248
    ds_read_b64_tr_b16 a[122:123], v6 offset:9632
    v_pk_mul_f32 v[192:193], v[192:193], v[200:201]
    v_pk_mul_f32 v[194:195], v[194:195], v[202:203]
    v_pk_mul_f32 v[196:197], v[196:197], v[204:205]
    s_waitcnt lgkmcnt(12)
    v_mfma_f32_32x32x16_bf16 v[208:223], a[88:91], v[32:35], v[208:223]
    ds_read_b64_tr_b16 a[124:125], v6 offset:10752
    ds_read_b64_tr_b16 a[126:127], v6 offset:11136
    v_pk_mul_f32 v[198:199], v[198:199], v[206:207]
    v_cvt_pk_bf16_f32 v200, v192, v193
    v_cvt_pk_bf16_f32 v201, v194, v195
    v_cvt_pk_bf16_f32 v202, v196, v197
    s_waitcnt lgkmcnt(12)
    v_mfma_f32_32x32x16_bf16 v[224:239], a[92:95], v[32:35], v[224:239]
    ds_write_b128 v8, a[224:227] offset:36864
    ds_read_b64_tr_b16 a[128:129], v6 offset:10784
    ds_read_b64_tr_b16 a[130:131], v6 offset:11168
    v_cvt_pk_bf16_f32 v203, v198, v199
    buffer_store_dwordx4 v[200:203], v10, s[16:19], 0 offen offset:3072 sc1
    s_add_u32 s3, s20, 8192
    buffer_load_dwordx4 a[136:139], v11, s[16:19], s3 offen offset:2048
    s_waitcnt lgkmcnt(13)
    v_mfma_f32_32x32x16_bf16 v[208:223], a[96:99], v[36:39], v[208:223]
    ds_read_b64_tr_b16 a[140:141], v6 offset:16384
    ds_read_b64_tr_b16 a[142:143], v6 offset:16768
    s_add_u32 s3, s21, 0
    buffer_load_dwordx4 a[144:147], v11, s[16:19], s3 offen offset:2048
    v_add_u32 v4, s34, v4
    v_add_u32 v5, 35840, v4
    s_waitcnt lgkmcnt(13)
    v_mfma_f32_32x32x16_bf16 v[224:239], a[112:115], v[36:39], v[224:239]
    ds_write_b128 v8, a[228:231] offset:37888
    ds_read_b64_tr_b16 a[160:161], v6 offset:16416
    s_waitcnt lgkmcnt(11)
    ds_read_b64_tr_b16 a[162:163], v6 offset:16800
    s_add_u32 s3, s22, 0
    buffer_load_dwordx4 a[164:167], v11, s[16:19], s3 offen offset:2048
    v_mfma_f32_32x32x16_bf16 v[208:223], a[116:119], v[40:43], v[208:223]
    ds_read_b64_tr_b16 a[168:169], v6 offset:17920
    ds_read_b64_tr_b16 a[170:171], v6 offset:18304
    s_add_u32 s3, s23, 0
    buffer_load_dwordx4 a[172:175], v11, s[16:19], s3 offen offset:2048
    s_waitcnt lgkmcnt(12)
    v_mfma_f32_32x32x16_bf16 v[224:239], a[120:123], v[40:43], v[224:239]
    ds_read_b64_tr_b16 a[176:177], v6 offset:17952
    ds_read_b64_tr_b16 a[178:179], v6 offset:18336
    s_waitcnt lgkmcnt(12)
    v_mfma_f32_32x32x16_bf16 v[208:223], a[124:127], v[44:47], v[208:223]
    ds_read_b64_tr_b16 a[180:181], v6 offset:19456
    ds_read_b64_tr_b16 a[182:183], v6 offset:19840
    s_add_u32 s3, s21, 0
    buffer_load_dwordx4 a[148:151], v11, s[16:19], s3 offen offset:3072
    s_waitcnt lgkmcnt(11)
    v_mfma_f32_32x32x16_bf16 v[224:239], a[128:131], v[44:47], v[224:239]
    ds_read_b64_tr_b16 a[156:157], v6 offset:19488
    ds_read_b64_tr_b16 a[158:159], v6 offset:19872
    s_add_u32 s3, s20, 8192
    buffer_load_dwordx4 a[0:3], v11, s[16:19], s3 offen offset:3072
    s_waitcnt lgkmcnt(11)
    v_mfma_f32_32x32x16_bf16 v[208:223], a[140:143], v[48:51], v[208:223]
    s_waitcnt lgkmcnt(10)
    s_barrier
    ds_read_b64_tr_b16 a[8:9], v6 offset:20992
    ds_read_b64_tr_b16 a[10:11], v6 offset:21376
    s_waitcnt lgkmcnt(10)
    v_mfma_f32_32x32x16_bf16 v[224:239], a[160:163], v[48:51], v[224:239]
    ds_read_b64_tr_b16 a[16:17], v6 offset:21024
    ds_read_b64_tr_b16 a[18:19], v6 offset:21408
    s_waitcnt lgkmcnt(10)
    v_mfma_f32_32x32x16_bf16 v[208:223], a[168:171], v[52:55], v[208:223]
    ds_read_b64_tr_b16 a[20:21], v6 offset:22528
    ds_read_b64_tr_b16 a[22:23], v6 offset:22912
    s_add_u32 s3, s22, 0
    buffer_load_dwordx4 a[24:27], v11, s[16:19], s3 offen offset:3072
    s_waitcnt lgkmcnt(10)
    v_mfma_f32_32x32x16_bf16 v[224:239], a[176:179], v[52:55], v[224:239]
    ds_read_b64_tr_b16 a[32:33], v6 offset:22560
    ds_read_b64_tr_b16 a[34:35], v6 offset:22944
    s_waitcnt lgkmcnt(10)
    v_mfma_f32_32x32x16_bf16 v[208:223], a[180:183], v[56:59], v[208:223]
    ds_read_b64_tr_b16 a[36:37], v6 offset:24064
    ds_read_b64_tr_b16 a[38:39], v6 offset:24448
    s_add_u32 s3, s23, 0
    buffer_load_dwordx4 a[44:47], v11, s[16:19], s3 offen offset:3072
    s_waitcnt lgkmcnt(10)
    v_mfma_f32_32x32x16_bf16 v[224:239], a[156:159], v[56:59], v[224:239]
    s_waitcnt vmcnt(33)
    ds_write_b128 v7, a[232:235] offset:49152
    ds_read_b64_tr_b16 a[52:53], v6 offset:24096
    ds_read_b64_tr_b16 a[54:55], v6 offset:24480
    s_add_u32 s3, s20, 12288
    buffer_load_dwordx4 a[56:59], v11, s[16:19], s3 offen offset:0
    s_waitcnt lgkmcnt(11)
    v_mfma_f32_32x32x16_bf16 v[208:223], a[8:11], v[60:63], v[208:223]
    ds_read_b64_tr_b16 a[184:185], v6 offset:25600
    ds_read_b64_tr_b16 a[186:187], v6 offset:25984
    s_waitcnt lgkmcnt(11)
    v_mfma_f32_32x32x16_bf16 v[224:239], a[16:19], v[60:63], v[224:239]
    ds_write_b128 v7, a[236:239] offset:50176
    ds_read_b64_tr_b16 a[192:193], v6 offset:25632
    ds_read_b64_tr_b16 a[194:195], v6 offset:26016
    s_waitcnt vmcnt(21)
    s_mov_b64 exec, 1
    buffer_store_dword v13, off, s[16:19], s74 offset:0 sc1
    s_mov_b64 exec, -1
    s_waitcnt lgkmcnt(12)
    v_mfma_f32_32x32x16_bf16 v[208:223], a[20:23], v[64:67], v[208:223]
    ds_read_b64_tr_b16 a[196:197], v6 offset:27136
    ds_read_b64_tr_b16 a[198:199], v6 offset:27520
    s_waitcnt lgkmcnt(12)
    v_mfma_f32_32x32x16_bf16 v[224:239], a[32:35], v[64:67], v[224:239]
    ds_write_b128 v7, a[240:243] offset:51200
    ds_read_b64_tr_b16 a[204:205], v6 offset:27168
    ds_read_b64_tr_b16 a[206:207], v6 offset:27552
    s_add_u32 s3, s21, 4096
    buffer_load_dwordx4 a[64:67], v11, s[16:19], s3 offen offset:0
    s_waitcnt lgkmcnt(13)
    v_mfma_f32_32x32x16_bf16 v[208:223], a[36:39], v[68:71], v[208:223]
    ds_read_b64_tr_b16 a[68:69], v6 offset:32768
    ds_read_b64_tr_b16 a[70:71], v6 offset:33152
    s_waitcnt lgkmcnt(12)
    v_mfma_f32_32x32x16_bf16 v[224:239], a[52:55], v[68:71], v[224:239]
    ds_write_b128 v8, a[244:247] offset:52224
    ds_read_b64_tr_b16 a[72:73], v6 offset:32800
    ds_read_b64_tr_b16 a[74:75], v6 offset:33184
    s_add_u32 s3, s20, 12288
    buffer_load_dwordx4 a[88:91], v11, s[16:19], s3 offen offset:1024
    s_waitcnt lgkmcnt(13)
    v_mfma_f32_32x32x16_bf16 v[208:223], a[184:187], v[72:75], v[208:223]
    ds_read_b64_tr_b16 a[92:93], v6 offset:34304
    ds_read_b64_tr_b16 a[94:95], v6 offset:34688
    s_waitcnt lgkmcnt(12)
    v_mfma_f32_32x32x16_bf16 v[224:239], a[192:195], v[72:75], v[224:239]
    ds_write_b128 v8, a[248:251] offset:53248
    ds_read_b64_tr_b16 a[96:97], v6 offset:34336
    ds_read_b64_tr_b16 a[98:99], v6 offset:34720
    s_add_u32 s3, s22, 4096
    buffer_load_dwordx4 a[112:115], v11, s[16:19], s3 offen offset:0
    s_waitcnt lgkmcnt(13)
    v_mfma_f32_32x32x16_bf16 v[208:223], a[196:199], v[76:79], v[208:223]
    ds_read_b64_tr_b16 a[116:117], v6 offset:35840
    ds_read_b64_tr_b16 a[118:119], v6 offset:36224
    s_waitcnt lgkmcnt(12)
    v_mfma_f32_32x32x16_bf16 v[224:239], a[204:207], v[76:79], v[224:239]
    ds_write_b128 v8, a[252:255] offset:54272
    ds_read_b64_tr_b16 a[120:121], v6 offset:35872
    ds_read_b64_tr_b16 a[122:123], v6 offset:36256
    s_add_u32 s3, s23, 4096
    buffer_load_dwordx4 a[124:127], v11, s[16:19], s3 offen offset:0
    s_waitcnt lgkmcnt(13)
    v_mfma_f32_32x32x16_bf16 v[208:223], a[68:71], v[80:83], v[208:223]
    ds_read_b64_tr_b16 a[128:129], v6 offset:37376
    ds_read_b64_tr_b16 a[130:131], v6 offset:37760
    s_waitcnt lgkmcnt(12)
    v_mfma_f32_32x32x16_bf16 v[224:239], a[72:75], v[80:83], v[224:239]
    ds_read_b64_tr_b16 a[208:209], v6 offset:37408
    ds_read_b64_tr_b16 a[210:211], v6 offset:37792
    s_add_u32 s3, s21, 4096
    buffer_load_dwordx4 a[212:215], v11, s[16:19], s3 offen offset:1024
    s_waitcnt lgkmcnt(12)
    v_mfma_f32_32x32x16_bf16 v[208:223], a[92:95], v[84:87], v[208:223]
    ds_read_b64_tr_b16 a[216:217], v6 offset:38912
    ds_read_b64_tr_b16 a[218:219], v6 offset:39296
    s_waitcnt lgkmcnt(11)
    v_mfma_f32_32x32x16_bf16 v[224:239], a[96:99], v[84:87], v[224:239]
    ds_read_b64_tr_b16 a[220:221], v6 offset:38944
    ds_read_b64_tr_b16 a[222:223], v6 offset:39328
    s_add_u32 s3, s22, 4096
    buffer_load_dwordx4 a[224:227], v11, s[16:19], s3 offen offset:1024
    s_waitcnt lgkmcnt(11)
    v_mfma_f32_32x32x16_bf16 v[208:223], a[116:119], v[88:91], v[208:223]
    s_waitcnt lgkmcnt(10)
    s_barrier
    ds_read_b64_tr_b16 a[228:229], v6 offset:40448
    ds_read_b64_tr_b16 a[230:231], v6 offset:40832
    s_waitcnt lgkmcnt(10)
    v_mfma_f32_32x32x16_bf16 v[224:239], a[120:123], v[88:91], v[224:239]
    ds_read_b64_tr_b16 a[140:141], v6 offset:40480
    ds_read_b64_tr_b16 a[142:143], v6 offset:40864
    s_add_u32 s3, s23, 4096
    buffer_load_dwordx4 a[160:163], v11, s[16:19], s3 offen offset:1024
    s_waitcnt lgkmcnt(10)
    v_mfma_f32_32x32x16_bf16 v[208:223], a[128:131], v[92:95], v[208:223]
    ds_read_b64_tr_b16 a[168:169], v6 offset:41984
    ds_read_b64_tr_b16 a[170:171], v6 offset:42368
    s_waitcnt lgkmcnt(10)
    v_mfma_f32_32x32x16_bf16 v[224:239], a[208:211], v[92:95], v[224:239]
    ds_read_b64_tr_b16 a[176:177], v6 offset:42016
    ds_read_b64_tr_b16 a[178:179], v6 offset:42400
    s_add_u32 s3, s21, 4096
    buffer_load_dwordx4 a[180:183], v11, s[16:19], s3 offen offset:2048
    s_waitcnt lgkmcnt(10)
    v_mfma_f32_32x32x16_bf16 v[208:223], a[216:219], v[96:99], v[208:223]
    ds_read_b64_tr_b16 a[156:157], v6 offset:43520
    ds_read_b64_tr_b16 a[158:159], v6 offset:43904
    s_waitcnt lgkmcnt(10)
    v_mfma_f32_32x32x16_bf16 v[224:239], a[220:223], v[96:99], v[224:239]
    ds_read_b64_tr_b16 a[8:9], v6 offset:43552
    ds_read_b64_tr_b16 a[10:11], v6 offset:43936
    s_add_u32 s3, s22, 4096
    buffer_load_dwordx4 a[16:19], v11, s[16:19], s3 offen offset:2048
    s_waitcnt lgkmcnt(10)
    v_mfma_f32_32x32x16_bf16 v[208:223], a[228:231], v[100:103], v[208:223]
    ds_read_b64_tr_b16 a[20:21], v6 offset:49152
    ds_read_b64_tr_b16 a[22:23], v6 offset:49536
    s_mov_b64 exec, 255
    buffer_load_dwordx2 v[14:15], v12, s[16:19], s33 offen offset:0 sc1
    s_mov_b64 exec, -1
    s_waitcnt lgkmcnt(10)
    v_mfma_f32_32x32x16_bf16 v[224:239], a[140:143], v[100:103], v[224:239]
    ds_read_b64_tr_b16 a[32:33], v6 offset:49184
    ds_read_b64_tr_b16 a[34:35], v6 offset:49568
    s_add_u32 s3, s23, 4096
    buffer_load_dwordx4 a[36:39], v11, s[16:19], s3 offen offset:2048
    s_waitcnt lgkmcnt(10)
    v_mfma_f32_32x32x16_bf16 v[208:223], a[168:171], v[104:107], v[208:223]
    ds_read_b64_tr_b16 a[52:53], v6 offset:50688
    ds_read_b64_tr_b16 a[54:55], v6 offset:51072
    s_waitcnt lgkmcnt(10)
    v_mfma_f32_32x32x16_bf16 v[224:239], a[176:179], v[104:107], v[224:239]
    ds_read_b64_tr_b16 a[184:185], v6 offset:50720
    ds_read_b64_tr_b16 a[186:187], v6 offset:51104
    s_add_u32 s3, s21, 4096
    buffer_load_dwordx4 a[192:195], v11, s[16:19], s3 offen offset:3072
    s_waitcnt lgkmcnt(10)
    v_mfma_f32_32x32x16_bf16 v[208:223], a[156:159], v[108:111], v[208:223]
    ds_read_b64_tr_b16 a[196:197], v6 offset:52224
    ds_read_b64_tr_b16 a[198:199], v6 offset:52608
    s_waitcnt lgkmcnt(10)
    v_mfma_f32_32x32x16_bf16 v[224:239], a[8:11], v[108:111], v[224:239]
    ds_read_b64_tr_b16 a[204:205], v6 offset:52256
    ds_read_b64_tr_b16 a[206:207], v6 offset:52640
    s_add_u32 s3, s22, 4096
    buffer_load_dwordx4 a[68:71], v11, s[16:19], s3 offen offset:3072
    s_waitcnt lgkmcnt(10)
    v_mfma_f32_32x32x16_bf16 v[208:223], a[20:23], v[112:115], v[208:223]
    ds_read_b64_tr_b16 a[72:73], v6 offset:53760
    ds_read_b64_tr_b16 a[74:75], v6 offset:54144
    s_waitcnt lgkmcnt(10)
    v_mfma_f32_32x32x16_bf16 v[224:239], a[32:35], v[112:115], v[224:239]
    ds_read_b64_tr_b16 a[92:93], v6 offset:53792
    ds_read_b64_tr_b16 a[94:95], v6 offset:54176
    s_add_u32 s3, s23, 4096
    buffer_load_dwordx4 a[96:99], v11, s[16:19], s3 offen offset:3072
    s_waitcnt lgkmcnt(10)
    v_mfma_f32_32x32x16_bf16 v[208:223], a[52:55], v[116:119], v[208:223]
    ds_read_b64_tr_b16 a[232:233], v6 offset:55296
    ds_read_b64_tr_b16 a[234:235], v6 offset:55680
    s_waitcnt lgkmcnt(10)
    v_mfma_f32_32x32x16_bf16 v[224:239], a[184:187], v[116:119], v[224:239]
    ds_read_b64_tr_b16 a[236:237], v6 offset:55328
    ds_read_b64_tr_b16 a[238:239], v6 offset:55712
    s_add_u32 s3, s21, 8192
    buffer_load_dwordx4 a[240:243], v11, s[16:19], s3 offen offset:0
    s_waitcnt lgkmcnt(10)
    v_mfma_f32_32x32x16_bf16 v[208:223], a[196:199], v[120:123], v[208:223]
    ds_read_b64_tr_b16 a[244:245], v6 offset:56832
    ds_read_b64_tr_b16 a[246:247], v6 offset:57216
    s_waitcnt lgkmcnt(10)
    v_mfma_f32_32x32x16_bf16 v[224:239], a[204:207], v[120:123], v[224:239]
    ds_read_b64_tr_b16 a[248:249], v6 offset:56864
    ds_read_b64_tr_b16 a[250:251], v6 offset:57248
    s_add_u32 s3, s22, 8192
    buffer_load_dwordx4 a[252:255], v11, s[16:19], s3 offen offset:0
    s_waitcnt lgkmcnt(10)
    v_mfma_f32_32x32x16_bf16 v[208:223], a[72:75], v[124:127], v[208:223]
    ds_read_b64_tr_b16 a[116:117], v6 offset:58368
    ds_read_b64_tr_b16 a[118:119], v6 offset:58752
    s_waitcnt vmcnt(26)
    s_mov_b64 exec, 1
    buffer_store_dword v13, off, s[16:19], s74 offset:1024 sc1
    s_mov_b64 exec, -1
    s_waitcnt lgkmcnt(10)
    v_mfma_f32_32x32x16_bf16 v[224:239], a[92:95], v[124:127], v[224:239]
    ds_read_b64_tr_b16 a[120:121], v6 offset:58400
    ds_read_b64_tr_b16 a[122:123], v6 offset:58784
    s_add_u32 s3, s23, 8192
    buffer_load_dwordx4 a[128:131], v11, s[16:19], s3 offen offset:0
    s_waitcnt lgkmcnt(10)
    v_mfma_f32_32x32x16_bf16 v[208:223], a[232:235], v[128:131], v[208:223]
    ds_read_b64_tr_b16 a[208:209], v6 offset:59904
    ds_read_b64_tr_b16 a[210:211], v6 offset:60288
    s_waitcnt lgkmcnt(10)
    v_mfma_f32_32x32x16_bf16 v[224:239], a[236:239], v[128:131], v[224:239]
    ds_read_b64_tr_b16 a[216:217], v6 offset:59936
    ds_read_b64_tr_b16 a[218:219], v6 offset:60320
    s_add_u32 s3, s21, 8192
    buffer_load_dwordx4 a[220:223], v11, s[16:19], s3 offen offset:1024
    s_waitcnt lgkmcnt(10)
    v_mfma_f32_32x32x16_bf16 v[208:223], a[244:247], v[132:135], v[208:223]
    ds_read_b64_tr_b16 a[228:229], v6 offset:64
    ds_read_b64_tr_b16 a[230:231], v6 offset:448
    s_mov_b64 exec, 255
    s_waitcnt vmcnt(9)
    v_xor_b32 v14, s36, v14
    v_xor_b32 v15, s36, v15
    v_or_b32 v14, v14, v15
    v_cmp_ne_u32 vcc, 0, v14
    s_cbranch_vccnz LG_slow5
LG_back5:
    s_mov_b64 exec, -1
    s_waitcnt lgkmcnt(10)
    v_mfma_f32_32x32x16_bf16 v[224:239], a[248:251], v[132:135], v[224:239]
    ds_read_b64_tr_b16 a[140:141], v6 offset:1600
    ds_read_b64_tr_b16 a[142:143], v6 offset:1984
    buffer_load_dwordx4 v[144:147], v2, s[16:19], s24 offen offset:0
    buffer_load_dwordx4 v[148:151], v3, s[16:19], s24 offen offset:0
    s_waitcnt lgkmcnt(10)
    v_mfma_f32_32x32x16_bf16 v[208:223], a[116:119], v[136:139], v[208:223]
    ds_read_b64_tr_b16 a[168:169], v6 offset:3136
    ds_read_b64_tr_b16 a[170:171], v6 offset:3520
    s_waitcnt lgkmcnt(10)
    v_mfma_f32_32x32x16_bf16 v[224:239], a[120:123], v[136:139], v[224:239]
    ds_read_b64_tr_b16 a[176:177], v6 offset:4672
    ds_read_b64_tr_b16 a[178:179], v6 offset:5056
    s_waitcnt lgkmcnt(10)
    v_mfma_f32_32x32x16_bf16 v[208:223], a[208:211], v[140:143], v[208:223]
    ds_read_b64_tr_b16 a[156:157], v6 offset:6208
    ds_read_b64_tr_b16 a[158:159], v6 offset:6592
    buffer_load_dwordx4 v[152:155], v2, s[16:19], s24 offen offset:1024
    buffer_load_dwordx4 v[156:159], v3, s[16:19], s24 offen offset:1024
    s_waitcnt lgkmcnt(10)
    v_mfma_f32_32x32x16_bf16 v[224:239], a[216:219], v[140:143], v[224:239]
    ds_read_b64_tr_b16 a[8:9], v6 offset:7744
    ds_read_b64_tr_b16 a[10:11], v6 offset:8128
    s_waitcnt lgkmcnt(10)
    v_mfma_f32_32x32x16_bf16 v[240:255], a[228:231], v[16:19], 0
    ds_read_b64_tr_b16 a[20:21], v6 offset:9280
    ds_read_b64_tr_b16 a[22:23], v6 offset:9664
    s_waitcnt lgkmcnt(10)
    v_mfma_f32_32x32x16_bf16 v[240:255], a[140:143], v[20:23], v[240:255]
    ds_read_b64_tr_b16 a[32:33], v6 offset:10816
    ds_read_b64_tr_b16 a[34:35], v6 offset:11200
    v_max_f32 v208, 0, v208
    v_max_f32 v209, 0, v209
    v_max_f32 v210, 0, v210
    v_max_f32 v211, 0, v211
    buffer_load_dwordx4 v[160:163], v2, s[16:19], s25 offen offset:0
    buffer_load_dwordx4 v[164:167], v3, s[16:19], s25 offen offset:0
    s_waitcnt lgkmcnt(10)
    v_mfma_f32_32x32x16_bf16 v[240:255], a[168:171], v[24:27], v[240:255]
    ds_read_b64_tr_b16 a[52:53], v6 offset:16448
    ds_read_b64_tr_b16 a[54:55], v6 offset:16832
    v_max_f32 v212, 0, v212
    v_max_f32 v213, 0, v213
    v_max_f32 v214, 0, v214
    v_max_f32 v215, 0, v215
    s_waitcnt lgkmcnt(10)
    v_mfma_f32_32x32x16_bf16 v[240:255], a[176:179], v[28:31], v[240:255]
    ds_read_b64_tr_b16 a[184:185], v6 offset:17984
    ds_read_b64_tr_b16 a[186:187], v6 offset:18368
    v_pk_mul_f32 v[208:209], v[208:209], v[216:217]
    v_pk_mul_f32 v[210:211], v[210:211], v[218:219]
    v_pk_mul_f32 v[212:213], v[212:213], v[220:221]
    v_pk_mul_f32 v[214:215], v[214:215], v[222:223]
    s_waitcnt lgkmcnt(10)
    v_mfma_f32_32x32x16_bf16 v[240:255], a[156:159], v[32:35], v[240:255]
    s_barrier
    ds_read_b64_tr_b16 a[196:197], v6 offset:19520
    ds_read_b64_tr_b16 a[198:199], v6 offset:19904
    v_cvt_pk_bf16_f32 v216, v208, v209
    v_cvt_pk_bf16_f32 v217, v210, v211
    v_cvt_pk_bf16_f32 v218, v212, v213
    buffer_load_dwordx4 v[168:171], v2, s[16:19], s25 offen offset:1024
    buffer_load_dwordx4 v[172:175], v3, s[16:19], s25 offen offset:1024
    s_waitcnt lgkmcnt(10)
    v_mfma_f32_32x32x16_bf16 v[240:255], a[8:11], v[36:39], v[240:255]
    ds_read_b64_tr_b16 a[204:205], v6 offset:21056
    ds_read_b64_tr_b16 a[206:207], v6 offset:21440
    v_cvt_pk_bf16_f32 v219, v214, v215
    buffer_store_dwordx4 v[216:219], v10, s[16:19], s56 offen offset:0 sc1
    v_max_f32 v224, 0, v224
    v_max_f32 v225, 0, v225
    s_waitcnt lgkmcnt(10)
    v_mfma_f32_32x32x16_bf16 v[240:255], a[20:23], v[40:43], v[240:255]
    ds_read_b64_tr_b16 a[72:73], v6 offset:22592
    ds_read_b64_tr_b16 a[74:75], v6 offset:22976
    v_max_f32 v226, 0, v226
    v_max_f32 v227, 0, v227
    v_max_f32 v228, 0, v228
    v_max_f32 v229, 0, v229
    s_waitcnt lgkmcnt(10)
    v_mfma_f32_32x32x16_bf16 v[240:255], a[32:35], v[44:47], v[240:255]
    ds_read_b64_tr_b16 a[92:93], v6 offset:24128
    ds_read_b64_tr_b16 a[94:95], v6 offset:24512
    v_max_f32 v230, 0, v230
    v_max_f32 v231, 0, v231
    v_pk_mul_f32 v[224:225], v[224:225], v[232:233]
    v_pk_mul_f32 v[226:227], v[226:227], v[234:235]
    buffer_load_dwordx4 v[176:179], v2, s[16:19], s26 offen offset:0
    buffer_load_dwordx4 v[180:183], v3, s[16:19], s26 offen offset:0
    s_waitcnt lgkmcnt(10)
    v_mfma_f32_32x32x16_bf16 v[240:255], a[52:55], v[48:51], v[240:255]
    ds_read_b64_tr_b16 a[232:233], v6 offset:25664
    ds_read_b64_tr_b16 a[234:235], v6 offset:26048
    v_pk_mul_f32 v[228:229], v[228:229], v[236:237]
    v_pk_mul_f32 v[230:231], v[230:231], v[238:239]
    v_cvt_pk_bf16_f32 v232, v224, v225
    v_cvt_pk_bf16_f32 v233, v226, v227
    s_waitcnt lgkmcnt(10)
    v_mfma_f32_32x32x16_bf16 v[240:255], a[184:187], v[52:55], v[240:255]
    ds_read_b64_tr_b16 a[236:237], v6 offset:27200
    ds_read_b64_tr_b16 a[238:239], v6 offset:27584
    v_cvt_pk_bf16_f32 v234, v228, v229
    v_cvt_pk_bf16_f32 v235, v230, v231
    buffer_store_dwordx4 v[232:235], v1, s[16:19], s32 offen offset:0 sc1
    s_waitcnt lgkmcnt(10)
    v_mfma_f32_32x32x16_bf16 v[240:255], a[196:199], v[56:59], v[240:255]
    ds_read_b64_tr_b16 a[244:245], v6 offset:32832
    ds_read_b64_tr_b16 a[246:247], v6 offset:33216
    buffer_load_dwordx4 v[184:187], v2, s[16:19], s26 offen offset:1024
    buffer_load_dwordx4 v[188:191], v3, s[16:19], s26 offen offset:1024
    s_waitcnt lgkmcnt(10)
    v_mfma_f32_32x32x16_bf16 v[240:255], a[204:207], v[60:63], v[240:255]
    ds_read_b64_tr_b16 a[248:249], v6 offset:34368
    ds_read_b64_tr_b16 a[250:251], v6 offset:34752
    s_waitcnt lgkmcnt(10)
    v_mfma_f32_32x32x16_bf16 v[240:255], a[72:75], v[64:67], v[240:255]
    ds_read_b64_tr_b16 a[116:117], v6 offset:35904
    ds_read_b64_tr_b16 a[118:119], v6 offset:36288
    s_waitcnt lgkmcnt(10)
    v_mfma_f32_32x32x16_bf16 v[240:255], a[92:95], v[68:71], v[240:255]
    ds_read_b64_tr_b16 a[120:121], v6 offset:37440
    ds_read_b64_tr_b16 a[122:123], v6 offset:37824
    buffer_load_dwordx4 v[192:195], v2, s[16:19], s27 offen offset:0
    buffer_load_dwordx4 v[196:199], v3, s[16:19], s27 offen offset:0
    s_waitcnt lgkmcnt(10)
    v_mfma_f32_32x32x16_bf16 v[240:255], a[232:235], v[72:75], v[240:255]
    ds_read_b64_tr_b16 a[208:209], v6 offset:38976
    ds_read_b64_tr_b16 a[210:211], v6 offset:39360
    s_waitcnt lgkmcnt(10)
    v_mfma_f32_32x32x16_bf16 v[240:255], a[236:239], v[76:79], v[240:255]
    ds_read_b64_tr_b16 a[216:217], v6 offset:40512
    ds_read_b64_tr_b16 a[218:219], v6 offset:40896
    s_waitcnt lgkmcnt(10)
    v_mfma_f32_32x32x16_bf16 v[240:255], a[244:247], v[80:83], v[240:255]
    ds_read_b64_tr_b16 a[228:229], v6 offset:42048
    ds_read_b64_tr_b16 a[230:231], v6 offset:42432
    buffer_load_dwordx4 v[200:203], v2, s[16:19], s27 offen offset:1024
    buffer_load_dwordx4 v[204:207], v3, s[16:19], s27 offen offset:1024
    s_waitcnt lgkmcnt(10)
    v_mfma_f32_32x32x16_bf16 v[240:255], a[248:251], v[84:87], v[240:255]
    ds_read_b64_tr_b16 a[140:141], v6 offset:43584
    ds_read_b64_tr_b16 a[142:143], v6 offset:43968
    s_waitcnt lgkmcnt(10)
    v_mfma_f32_32x32x16_bf16 v[240:255], a[116:119], v[88:91], v[240:255]
    ds_read_b64_tr_b16 a[168:169], v6 offset:49216
    ds_read_b64_tr_b16 a[170:171], v6 offset:49600
    s_mov_b64 exec, 15
    buffer_load_dwordx2 v[14:15], v12, s[16:19], s75 offen offset:1024 sc1
    s_mov_b64 exec, -1
    s_waitcnt lgkmcnt(10)
    v_mfma_f32_32x32x16_bf16 v[240:255], a[120:123], v[92:95], v[240:255]
    ds_read_b64_tr_b16 a[176:177], v6 offset:50752
    ds_read_b64_tr_b16 a[178:179], v6 offset:51136
    s_waitcnt lgkmcnt(10)
    v_mfma_f32_32x32x16_bf16 v[240:255], a[208:211], v[96:99], v[240:255]
    ds_read_b64_tr_b16 a[156:157], v6 offset:52288
    ds_read_b64_tr_b16 a[158:159], v6 offset:52672
    s_waitcnt lgkmcnt(10)
    v_mfma_f32_32x32x16_bf16 v[240:255], a[216:219], v[100:103], v[240:255]
    ds_read_b64_tr_b16 a[8:9], v6 offset:53824
    ds_read_b64_tr_b16 a[10:11], v6 offset:54208
    s_waitcnt lgkmcnt(10)
    v_mfma_f32_32x32x16_bf16 v[240:255], a[228:231], v[104:107], v[240:255]
    ds_read_b64_tr_b16 a[20:21], v6 offset:55360
    ds_read_b64_tr_b16 a[22:23], v6 offset:55744
    s_waitcnt lgkmcnt(10)
    v_mfma_f32_32x32x16_bf16 v[240:255], a[140:143], v[108:111], v[240:255]
    ds_read_b64_tr_b16 a[32:33], v6 offset:56896
    ds_read_b64_tr_b16 a[34:35], v6 offset:57280
    s_waitcnt vmcnt(7)
    s_mov_b64 exec, 1
    buffer_store_dword v13, off, s[16:19], s74 offset:2048 sc1
    s_mov_b64 exec, -1
    s_waitcnt lgkmcnt(10)
    v_mfma_f32_32x32x16_bf16 v[240:255], a[168:171], v[112:115], v[240:255]
    ds_read_b64_tr_b16 a[52:53], v6 offset:58432
    ds_read_b64_tr_b16 a[54:55], v6 offset:58816
    s_waitcnt lgkmcnt(10)
    v_mfma_f32_32x32x16_bf16 v[240:255], a[176:179], v[116:119], v[240:255]
    ds_read_b64_tr_b16 a[184:185], v6 offset:59968
    ds_read_b64_tr_b16 a[186:187], v6 offset:60352
    s_waitcnt lgkmcnt(10)
    v_mfma_f32_32x32x16_bf16 v[240:255], a[156:159], v[120:123], v[240:255]
    s_add_u32 s3, s22, 8192
    buffer_load_dwordx4 a[196:199], v11, s[16:19], s3 offen offset:1024
    s_waitcnt lgkmcnt(8)
    v_mfma_f32_32x32x16_bf16 v[240:255], a[8:11], v[124:127], v[240:255]
    s_waitcnt lgkmcnt(6)
    v_mfma_f32_32x32x16_bf16 v[240:255], a[20:23], v[128:131], v[240:255]
    s_add_u32 s3, s23, 8192
    buffer_load_dwordx4 a[204:207], v11, s[16:19], s3 offen offset:1024
    s_waitcnt lgkmcnt(4)
    v_mfma_f32_32x32x16_bf16 v[240:255], a[32:35], v[132:135], v[240:255]
    s_waitcnt lgkmcnt(2)
    v_mfma_f32_32x32x16_bf16 v[240:255], a[52:55], v[136:139], v[240:255]
    s_add_u32 s3, s21, 8192
    buffer_load_dwordx4 a[72:75], v11, s[16:19], s3 offen offset:2048
    s_waitcnt lgkmcnt(0)
    v_mfma_f32_32x32x16_bf16 v[240:255], a[184:187], v[140:143], v[240:255]
    v_mfma_f32_32x32x16_bf16 v[16:31], a[80:83], v[144:147], 0
    s_add_u32 s3, s22, 8192
    buffer_load_dwordx4 a[92:95], v11, s[16:19], s3 offen offset:2048
    v_mfma_f32_32x32x16_bf16 v[32:47], a[80:83], v[148:151], 0
    v_mfma_f32_32x32x16_bf16 v[48:63], a[84:87], v[144:147], 0
    v_max_f32 v240, 0, v240
    v_max_f32 v241, 0, v241
    v_max_f32 v242, 0, v242
    v_max_f32 v243, 0, v243
    v_max_f32 v244, 0, v244
    v_max_f32 v245, 0, v245
    v_mfma_f32_32x32x16_bf16 v[64:79], a[84:87], v[148:151], 0
    v_max_f32 v246, 0, v246
    v_max_f32 v247, 0, v247
    v_pk_mul_f32 v[240:241], v[240:241], v[248:249]
    v_pk_mul_f32 v[242:243], v[242:243], v[250:251]
    v_pk_mul_f32 v[244:245], v[244:245], v[252:253]
    v_pk_mul_f32 v[246:247], v[246:247], v[254:255]
    v_mfma_f32_32x32x16_bf16 v[16:31], a[100:103], v[152:155], v[16:31]
    v_cvt_pk_bf16_f32 v248, v240, v241
    v_cvt_pk_bf16_f32 v249, v242, v243
    v_cvt_pk_bf16_f32 v250, v244, v245
    v_cvt_pk_bf16_f32 v251, v246, v247
    buffer_store_dwordx4 v[248:251], v1, s[16:19], s32 offen offset:1024 sc1
    s_add_u32 s3, s23, 8192
    buffer_load_dwordx4 a[232:235], v11, s[16:19], s3 offen offset:2048
    v_mfma_f32_32x32x16_bf16 v[32:47], a[100:103], v[156:159], v[32:47]
    s_mov_b64 exec, 15
    s_waitcnt vmcnt(7)
    v_xor_b32 v14, s36, v14
    v_xor_b32 v15, s36, v15
    v_or_b32 v14, v14, v15
    v_cmp_ne_u32 vcc, 0, v14
    s_cbranch_vccnz LG_slow6
LG_back6:
    s_mov_b64 exec, -1
    v_mfma_f32_32x32x16_bf16 v[48:63], a[104:107], v[152:155], v[48:63]
    buffer_load_dwordx4 v[144:147], v2, s[16:19], s24 offen offset:2048
    buffer_load_dwordx4 v[148:151], v3, s[16:19], s24 offen offset:2048
    s_mov_b64 exec, 15
    buffer_load_dwordx2 v[14:15], v12, s[16:19], s75 offen offset:2048 sc1
    s_mov_b64 exec, -1
    v_mfma_f32_32x32x16_bf16 v[64:79], a[104:107], v[156:159], v[64:79]
    v_mfma_f32_32x32x16_bf16 v[16:31], a[4:7], v[160:163], v[16:31]
    v_mfma_f32_32x32x16_bf16 v[32:47], a[4:7], v[164:167], v[32:47]
    buffer_load_dwordx4 v[152:155], v2, s[16:19], s24 offen offset:3072
    buffer_load_dwordx4 v[156:159], v3, s[16:19], s24 offen offset:3072
    v_mfma_f32_32x32x16_bf16 v[48:63], a[188:191], v[160:163], v[48:63]
    v_mfma_f32_32x32x16_bf16 v[64:79], a[188:191], v[164:167], v[64:79]
    v_mfma_f32_32x32x16_bf16 v[16:31], a[144:147], v[168:171], v[16:31]
    buffer_load_dwordx4 v[160:163], v2, s[16:19], s25 offen offset:2048
    buffer_load_dwordx4 v[164:167], v3, s[16:19], s25 offen offset:2048
    v_mfma_f32_32x32x16_bf16 v[32:47], a[144:147], v[172:175], v[32:47]
    v_mfma_f32_32x32x16_bf16 v[48:63], a[148:151], v[168:171], v[48:63]
    v_mfma_f32_32x32x16_bf16 v[64:79], a[148:151], v[172:175], v[64:79]
    buffer_load_dwordx4 v[80:83], v2, s[16:19], s25 offen offset:3072
    buffer_load_dwordx4 v[84:87], v3, s[16:19], s25 offen offset:3072
    v_mfma_f32_32x32x16_bf16 v[16:31], a[28:31], v[176:179], v[16:31]
    v_mfma_f32_32x32x16_bf16 v[32:47], a[28:31], v[180:183], v[32:47]
    v_mfma_f32_32x32x16_bf16 v[48:63], a[200:203], v[176:179], v[48:63]
    s_waitcnt vmcnt(10)
    s_mov_b64 exec, 1
    buffer_store_dword v13, off, s[16:19], s74 offset:3072 sc1
    s_mov_b64 exec, -1
    buffer_load_dwordx4 v[168:171], v2, s[16:19], s26 offen offset:2048
    buffer_load_dwordx4 v[172:175], v3, s[16:19], s26 offen offset:2048
    v_mfma_f32_32x32x16_bf16 v[64:79], a[200:203], v[180:183], v[64:79]
    v_mfma_f32_32x32x16_bf16 v[16:31], a[164:167], v[184:187], v[16:31]
    s_mov_b64 exec, 15
    s_waitcnt vmcnt(9)
    v_xor_b32 v14, s36, v14
    v_xor_b32 v15, s36, v15
    v_or_b32 v14, v14, v15
    v_cmp_ne_u32 vcc, 0, v14
    s_cbranch_vccnz LG_slow7
LG_back7:
    s_mov_b64 exec, -1
    v_mfma_f32_32x32x16_bf16 v[32:47], a[164:167], v[188:191], v[32:47]
    buffer_load_dwordx4 v[176:179], v2, s[16:19], s26 offen offset:3072
    buffer_load_dwordx4 v[180:183], v3, s[16:19], s26 offen offset:3072
    v_mfma_f32_32x32x16_bf16 v[48:63], a[24:27], v[184:187], v[48:63]
    v_mfma_f32_32x32x16_bf16 v[64:79], a[24:27], v[188:191], v[64:79]
    v_mfma_f32_32x32x16_bf16 v[16:31], a[40:43], v[192:195], v[16:31]
    buffer_load_dwordx4 v[184:187], v2, s[16:19], s27 offen offset:2048
    buffer_load_dwordx4 v[188:191], v3, s[16:19], s27 offen offset:2048
    v_mfma_f32_32x32x16_bf16 v[32:47], a[40:43], v[196:199], v[32:47]
    v_mfma_f32_32x32x16_bf16 v[48:63], a[76:79], v[192:195], v[48:63]
    v_mfma_f32_32x32x16_bf16 v[64:79], a[76:79], v[196:199], v[64:79]
    buffer_load_dwordx4 v[88:91], v2, s[16:19], s27 offen offset:3072
    buffer_load_dwordx4 v[92:95], v3, s[16:19], s27 offen offset:3072
    v_mfma_f32_32x32x16_bf16 v[16:31], a[172:175], v[200:203], v[16:31]
    v_mfma_f32_32x32x16_bf16 v[32:47], a[172:175], v[204:207], v[32:47]
    v_mfma_f32_32x32x16_bf16 v[48:63], a[44:47], v[200:203], v[48:63]
    buffer_load_dwordx4 v[192:195], v4, s[16:19], s4 offen offset:0 sc1
    buffer_load_dwordx4 v[196:199], v5, s[16:19], s4 offen offset:0 sc1
    v_mfma_f32_32x32x16_bf16 v[64:79], a[44:47], v[204:207], v[64:79]
    v_mfma_f32_32x32x16_bf16 v[16:31], a[108:111], v[144:147], v[16:31]
    s_barrier
    s_and_b32 s48, s45, 7
    v_lshrrev_b32 v252, 4, v0
    v_and_b32 v253, 15, v0
    v_lshrrev_b32 v254, 3, v252
    v_and_b32 v255, 7, v252
    v_mfma_f32_32x32x16_bf16 v[32:47], a[108:111], v[148:151], v[32:47]
    v_lshlrev_b32 v254, 15, v254
    v_lshl_add_u32 v254, v255, 4, v254
    v_lshl_add_u32 v254, v253, 8, v254
    s_lshl_b32 s53, s72, 16
    s_lshl_b32 s54, s48, 12
    s_add_u32 s54, s54, s53
    buffer_load_dwordx4 v[200:203], v4, s[16:19], s5 offen offset:0 sc1
    buffer_load_dwordx4 v[204:207], v5, s[16:19], s5 offen offset:0 sc1
    v_mfma_f32_32x32x16_bf16 v[48:63], a[132:135], v[144:147], v[48:63]
    s_add_u32 s54, s54, 4194304
    buffer_load_dwordx4 v[240:243], v254, s[16:19], s54 offen offset:0 sc1
    buffer_load_dwordx4 v[244:247], v254, s[16:19], s54 offen offset:128 sc1
    v_and_b32 v8, 31, v0
    v_bfe_u32 v9, v0, 5, 1
    v_mul_u32_u24 v8, 272, v8
    v_mfma_f32_32x32x16_bf16 v[64:79], a[132:135], v[148:151], v[64:79]
    v_lshl_add_u32 v8, v9, 4, v8
    s_mul_i32 s54, s44, 17408
    v_add_u32 v8, s54, v8
    s_mov_b64 exec, 15
    buffer_load_dwordx2 v[14:15], v12, s[16:19], s75 offen offset:3072 sc1
    s_mov_b64 exec, -1
    s_waitcnt vmcnt(20)
    v_mfma_f32_32x32x16_bf16 v[16:31], a[152:155], v[152:155], v[16:31]
    buffer_load_dwordx4 v[144:147], v4, s[16:19], s6 offen offset:0 sc1
    buffer_load_dwordx4 v[148:151], v5, s[16:19], s6 offen offset:0 sc1
    v_mfma_f32_32x32x16_bf16 v[32:47], a[152:155], v[156:159], v[32:47]
    v_mfma_f32_32x32x16_bf16 v[48:63], a[12:15], v[152:155], v[48:63]
    v_mfma_f32_32x32x16_bf16 v[64:79], a[12:15], v[156:159], v[64:79]
    buffer_load_dwordx4 v[96:99], v4, s[16:19], s7 offen offset:0 sc1
    buffer_load_dwordx4 v[100:103], v5, s[16:19], s7 offen offset:0 sc1
    s_waitcnt vmcnt(22)
    v_mfma_f32_32x32x16_bf16 v[16:31], a[64:67], v[160:163], v[16:31]
    v_mfma_f32_32x32x16_bf16 v[32:47], a[64:67], v[164:167], v[32:47]
    v_mfma_f32_32x32x16_bf16 v[48:63], a[212:215], v[160:163], v[48:63]
    v_mfma_f32_32x32x16_bf16 v[64:79], a[212:215], v[164:167], v[64:79]
    s_waitcnt vmcnt(20)
    v_mfma_f32_32x32x16_bf16 v[16:31], a[180:183], v[80:83], v[16:31]
    v_mfma_f32_32x32x16_bf16 v[32:47], a[180:183], v[84:87], v[32:47]
    v_mfma_f32_32x32x16_bf16 v[48:63], a[192:195], v[80:83], v[48:63]
    v_mfma_f32_32x32x16_bf16 v[64:79], a[192:195], v[84:87], v[64:79]
    s_waitcnt vmcnt(17)
    v_mfma_f32_32x32x16_bf16 v[16:31], a[112:115], v[168:171], v[16:31]
    s_add_u32 s3, s21, 8192
    buffer_load_dwordx4 a[236:239], v11, s[16:19], s3 offen offset:3072
    s_mov_b64 exec, 15
    s_waitcnt vmcnt(5)
    v_xor_b32 v14, s36, v14
    v_xor_b32 v15, s36, v15
    v_or_b32 v14, v14, v15
    v_cmp_ne_u32 vcc, 0, v14
    s_cbranch_vccnz LG_slow8
LG_back8:
    s_mov_b64 exec, -1
    v_mfma_f32_32x32x16_bf16 v[32:47], a[112:115], v[172:175], v[32:47]
    buffer_load_dwordx4 v[152:155], v4, s[16:19], s4 offen offset:1024 sc1
    buffer_load_dwordx4 v[156:159], v5, s[16:19], s4 offen offset:1024 sc1
    v_mfma_f32_32x32x16_bf16 v[48:63], a[224:227], v[168:171], v[48:63]
    v_mfma_f32_32x32x16_bf16 v[64:79], a[224:227], v[172:175], v[64:79]
    v_mfma_f32_32x32x16_bf16 v[16:31], a[16:19], v[176:179], v[16:31]
    buffer_load_dwordx4 v[160:163], v4, s[16:19], s5 offen offset:1024 sc1
    buffer_load_dwordx4 v[164:167], v5, s[16:19], s5 offen offset:1024 sc1
    v_mfma_f32_32x32x16_bf16 v[32:47], a[16:19], v[180:183], v[32:47]
    v_mfma_f32_32x32x16_bf16 v[48:63], a[68:71], v[176:179], v[48:63]
    v_mfma_f32_32x32x16_bf16 v[64:79], a[68:71], v[180:183], v[64:79]
    buffer_load_dwordx4 v[168:171], v4, s[16:19], s6 offen offset:1024 sc1
    buffer_load_dwordx4 v[172:175], v5, s[16:19], s6 offen offset:1024 sc1
    v_mfma_f32_32x32x16_bf16 v[16:31], a[124:127], v[184:187], v[16:31]
    v_mfma_f32_32x32x16_bf16 v[32:47], a[124:127], v[188:191], v[32:47]
    v_mfma_f32_32x32x16_bf16 v[48:63], a[160:163], v[184:187], v[48:63]
    buffer_load_dwordx4 v[176:179], v4, s[16:19], s7 offen offset:1024 sc1
    buffer_load_dwordx4 v[180:183], v5, s[16:19], s7 offen offset:1024 sc1
    v_mfma_f32_32x32x16_bf16 v[64:79], a[160:163], v[188:191], v[64:79]
    v_mfma_f32_32x32x16_bf16 v[16:31], a[36:39], v[88:91], v[16:31]
    v_mfma_f32_32x32x16_bf16 v[32:47], a[36:39], v[92:95], v[32:47]
    s_add_u32 s60, s24, 4096
    buffer_load_dwordx4 v[184:187], v2, s[16:19], s60 offen offset:0
    buffer_load_dwordx4 v[188:191], v3, s[16:19], s60 offen offset:0
    v_mfma_f32_32x32x16_bf16 v[48:63], a[96:99], v[88:91], v[48:63]
    v_mfma_f32_32x32x16_bf16 v[64:79], a[96:99], v[92:95], v[64:79]
    v_mfma_f32_32x32x16_bf16 v[16:31], a[136:139], v[192:195], v[16:31]
    s_add_u32 s60, s25, 4096
    buffer_load_dwordx4 v[80:83], v2, s[16:19], s60 offen offset:0
    buffer_load_dwordx4 v[84:87], v3, s[16:19], s60 offen offset:0
    v_mfma_f32_32x32x16_bf16 v[32:47], a[136:139], v[196:199], v[32:47]
    v_mfma_f32_32x32x16_bf16 v[48:63], a[0:3], v[192:195], v[48:63]
    v_mfma_f32_32x32x16_bf16 v[64:79], a[0:3], v[196:199], v[64:79]
    s_add_u32 s60, s26, 4096
    buffer_load_dwordx4 v[88:91], v2, s[16:19], s60 offen offset:0
    buffer_load_dwordx4 v[92:95], v3, s[16:19], s60 offen offset:0
    s_waitcnt vmcnt(14)
    v_mfma_f32_32x32x16_bf16 v[16:31], a[72:75], v[200:203], v[16:31]
    s_add_u32 s3, s22, 8192
    buffer_load_dwordx4 a[244:247], v11, s[16:19], s3 offen offset:3072
    v_mfma_f32_32x32x16_bf16 v[32:47], a[72:75], v[204:207], v[32:47]
    s_add_u32 s3, s23, 8192
    buffer_load_dwordx4 a[248:251], v11, s[16:19], s3 offen offset:3072
    v_mfma_f32_32x32x16_bf16 v[48:63], a[236:239], v[200:203], v[48:63]
    s_add_u32 s60, s27, 4096
    buffer_load_dwordx4 v[192:195], v2, s[16:19], s60 offen offset:0
    buffer_load_dwordx4 v[196:199], v3, s[16:19], s60 offen offset:0
    v_mfma_f32_32x32x16_bf16 v[64:79], a[236:239], v[204:207], v[64:79]
    s_add_u32 s3, s21, 12288
    buffer_load_dwordx4 a[116:119], v11, s[16:19], s3 offen offset:0
    s_waitcnt vmcnt(4)
    v_mfma_f32_32x32x16_bf16 v[16:31], a[92:95], v[144:147], v[16:31]
    s_add_u32 s3, s22, 12288
    buffer_load_dwordx4 a[120:123], v11, s[16:19], s3 offen offset:0
    v_mfma_f32_32x32x16_bf16 v[32:47], a[92:95], v[148:151], v[32:47]
    s_add_u32 s3, s23, 12288
    buffer_load_dwordx4 a[208:211], v11, s[16:19], s3 offen offset:0
    v_mfma_f32_32x32x16_bf16 v[48:63], a[244:247], v[144:147], v[48:63]
    s_add_u32 s3, s21, 12288
    buffer_load_dwordx4 a[216:219], v11, s[16:19], s3 offen offset:1024
    v_mfma_f32_32x32x16_bf16 v[64:79], a[244:247], v[148:151], v[64:79]
    s_add_u32 s3, s22, 12288
    buffer_load_dwordx4 a[228:231], v11, s[16:19], s3 offen offset:1024
    s_waitcnt vmcnt(7)
    v_mfma_f32_32x32x16_bf16 v[16:31], a[232:235], v[96:99], v[16:31]
    s_add_u32 s3, s23, 12288
    buffer_load_dwordx4 a[140:143], v11, s[16:19], s3 offen offset:1024
    v_mfma_f32_32x32x16_bf16 v[32:47], a[232:235], v[100:103], v[32:47]
    v_mfma_f32_32x32x16_bf16 v[48:63], a[248:251], v[96:99], v[48:63]
    v_mfma_f32_32x32x16_bf16 v[64:79], a[248:251], v[100:103], v[64:79]
    v_mfma_f32_32x32x16_bf16 v[16:31], a[56:59], v[152:155], v[16:31]
    s_waitcnt vmcnt(2)
    v_mfma_f32_32x32x16_bf16 v[16:31], a[116:119], v[160:163], v[16:31]
    s_waitcnt vmcnt(1)
    v_mfma_f32_32x32x16_bf16 v[16:31], a[120:123], v[168:171], v[16:31]
    s_waitcnt vmcnt(0)
    v_mfma_f32_32x32x16_bf16 v[16:31], a[208:211], v[176:179], v[16:31]
    v_mfma_f32_32x32x16_bf16 v[16:31], a[48:51], v[184:187], v[16:31]
    v_mfma_f32_32x32x16_bf16 v[16:31], a[240:243], v[80:83], v[16:31]
    v_mfma_f32_32x32x16_bf16 v[16:31], a[252:255], v[88:91], v[16:31]
    v_mfma_f32_32x32x16_bf16 v[16:31], a[128:131], v[192:195], v[16:31]
    v_mfma_f32_32x32x16_bf16 v[32:47], a[56:59], v[156:159], v[32:47]
    v_mfma_f32_32x32x16_bf16 v[32:47], a[116:119], v[164:167], v[32:47]
    v_mfma_f32_32x32x16_bf16 v[32:47], a[120:123], v[172:175], v[32:47]
    ds_write_b128 v8, v[16:19] offset:0
    v_mfma_f32_32x32x16_bf16 v[32:47], a[208:211], v[180:183], v[32:47]
    v_mfma_f32_32x32x16_bf16 v[32:47], a[48:51], v[188:191], v[32:47]
    ds_write_b128 v8, v[20:23] offset:32
    v_mfma_f32_32x32x16_bf16 v[32:47], a[240:243], v[84:87], v[32:47]
    v_mfma_f32_32x32x16_bf16 v[32:47], a[252:255], v[92:95], v[32:47]
    ds_write_b128 v8, v[24:27] offset:64
    v_mfma_f32_32x32x16_bf16 v[32:47], a[128:131], v[196:199], v[32:47]
    v_mfma_f32_32x32x16_bf16 v[48:63], a[88:91], v[152:155], v[48:63]
    ds_write_b128 v8, v[28:31] offset:96
    v_mfma_f32_32x32x16_bf16 v[48:63], a[216:219], v[160:163], v[48:63]
    v_mfma_f32_32x32x16_bf16 v[48:63], a[228:231], v[168:171], v[48:63]
    ds_write_b128 v8, v[32:35] offset:8704
    v_mfma_f32_32x32x16_bf16 v[48:63], a[140:143], v[176:179], v[48:63]
    v_mfma_f32_32x32x16_bf16 v[48:63], a[60:63], v[184:187], v[48:63]
    ds_write_b128 v8, v[36:39] offset:8736
    v_mfma_f32_32x32x16_bf16 v[48:63], a[220:223], v[80:83], v[48:63]
    v_mfma_f32_32x32x16_bf16 v[48:63], a[196:199], v[88:91], v[48:63]
    ds_write_b128 v8, v[40:43] offset:8768
    v_mfma_f32_32x32x16_bf16 v[48:63], a[204:207], v[192:195], v[48:63]
    v_mfma_f32_32x32x16_bf16 v[64:79], a[88:91], v[156:159], v[64:79]
    ds_write_b128 v8, v[44:47] offset:8800
    v_mfma_f32_32x32x16_bf16 v[64:79], a[216:219], v[164:167], v[64:79]
    v_mfma_f32_32x32x16_bf16 v[64:79], a[228:231], v[172:175], v[64:79]
    ds_write_b128 v8, v[48:51] offset:128
    v_mfma_f32_32x32x16_bf16 v[64:79], a[140:143], v[180:183], v[64:79]
    v_mfma_f32_32x32x16_bf16 v[64:79], a[60:63], v[188:191], v[64:79]
    ds_write_b128 v8, v[52:55] offset:160
    v_mfma_f32_32x32x16_bf16 v[64:79], a[220:223], v[84:87], v[64:79]
    v_mfma_f32_32x32x16_bf16 v[64:79], a[196:199], v[92:95], v[64:79]
    ds_write_b128 v8, v[56:59] offset:192
    v_mfma_f32_32x32x16_bf16 v[64:79], a[204:207], v[196:199], v[64:79]
    v_mul_u32_u24 v9, 1088, v252
    v_lshl_add_u32 v9, v253, 4, v9
    v_lshlrev_b32 v10, 12, v252
    v_lshl_add_u32 v10, v253, 3, v10
    s_lshl_b32 s53, s72, 16
    s_lshl_b32 s54, s48, 7
    s_add_u32 s53, s53, s54
    s_nop 7
    ds_write_b128 v8, v[60:63] offset:224
    ds_write_b128 v8, v[64:67] offset:8832
    ds_write_b128 v8, v[68:71] offset:8864
    ds_write_b128 v8, v[72:75] offset:8896
    ds_write_b128 v8, v[76:79] offset:8928
    s_mov_b32 s32, s8
    s_and_b32 s33, s9, 0xffff
    s_mov_b32 s34, 0x200000
    s_mov_b32 s35, 0x00020000
    v_lshlrev_b32 v13, 4, v253
    s_lshl_b32 s54, s48, 8
    s_add_u32 s54, s54, 141312
    v_add_u32 v13, s54, v13
    v_lshlrev_b32 v112, 16, v240
    v_and_b32 v113, s40, v240
    v_lshlrev_b32 v114, 16, v244
    v_and_b32 v115, s40, v244
    v_lshlrev_b32 v116, 16, v241
    v_and_b32 v117, s40, v241
    v_lshlrev_b32 v118, 16, v245
    v_and_b32 v119, s40, v245
    v_lshlrev_b32 v120, 16, v242
    v_and_b32 v121, s40, v242
    v_lshlrev_b32 v122, 16, v246
    v_and_b32 v123, s40, v246
    v_lshlrev_b32 v124, 16, v243
    v_and_b32 v125, s40, v243
    v_lshlrev_b32 v126, 16, v247
    v_and_b32 v127, s40, v247
    s_waitcnt lgkmcnt(0)
    s_barrier
    ds_read_b128 v[128:131], v9 offset:0
    ds_read_b128 v[132:135], v9 offset:272
    ds_read_b128 v[136:139], v9 offset:544
    ds_read_b128 v[140:143], v9 offset:816
    ds_read_b128 v[144:147], v9 offset:17408
    ds_read_b128 v[148:151], v9 offset:17680
    ds_read_b128 v[152:155], v9 offset:17952
    ds_read_b128 v[156:159], v9 offset:18224
    ds_read_b128 v[160:163], v9 offset:34816
    ds_read_b128 v[164:167], v9 offset:35088
    ds_read_b128 v[168:171], v9 offset:35360
    ds_read_b128 v[172:175], v9 offset:35632
    ds_read_b128 v[176:179], v9 offset:52224
    ds_read_b128 v[180:183], v9 offset:52496
    ds_read_b128 v[184:187], v9 offset:52768
    s_waitcnt lgkmcnt(7)
    ds_read_b128 v[188:191], v9 offset:53040
    ds_read_b128 v[96:99], v13
    v_pk_add_f32 v[128:129], v[128:129], v[144:145]
    v_pk_add_f32 v[130:131], v[130:131], v[146:147]
    v_pk_add_f32 v[132:133], v[132:133], v[148:149]
    v_pk_add_f32 v[134:135], v[134:135], v[150:151]
    v_pk_add_f32 v[136:137], v[136:137], v[152:153]
    v_pk_add_f32 v[138:139], v[138:139], v[154:155]
    v_pk_add_f32 v[140:141], v[140:141], v[156:157]
    v_pk_add_f32 v[142:143], v[142:143], v[158:159]
    s_waitcnt lgkmcnt(0)
    v_pk_add_f32 v[160:161], v[160:161], v[176:177]
    v_pk_add_f32 v[162:163], v[162:163], v[178:179]
    v_pk_add_f32 v[164:165], v[164:165], v[180:181]
    v_pk_add_f32 v[166:167], v[166:167], v[182:183]
    v_pk_add_f32 v[168:169], v[168:169], v[184:185]
    v_pk_add_f32 v[170:171], v[170:171], v[186:187]
    v_pk_add_f32 v[172:173], v[172:173], v[188:189]
    v_pk_add_f32 v[174:175], v[174:175], v[190:191]
    v_pk_add_f32 v[128:129], v[128:129], v[160:161]
    v_pk_add_f32 v[130:131], v[130:131], v[162:163]
    v_pk_add_f32 v[132:133], v[132:133], v[164:165]
    v_pk_add_f32 v[134:135], v[134:135], v[166:167]
    v_pk_add_f32 v[136:137], v[136:137], v[168:169]
    v_pk_add_f32 v[138:139], v[138:139], v[170:171]
    v_pk_add_f32 v[140:141], v[140:141], v[172:173]
    v_pk_add_f32 v[142:143], v[142:143], v[174:175]
    v_cvt_pk_bf16_f32 v128, 0, v128
    v_cvt_pk_bf16_f32 v129, 0, v129
    v_cvt_pk_bf16_f32 v130, 0, v130
    v_cvt_pk_bf16_f32 v131, 0, v131
    v_cvt_pk_bf16_f32 v132, 0, v132
    v_cvt_pk_bf16_f32 v133, 0, v133
    v_cvt_pk_bf16_f32 v134, 0, v134
    v_cvt_pk_bf16_f32 v135, 0, v135
    v_cvt_pk_bf16_f32 v136, 0, v136
    v_cvt_pk_bf16_f32 v137, 0, v137
    v_cvt_pk_bf16_f32 v138, 0, v138
    v_cvt_pk_bf16_f32 v139, 0, v139
    v_cvt_pk_bf16_f32 v140, 0, v140
    v_cvt_pk_bf16_f32 v141, 0, v141
    v_cvt_pk_bf16_f32 v142, 0, v142
    v_cvt_pk_bf16_f32 v143, 0, v143
    v_pk_mul_f32 v[128:129], v[128:129], v[96:97]
    v_pk_mul_f32 v[130:131], v[130:131], v[98:99]
    v_pk_mul_f32 v[132:133], v[132:133], v[96:97]
    v_pk_mul_f32 v[134:135], v[134:135], v[98:99]
    v_pk_mul_f32 v[136:137], v[136:137], v[96:97]
    v_pk_mul_f32 v[138:139], v[138:139], v[98:99]
    v_pk_mul_f32 v[140:141], v[140:141], v[96:97]
    v_pk_mul_f32 v[142:143], v[142:143], v[98:99]
    v_cvt_pk_bf16_f32 v128, 0, v128
    v_cvt_pk_bf16_f32 v129, 0, v129
    v_cvt_pk_bf16_f32 v130, 0, v130
    v_cvt_pk_bf16_f32 v131, 0, v131
    v_cvt_pk_bf16_f32 v132, 0, v132
    v_cvt_pk_bf16_f32 v133, 0, v133
    v_cvt_pk_bf16_f32 v134, 0, v134
    v_cvt_pk_bf16_f32 v135, 0, v135
    v_cvt_pk_bf16_f32 v136, 0, v136
    v_cvt_pk_bf16_f32 v137, 0, v137
    v_cvt_pk_bf16_f32 v138, 0, v138
    v_cvt_pk_bf16_f32 v139, 0, v139
    v_cvt_pk_bf16_f32 v140, 0, v140
    v_cvt_pk_bf16_f32 v141, 0, v141
    v_cvt_pk_bf16_f32 v142, 0, v142
    v_cvt_pk_bf16_f32 v143, 0, v143
    v_pk_add_f32 v[128:129], v[128:129], v[112:113]
    v_pk_add_f32 v[130:131], v[130:131], v[114:115]
    v_pk_add_f32 v[132:133], v[132:133], v[116:117]
    v_pk_add_f32 v[134:135], v[134:135], v[118:119]
    v_pk_add_f32 v[136:137], v[136:137], v[120:121]
    v_pk_add_f32 v[138:139], v[138:139], v[122:123]
    v_pk_add_f32 v[140:141], v[140:141], v[124:125]
    v_pk_add_f32 v[142:143], v[142:143], v[126:127]
    v_cvt_pk_bf16_f32 v144, v128, v129
    v_cvt_pk_bf16_f32 v145, v130, v131
    v_cvt_pk_bf16_f32 v146, v132, v133
    v_cvt_pk_bf16_f32 v147, v134, v135
    v_cvt_pk_bf16_f32 v148, v136, v137
    v_cvt_pk_bf16_f32 v149, v138, v139
    v_cvt_pk_bf16_f32 v150, v140, v141
    v_cvt_pk_bf16_f32 v151, v142, v143
    buffer_store_dwordx2 v[144:145], v10, s[32:35], s53 offen offset:0
    buffer_store_dwordx2 v[146:147], v10, s[32:35], s53 offen offset:1024
    buffer_store_dwordx2 v[148:149], v10, s[32:35], s53 offen offset:2048
    buffer_store_dwordx2 v[150:151], v10, s[32:35], s53 offen offset:3072
    s_endpgm
LG_slow0:
    s_mov_b32 s59, 0
LG_slowl0:
    s_sleep 1
    buffer_load_dwordx2 v[48:49], v189, s[16:19], s37 offen sc1
    s_add_u32 s59, s59, 1
    s_waitcnt vmcnt(0)
    v_xor_b32 v48, s36, v48
    v_xor_b32 v49, s36, v49
    v_or_b32 v48, v48, v49
    v_cmp_ne_u32 vcc, 0, v48
    s_cbranch_vccz LG_back0
    s_cmp_lt_u32 s59, 8192
    s_cbranch_scc1 LG_slowl0
    s_branch LG_back0
LG_slow1:
    s_mov_b32 s59, 0
LG_slowl1:
    s_sleep 1
    buffer_load_dwordx2 v[144:145], v24, s[16:19], s54 offen offset:0 sc1
    buffer_load_dwordx2 v[146:147], v24, s[16:19], s54 offen offset:2048 sc1
    buffer_load_dwordx2 v[148:149], v24, s[16:19], s55 offen offset:0 sc1
    buffer_load_dwordx2 v[150:151], v24, s[16:19], s55 offen offset:2048 sc1
    buffer_load_dwordx2 v[152:153], v24, s[16:19], s56 offen offset:0 sc1
    buffer_load_dwordx2 v[154:155], v24, s[16:19], s56 offen offset:2048 sc1
    buffer_load_dwordx2 v[156:157], v189, s[16:19], s56 offen sc1
    s_add_u32 s59, s59, 1
    s_waitcnt vmcnt(0)
    v_xor_b32 v145, s36, v145
    v_xor_b32 v147, s36, v147
    v_xor_b32 v149, s36, v149
    v_xor_b32 v151, s36, v151
    v_xor_b32 v153, s36, v153
    v_xor_b32 v155, s36, v155
    v_xor_b32 v157, s36, v157
    v_or3_b32 v145, v145, v147, v149
    v_or3_b32 v145, v145, v151, v153
    v_or3_b32 v145, v145, v155, v157
    v_cmp_ne_u32 vcc, 0, v145
    s_cbranch_vccz LG_back1
    s_cmp_lt_u32 s59, 8192
    s_cbranch_scc1 LG_slowl1
    s_branch LG_back1
LG_slow2:
    s_mov_b32 s59, 0
LG_slowl2:
    s_sleep 1
    buffer_load_dword v208, v232, s[16:19], s98 offen offset:0 sc1
    buffer_load_dword v209, v232, s[16:19], s98 offen offset:128 sc1
    buffer_load_dword v210, v232, s[16:19], s98 offen offset:256 sc1
    buffer_load_dword v211, v232, s[16:19], s98 offen offset:384 sc1
    buffer_load_dword v212, v232, s[16:19], s58 offen offset:0 sc1
    buffer_load_dword v213, v232, s[16:19], s58 offen offset:128 sc1
    buffer_load_dword v214, v232, s[16:19], s58 offen offset:256 sc1
    buffer_load_dword v215, v232, s[16:19], s58 offen offset:384 sc1
    s_add_u32 s59, s59, 1
    s_waitcnt vmcnt(0)
    v_max3_u32 v217, v208, v209, v210
    v_max3_u32 v217, v217, v211, v212
    v_max3_u32 v217, v217, v213, v214
    v_max_u32 v217, v217, v215
    v_cmp_eq_u32 vcc, -1, v217
    s_cbranch_vccz LG_back2
    s_cmp_lt_u32 s59, 8192
    s_cbranch_scc1 LG_slowl2
    s_branch LG_back2
LG_slow3:
    s_mov_b32 s59, 0
LG_slowl3:
    s_sleep 4
    buffer_load_dword v200, v205, s[16:19], s61 offen sc1
    s_add_u32 s59, s59, 1
    s_waitcnt vmcnt(0)
    v_cmp_ne_u32 vcc, s36, v200
    s_cbranch_vccz LG_back3
    s_cmp_lt_u32 s59, 8192
    s_cbranch_scc1 LG_slowl3
    s_branch LG_back3
LG_slow4:
    s_mov_b32 s59, 0
LG_slowl4:
    s_sleep 0
    buffer_load_dword v14, v250, s[16:19], s67 offen sc1
    s_add_u32 s59, s59, 1
    s_waitcnt vmcnt(0)
    v_cmp_ne_u32 vcc, s36, v14
    s_cbranch_vccz LG_back4
    s_cmp_lt_u32 s59, 8192
    s_cbranch_scc1 LG_slowl4
    s_branch LG_back4
LG_slow5:
    s_mov_b32 s59, 0
LG_slowl5:
    s_sleep 1
    buffer_load_dwordx2 v[14:15], v12, s[16:19], s33 offen offset:0 sc1
    s_add_u32 s59, s59, 1
    s_waitcnt vmcnt(0)
    v_xor_b32 v14, s36, v14
    v_xor_b32 v15, s36, v15
    v_or_b32 v14, v14, v15
    v_cmp_ne_u32 vcc, 0, v14
    s_cbranch_vccz LG_back5
    s_cmp_lt_u32 s59, 8192
    s_cbranch_scc1 LG_slowl5
    s_branch LG_back5
LG_slow6:
    s_mov_b32 s59, 0
LG_slowl6:
    s_sleep 1
    buffer_load_dwordx2 v[14:15], v12, s[16:19], s75 offen offset:1024 sc1
    s_add_u32 s59, s59, 1
    s_waitcnt vmcnt(0)
    v_xor_b32 v14, s36, v14
    v_xor_b32 v15, s36, v15
    v_or_b32 v14, v14, v15
    v_cmp_ne_u32 vcc, 0, v14
    s_cbranch_vccz LG_back6
    s_cmp_lt_u32 s59, 8192
    s_cbranch_scc1 LG_slowl6
    s_branch LG_back6
LG_slow7:
    s_mov_b32 s59, 0
LG_slowl7:
    s_sleep 1
    buffer_load_dwordx2 v[14:15], v12, s[16:19], s75 offen offset:2048 sc1
    s_add_u32 s59, s59, 1
    s_waitcnt vmcnt(0)
    v_xor_b32 v14, s36, v14
    v_xor_b32 v15, s36, v15
    v_or_b32 v14, v14, v15
    v_cmp_ne_u32 vcc, 0, v14
    s_cbranch_vccz LG_back7
    s_cmp_lt_u32 s59, 8192
    s_cbranch_scc1 LG_slowl7
    s_branch LG_back7
LG_slow8:
    s_mov_b32 s59, 0
LG_slowl8:
    s_sleep 1
    buffer_load_dwordx2 v[14:15], v12, s[16:19], s75 offen offset:3072 sc1
    s_add_u32 s59, s59, 1
    s_waitcnt vmcnt(0)
    v_xor_b32 v14, s36, v14
    v_xor_b32 v15, s36, v15
    v_or_b32 v14, v14, v15
    v_cmp_ne_u32 vcc, 0, v14
    s_cbranch_vccz LG_back8
    s_cmp_lt_u32 s59, 8192
    s_cbranch_scc1 LG_slowl8
    s_branch LG_back8

Lm_done:
    s_endpgm

Lcode_end:
.section .rodata,"a"
.p2align 6
.amdhsa_kernel mega_kernel
  .amdhsa_next_free_vgpr 512
  .amdhsa_next_free_sgpr 102
  .amdhsa_accum_offset 256
  .amdhsa_group_segment_fixed_size 0
  .amdhsa_kernarg_size 120
  .amdhsa_user_sgpr_count 2
  .amdhsa_user_sgpr_kernarg_segment_ptr 1
  .amdhsa_system_sgpr_workgroup_id_x 1
.end_amdhsa_kernel
```
